```python
import torch

def _softmax(x, axis=-1):
    return torch.softmax(x, dim=axis)
def _gelu(x):
    return torch.nn.functional.gelu(x, approximate="tanh")
def _silu(x):
    return torch.nn.functional.silu(x)
def _sigmoid(x):
    return torch.sigmoid(x)
def _layernorm(x, axis=-1, eps=1e-5):
    m = x.mean(dim=axis, keepdim=True)
    v = x.var(dim=axis, keepdim=True, unbiased=False)
    return (x - m) / torch.sqrt(v + eps)
def _scatter_add(tgt, idx, src, axis=0):
    return tgt.clone().index_add_(axis, idx, src)
def _segment_sum(src, seg, n):
    out = torch.zeros((n,) + src.shape[1:], dtype=src.dtype)
    return out.index_add_(0, seg, src)
def _pad(x, pw):
    flat = tuple(v for pair in reversed(pw) for v in pair)
    return torch.nn.functional.pad(x, flat)

kernel_name = 'interleave_layers__softmax_full_mha__dense_activation_gelu__prompt'

def setup_inputs():

    _w = (lambda a: (lambda t: t.to(torch.bfloat16) if t.is_floating_point() else t)(torch.as_tensor(a)))
    def _A_setup():
        B, S, D = 1, 2048, 640
        return {
            "x": _w((lambda *s: torch.randn(*s, dtype=torch.bfloat16) * 0.05)(B, S, D)),
            "wqkv": _w((lambda *s: torch.randn(*s, dtype=torch.bfloat16) * 0.05)(D, 3 * D)),
            "wo": _w((lambda *s: torch.randn(*s, dtype=torch.bfloat16) * 0.05)(D, D)),
        }
    _A_in = _A_setup()

    def _B_setup():
        B, S, D, F = 1, 2048, 640, 1536
        return {
            "x": _w((lambda *s: torch.randn(*s, dtype=torch.bfloat16) * 0.05)(B, S, D)),
            "w1": _w((lambda *s: torch.randn(*s, dtype=torch.bfloat16) * 0.8)(D, F) * (D ** -0.5)),
            "b1": _w((lambda *s: torch.randn(*s, dtype=torch.bfloat16) * 0.8)(F) * 0.01),
            "w2": _w((lambda *s: torch.randn(*s, dtype=torch.bfloat16) * 0.8)(F, D) * (F ** -0.5)),
            "b2": _w((lambda *s: torch.randn(*s, dtype=torch.bfloat16) * 0.8)(D) * 0.01),
        }
    _B_in = _B_setup()

    return {
        "A_x": _A_in["x"],
        "A_wqkv": _A_in["wqkv"],
        "A_wo": _A_in["wo"],
        "B_x": _B_in["x"],
        "B_w1": _B_in["w1"],
        "B_b1": _B_in["b1"],
        "B_w2": _B_in["w2"],
        "B_b2": _B_in["b2"],
    }

def reference(A_x, A_wqkv, A_wo, B_x, B_w1, B_b1, B_w2, B_b2):
    def _A_ref(x, wqkv, wo):
        B, S, D = x.shape
        H = 32; Dh = D // H
        qkv = (lambda x, *d: x.permute(*d))((x @ wqkv).reshape(B, S, 3, H, Dh), 2, 0, 3, 1, 4)
        q, k, v = qkv[0], qkv[1], qkv[2]
        scale = Dh ** -0.5
        scores = torch.einsum("bhqd,bhkd->bhqk", q, k) * scale
        p = _softmax(scores, axis=-1)
        o = torch.einsum("bhqk,bhkd->bhqd", p, v)
        return (lambda x, *d: x.permute(*d))(o, 0, 2, 1, 3).reshape(B, S, D) @ wo

    def _B_ref(x, w1, b1, w2, b2):
        h = torch.einsum("bsd,df->bsf", x, w1) + b1
        h = _gelu(h)
        return torch.einsum("bsf,fd->bsd", h, w2) + b2

    x = A_x
    x = x + _A_ref(_layernorm(x, axis=-1), A_wqkv, A_wo)
    x = x + _B_ref(_layernorm(x, axis=-1), B_w1, B_b1, B_w2, B_b2)
    x = x + _A_ref(_layernorm(x, axis=-1), A_wqkv, A_wo)
    x = x + _B_ref(_layernorm(x, axis=-1), B_w1, B_b1, B_w2, B_b2)
    return x
```

```asm
; @launch grid=(256,1,1) block=(512,1,1) lds=163840
.amdgcn_target "amdgcn-amd-amdhsa--gfx950"
.text
.globl interleave_layers__softmax_full_mha__dense_activation_gelu__prompt_kernel
.type interleave_layers__softmax_full_mha__dense_activation_gelu__prompt_kernel,@function
.p2align 8
interleave_layers__softmax_full_mha__dense_activation_gelu__prompt_kernel:
    s_cmp_ge_u32 s2, 256
    s_cbranch_scc1 L_end
    s_load_dwordx2 s[4:5], s[0:1], 80
    s_load_dwordx2 s[32:33], s[0:1], 0
    s_load_dwordx2 s[8:9], s[0:1], 8
    s_load_dwordx2 s[40:41], s[0:1], 72
    s_load_dwordx2 s[12:13], s[0:1], 16
    s_load_dwordx2 s[16:17], s[0:1], 32
    s_load_dwordx2 s[20:21], s[0:1], 48
    s_load_dwordx2 s[24:25], s[0:1], 40
    s_load_dwordx2 s[28:29], s[0:1], 56
    s_load_dwordx2 s[36:37], s[0:1], 64
    v_lshrrev_b32 v4, 6, v0
    v_and_b32 v0, 63, v0
    v_readfirstlane_b32 s46, v4
    v_and_b32 v2, 15, v0
    s_lshr_b32 s45, s2, 3
    s_cmp_eq_u32 s46, 3
    s_cbranch_scc0 L_cpa
    s_getpc_b64 s[66:67]
L_pca:
    s_lshl_b32 s68, s45, 11
    s_cmp_lt_u32 s68, L_last-L_pca
    s_cbranch_scc0 L_cpa
    v_lshlrev_b32 v4, 7, v2
    v_add_u32 v4, s68, v4
    v_min_u32 v4, L_last-L_pca, v4
    global_load_dword v99, v4, s[66:67]
L_cpa:
    s_mov_b32 s6, 0x10000000
    s_mov_b32 s7, 0x00020000
    s_mov_b32 s34, 0x280000
    s_mov_b32 s35, 0x00020000
    s_mov_b32 s10, 0x258000
    s_mov_b32 s11, 0x00020000
    s_mov_b32 s42, 0x100
    s_mov_b32 s43, 0x00020000
    s_mov_b32 s14, 0xc8000
    s_mov_b32 s15, 0x00020000
    s_mov_b32 s18, 0x1e0000
    s_mov_b32 s19, 0x00020000
    s_mov_b32 s22, 0x1e0000
    s_mov_b32 s23, 0x00020000
    s_mov_b32 s26, 0xc00
    s_mov_b32 s27, 0x00020000
    s_mov_b32 s30, 0x500
    s_mov_b32 s31, 0x00020000
    s_mov_b32 s38, 0x280000
    s_mov_b32 s39, 0x00020000
    v_lshlrev_b32 v1, 4, v0
    v_lshrrev_b32 v3, 4, v0
    v_mov_b32 v46, 0
    v_mov_b32 v47, 0
    v_mov_b32 v48, 0
    v_mov_b32 v49, 0
    s_and_b32 s44, s2, 7
    s_mov_b32 s47, 0
    s_mov_b32 s48, 0x80000
    s_mov_b32 s3, 0
    s_and_b32 s49, s45, 7
    s_and_b32 s50, s45, 1
    s_and_b32 s51, s46, 1
    s_bfe_u32 s52, s46, 0x10001
    s_and_b32 s53, s46, 3
    s_mov_b32 s64, 0x000fffff
    s_mov_b32 s65, 0x000fffff
    s_lshl_b32 s80, s44, 13
    s_add_u32 s80, s80, 0x1520000
    s_cmp_ge_u32 s46, 4
    s_cbranch_scc1 L_q0_load
    s_mul_i32 s66, s49, 160
    s_lshl_b32 s67, s50, 5
    s_add_u32 s54, s66, s67
    s_add_u32 s55, s54, 32
    s_add_u32 s56, s54, 64
    s_add_u32 s57, s54, 96
    s_add_u32 s58, s66, 128
    s_cmp_eq_u32 s50, 1
    s_cmov_b32 s58, s66
    s_bfe_u32 s93, s45, 0x10003
    s_lshr_b32 s66, s45, 4
    s_lshl_b32 s66, s66, 2
    s_add_u32 s66, s66, s53
    s_lshl_b32 s62, s66, 8
    s_add_u32 s62, s62, s80
    s_lshl_b32 s67, s49, 1
    s_add_u32 s67, s67, s93
    s_lshl_b32 s67, s67, 2
    s_add_u32 s62, s62, s67
    s_lshl_b32 s63, s44, 3
    s_add_u32 s63, s63, s66
    s_lshl_b32 s63, s63, 1
    s_add_u32 s63, s63, s93
    s_lshr_b32 s66, s49, 1
    s_mul_i32 s67, s66, 5120
    s_mul_i32 s68, s63, 21504
    s_add_u32 s67, s67, s68
    s_mul_i32 s59, s50, 3072
    s_add_u32 s59, s59, s67
    s_lshl_b32 s60, s50, 3
    s_add_u32 s60, s60, s67
    s_add_u32 s60, s60, 2048
    s_lshl_b32 s66, s66, 8
    s_add_u32 s61, s68, s66
    s_lshl_b32 s66, s50, 3
    s_add_u32 s61, s61, s66
    s_add_u32 s61, s61, 20480
    v_mul_u32_u24 v6, 1280, v2
    v_lshl_add_u32 v6, v3, 3, v6
    s_mul_i32 s66, s63, 20480
    v_add_u32 v6, s66, v6
    s_waitcnt lgkmcnt(0)
    s_or_b32 s71, s46, s45
    s_cmp_eq_u32 s71, 0
    s_cbranch_scc0 L_q0_c1
    v_mov_b32 v108, 0
    v_mov_b32 v109, 0
    v_mov_b32 v110, 0
    v_mov_b32 v111, 0
    s_add_u32 s66, s80, 4096
    buffer_store_dwordx4 v[108:111], v1, s[4:7], s80 offen offset:0 sc1
    buffer_store_dwordx4 v[108:111], v1, s[4:7], s80 offen offset:1024 sc1
    buffer_store_dwordx4 v[108:111], v1, s[4:7], s80 offen offset:3072 sc1
    buffer_store_dwordx4 v[108:111], v1, s[4:7], s66 offen offset:0 sc1
L_q0_c1:
    buffer_load_dwordx2 v[124:125], v6, s[32:35], s54 offen
    buffer_load_dwordx2 v[126:127], v6, s[32:35], s55 offen
    buffer_load_dwordx2 v[128:129], v6, s[32:35], s56 offen
    buffer_load_dwordx2 v[130:131], v6, s[32:35], s57 offen
    buffer_load_dwordx2 v[132:133], v6, s[32:35], s58 offen
    v_lshrrev_b32 v4, 2, v0
    v_mul_u32_u24 v4, 160, v4
    v_lshl_add_u32 v4, s50, 3, v4
    v_and_b32 v5, 3, v0
    v_lshlrev_b32 v6, 3, v5
    v_min_u32 v5, 2, v5
    v_mul_u32_u24 v5, 48, v5
    s_mul_i32 s66, s53, 48
    s_cmp_eq_u32 s53, 3
    s_cselect_b64 vcc, -1, 0
    s_cselect_b32 s66, 32, s66
    s_lshr_b32 s67, s46, 2
    s_mul_i32 s67, s67, 5120
    s_add_u32 s66, s66, s67
    s_add_u32 s66, s66, 61440
    v_cndmask_b32 v5, v6, v5, vcc
    v_add3_u32 v56, v4, v5, s66
    v_add_u32 v57, 51200, v56
    v_mov_b32 v60, 0x3f803f80
    v_mov_b32 v61, 0x3f803f80
    v_mov_b32 v62, 0x3f803f80
    v_mov_b32 v63, 0x3f803f80
    s_lshl_b32 s66, s44, 1
    s_lshr_b32 s67, s45, 4
    s_add_u32 s66, s66, s67
    s_lshl_b32 s66, s66, 3
    s_add_u32 s66, s66, s46
    s_and_b32 s69, s45, 15
    s_mul_i32 s92, s69, 120
    s_add_u32 s92, s92, s66
    s_lshl_b32 s92, s92, 10
    s_add_u32 s92, s92, 0x1600000
    s_cmp_ge_u32 s66, 120
    s_cmov_b32 s92, -1
    s_mul_i32 s67, s66, 171
    s_lshr_b32 s67, s67, 10
    s_mul_i32 s68, s67, 98112
    s_lshl_b32 s66, s66, 5
    s_add_u32 s66, s66, s68
    s_mul_i32 s69, s69, 192
    s_add_u32 s89, s66, s69
    s_lshl_b32 s66, s44, 2
    s_lshr_b32 s67, s45, 3
    s_add_u32 s66, s66, s67
    s_lshl_b32 s66, s66, 3
    s_add_u32 s66, s66, s46
    s_cmp_ge_u32 s66, 120
    s_cselect_b32 s67, 7, 0
    s_add_u32 s67, s67, s49
    s_mul_i32 s94, s67, 120
    s_add_u32 s94, s94, s66
    s_lshl_b32 s94, s94, 10
    s_add_u32 s94, s94, 0x1800000
    s_cmp_ge_u32 s66, 240
    s_cmov_b32 s94, -1
    s_mul_i32 s67, s66, 205
    s_lshr_b32 s67, s67, 10
    s_mul_i32 s68, s67, 5
    s_sub_u32 s66, s66, s68
    s_add_u32 s66, s66, s50
    s_cmp_eq_u32 s66, 5
    s_cselect_b32 s66, 0, s66
    s_lshl_b32 s66, s66, 5
    s_cmp_ge_u32 s67, 24
    s_cselect_b32 s90, 24, 0
    s_sub_u32 s67, s67, s90
    s_sub_u32 s68, s67, 1
    s_and_b32 s69, s68, 1
    s_lshr_b32 s68, s68, 1
    s_cmp_lt_u32 s67, 3
    s_cmov_b32 s68, 0
    s_cmov_b32 s69, s67
    s_cmp_ge_u32 s67, 17
    s_cmov_b32 s68, s67
    s_cmov_b32 s69, 2
    s_add_u32 s68, s68, s49
    s_and_b32 s68, s68, 7
    s_mul_i32 s68, s68, 3
    s_add_u32 s67, s68, s69
    s_add_u32 s67, s67, s90
    s_mul_i32 s67, s67, 40960
    s_add_u32 s66, s66, s67
    s_mul_i32 s68, s49, 160
    s_add_u32 s90, s66, s68
    s_lshl_b32 s66, s44, 2
    s_lshr_b32 s67, s45, 3
    s_add_u32 s66, s66, s67
    s_lshl_b32 s66, s66, 3
    s_add_u32 s66, s66, s46
    s_mul_i32 s95, s49, 100
    s_add_u32 s95, s95, s66
    s_lshl_b32 s95, s95, 10
    s_add_u32 s95, s95, 0x1a00000
    s_cmp_ge_u32 s66, 100
    s_cmov_b32 s95, -1
    s_mul_i32 s67, s66, 205
    s_lshr_b32 s67, s67, 10
    s_mul_i32 s68, s67, 5
    s_sub_u32 s66, s66, s68
    s_add_u32 s66, s66, s50
    s_cmp_eq_u32 s66, 5
    s_cselect_b32 s66, 0, s66
    s_lshl_b32 s66, s66, 5
    s_mul_i32 s67, s67, 40960
    s_add_u32 s66, s66, s67
    s_mul_i32 s68, s49, 160
    s_add_u32 s91, s66, s68
    s_lshl_b32 s72, s44, 2
    s_cmp_eq_u32 s71, 0
    s_cbranch_scc0 L_q0_c2
    v_mov_b32 v4, 1
    v_mov_b32 v5, 0
    s_waitcnt vmcnt(5)
    s_mov_b64 exec, 1
    buffer_store_dword v4, v5, s[40:43], s72 offen sc1
    s_mov_b64 exec, -1
    s_waitcnt vmcnt(1)
    s_branch L_q0_c3
L_q0_c2:
    s_waitcnt vmcnt(0)
L_q0_c3:
    buffer_store_dwordx4 v[124:127], v1, s[4:7], s59 offen sc1
    buffer_store_dwordx4 v[128:131], v1, s[4:7], s59 offen offset:1024 sc1
    buffer_store_dwordx2 v[132:133], v1, s[4:7], s60 offen sc1
    v_mov_b32 v138, 0x3f803f80
    v_dot2_f32_bf16 v135, v124, v124, 0
    v_dot2_f32_bf16 v134, v124, v138, 0
    v_dot2_f32_bf16 v137, v125, v125, 0
    v_dot2_f32_bf16 v136, v125, v138, 0
    v_dot2_f32_bf16 v135, v126, v126, v135
    v_dot2_f32_bf16 v134, v126, v138, v134
    v_dot2_f32_bf16 v137, v127, v127, v137
    v_dot2_f32_bf16 v136, v127, v138, v136
    v_dot2_f32_bf16 v135, v128, v128, v135
    v_dot2_f32_bf16 v134, v128, v138, v134
    v_dot2_f32_bf16 v137, v129, v129, v137
    v_dot2_f32_bf16 v136, v129, v138, v136
    v_dot2_f32_bf16 v135, v130, v130, v135
    v_dot2_f32_bf16 v134, v130, v138, v134
    v_dot2_f32_bf16 v137, v131, v131, v137
    v_dot2_f32_bf16 v136, v131, v138, v136
    v_dot2_f32_bf16 v135, v132, v132, v135
    v_dot2_f32_bf16 v134, v132, v138, v134
    v_dot2_f32_bf16 v137, v133, v133, v137
    v_dot2_f32_bf16 v136, v133, v138, v136
    v_lshlrev_b32 v4, 2, v3
    v_lshl_add_u32 v4, v2, 4, v4
    s_nop 0
    v_pk_add_f32 v[134:135], v[134:135], v[136:137]
    s_nop 1
    v_permlane16_swap_b32 v134, v135
    s_nop 0
    v_add_f32 v134, v134, v135
    v_mov_b32 v135, v134
    s_nop 1
    v_permlane32_swap_b32 v134, v135
    s_nop 0
    v_add_f32 v134, v134, v135
    s_mov_b32 exec_hi, 0
    buffer_store_dword v134, v4, s[4:7], s61 offen sc1
    s_mov_b64 exec, -1
    v_lshlrev_b32 v8, 16, v124
    v_and_b32 v9, 0xffff0000, v124
    v_lshlrev_b32 v10, 16, v125
    v_and_b32 v11, 0xffff0000, v125
    v_lshlrev_b32 v12, 16, v126
    v_and_b32 v13, 0xffff0000, v126
    v_lshlrev_b32 v14, 16, v127
    v_and_b32 v15, 0xffff0000, v127
    v_lshlrev_b32 v16, 16, v128
    v_and_b32 v17, 0xffff0000, v128
    v_lshlrev_b32 v18, 16, v129
    v_and_b32 v19, 0xffff0000, v129
    v_lshlrev_b32 v20, 16, v130
    v_and_b32 v21, 0xffff0000, v130
    v_lshlrev_b32 v22, 16, v131
    v_and_b32 v23, 0xffff0000, v131
    v_lshlrev_b32 v24, 16, v132
    v_and_b32 v25, 0xffff0000, v132
    v_lshlrev_b32 v26, 16, v133
    v_and_b32 v27, 0xffff0000, v133
    v_and_b32 v6, 7, v0
    v_lshlrev_b32 v6, 2, v6
    s_waitcnt vmcnt(0)
    s_buffer_load_dwordx8 s[72:79], s[40:43], 0
    s_waitcnt lgkmcnt(0)
    s_and_b64 s[72:73], s[72:73], s[74:75]
    s_and_b64 s[72:73], s[72:73], s[76:77]
    s_and_b64 s[72:73], s[72:73], s[78:79]
    s_and_b32 s72, s72, s73
    s_cbranch_scc1 L_q0_boot
    buffer_load_dword v7, v6, s[40:43], 0 offen sc1
    s_waitcnt vmcnt(0)
    v_cmp_gt_u32 vcc, 1, v7
    s_cbranch_vccnz L1_poll
L2_seen:
L_q0_boot:
    v_mov_b32 v4, 2
    v_mov_b32 v5, 0
    s_waitcnt vmcnt(0)
    s_mov_b64 exec, 1
    buffer_store_dword v4, v5, s[4:7], s62 offen sc1
    s_mov_b64 exec, -1
    v_lshlrev_b32 v4, 7, v2
    v_and_b32 v5, 0x380, v4
    buffer_load_dword v108, v4, s[4:7], s59 offen sc1
    buffer_load_dword v109, v5, s[4:7], s60 offen sc1
    s_getreg_b32 s66, hwreg(HW_REG_XCC_ID)
    s_and_b32 s66, s66, 15
    s_add_u32 s66, s66, 16
    v_mov_b32 v5, s66
    v_mov_b32 v6, 0
    s_lshl_b32 s66, s45, 2
    s_add_u32 s66, s66, s80
    s_cmp_eq_u32 s46, 0
    s_cbranch_scc0 L_q0_c4
    s_mov_b64 exec, 1
    buffer_store_dword v5, v6, s[4:7], s66 offen offset:3200 sc1
    s_mov_b64 exec, -1
L_q0_c4:
    s_barrier
    ds_read_b64_tr_b16 v[212:213], v56 offset:0
    ds_read_b64_tr_b16 v[214:215], v56 offset:2560
    ds_read_b64_tr_b16 v[216:217], v56 offset:10240
    ds_read_b64_tr_b16 v[218:219], v56 offset:12800
    ds_read_b64_tr_b16 v[220:221], v56 offset:20480
    ds_read_b64_tr_b16 v[222:223], v56 offset:23040
    ds_read_b64_tr_b16 v[224:225], v56 offset:30720
    ds_read_b64_tr_b16 v[226:227], v56 offset:33280
    s_waitcnt lgkmcnt(0)
    v_mfma_f32_16x16x32_bf16 v[28:31], v[60:63], v[212:215], 0
    v_mfma_f32_16x16x32_bf16 v[28:31], v[60:63], v[216:219], v[28:31]
    v_mfma_f32_16x16x32_bf16 v[28:31], v[60:63], v[220:223], v[28:31]
    v_mfma_f32_16x16x32_bf16 v[28:31], v[60:63], v[224:227], v[28:31]
    s_lshl_b32 s66, s46, 10
    v_add_u32 v4, s66, v1
    v_add_u32 v5, 40960, v4
    ds_write_b128 v4, v[212:215] offset:0
    ds_write_b128 v4, v[216:219] offset:8192
    ds_write_b128 v4, v[220:223] offset:16384
    ds_write_b128 v4, v[224:227] offset:24576
    s_setprio 2
    s_branch L_q0_conv
L_q0_load:
    v_add_u32 v4, 0, v0
    v_mul_u32_u24 v5, 205, v4
    v_lshrrev_b32 v5, 11, v5
    v_mul_u32_u24 v6, 10, v5
    v_sub_u32 v4, v4, v6
    v_mul_u32_u24 v5, 3840, v5
    v_min_u32 v4, 8, v4
    v_mul_u32_u24 v6, 11, v4
    v_lshrrev_b32 v6, 5, v6
    v_min_u32 v6, 2, v6
    v_mul_u32_u24 v6, 1232, v6
    v_add_u32 v5, v5, v6
    v_lshl_add_u32 v124, v4, 4, v5
    v_add_u32 v4, 64, v0
    v_mul_u32_u24 v5, 205, v4
    v_lshrrev_b32 v5, 11, v5
    v_mul_u32_u24 v6, 10, v5
    v_sub_u32 v4, v4, v6
    v_mul_u32_u24 v5, 3840, v5
    v_min_u32 v4, 8, v4
    v_mul_u32_u24 v6, 11, v4
    v_lshrrev_b32 v6, 5, v6
    v_min_u32 v6, 2, v6
    v_mul_u32_u24 v6, 1232, v6
    v_add_u32 v5, v5, v6
    v_lshl_add_u32 v125, v4, 4, v5
    v_add_u32 v4, 128, v0
    v_mul_u32_u24 v5, 205, v4
    v_lshrrev_b32 v5, 11, v5
    v_mul_u32_u24 v6, 10, v5
    v_sub_u32 v4, v4, v6
    v_mul_u32_u24 v5, 3840, v5
    v_min_u32 v4, 8, v4
    v_mul_u32_u24 v6, 11, v4
    v_lshrrev_b32 v6, 5, v6
    v_min_u32 v6, 2, v6
    v_mul_u32_u24 v6, 1232, v6
    v_add_u32 v5, v5, v6
    v_lshl_add_u32 v126, v4, 4, v5
    v_add_u32 v4, 192, v0
    v_mul_u32_u24 v5, 205, v4
    v_lshrrev_b32 v5, 11, v5
    v_mul_u32_u24 v6, 10, v5
    v_sub_u32 v4, v4, v6
    v_mul_u32_u24 v5, 3840, v5
    v_min_u32 v4, 8, v4
    v_mul_u32_u24 v6, 11, v4
    v_lshrrev_b32 v6, 5, v6
    v_min_u32 v6, 2, v6
    v_mul_u32_u24 v6, 1232, v6
    v_add_u32 v5, v5, v6
    v_lshl_add_u32 v127, v4, 4, v5
    v_add_u32 v4, 256, v0
    v_mul_u32_u24 v5, 205, v4
    v_lshrrev_b32 v5, 11, v5
    v_mul_u32_u24 v6, 10, v5
    v_sub_u32 v4, v4, v6
    v_mul_u32_u24 v5, 3840, v5
    v_min_u32 v4, 8, v4
    v_mul_u32_u24 v6, 11, v4
    v_lshrrev_b32 v6, 5, v6
    v_min_u32 v6, 2, v6
    v_mul_u32_u24 v6, 1232, v6
    v_add_u32 v5, v5, v6
    v_lshl_add_u32 v128, v4, 4, v5
    s_mul_i32 s83, s53, 122880
    s_mul_i32 s66, s45, 40
    s_and_b32 s66, s66, -16
    s_add_u32 s83, s83, s66
    s_mul_i32 s74, s53, 5120
    s_waitcnt lgkmcnt(0)
    s_add_u32 m0, s74, 61440
    s_nop 0
    buffer_load_dwordx4 v124, s[8:11], s83 offen lds
    s_waitcnt vmcnt(10)
    s_add_u32 m0, s74, 62464
    s_nop 0
    buffer_load_dwordx4 v125, s[8:11], s83 offen lds
    s_waitcnt vmcnt(10)
    s_add_u32 m0, s74, 63488
    s_nop 0
    buffer_load_dwordx4 v126, s[8:11], s83 offen lds
    s_waitcnt vmcnt(10)
    s_add_u32 m0, s74, 64512
    s_nop 0
    buffer_load_dwordx4 v127, s[8:11], s83 offen lds
    s_waitcnt vmcnt(10)
    s_add_u32 m0, s74, 65536
    s_nop 0
    buffer_load_dwordx4 v128, s[8:11], s83 offen lds
    s_waitcnt vmcnt(10)
    s_add_u32 s83, s83, 491520
    s_add_u32 m0, s74, 81920
    s_nop 0
    buffer_load_dwordx4 v124, s[8:11], s83 offen lds
    s_waitcnt vmcnt(10)
    s_add_u32 m0, s74, 82944
    s_nop 0
    buffer_load_dwordx4 v125, s[8:11], s83 offen lds
    s_waitcnt vmcnt(10)
    s_add_u32 m0, s74, 83968
    s_nop 0
    buffer_load_dwordx4 v126, s[8:11], s83 offen lds
    s_waitcnt vmcnt(10)
    s_add_u32 m0, s74, 84992
    s_nop 0
    buffer_load_dwordx4 v127, s[8:11], s83 offen lds
    s_waitcnt vmcnt(10)
    s_add_u32 m0, s74, 86016
    s_nop 0
    buffer_load_dwordx4 v128, s[8:11], s83 offen lds
    s_waitcnt vmcnt(10)
    s_add_u32 s83, s83, 491520
    s_add_u32 m0, s74, 102400
    s_nop 0
    buffer_load_dwordx4 v124, s[8:11], s83 offen lds
    s_waitcnt vmcnt(10)
    s_add_u32 m0, s74, 103424
    s_nop 0
    buffer_load_dwordx4 v125, s[8:11], s83 offen lds
    s_waitcnt vmcnt(10)
    s_add_u32 m0, s74, 104448
    s_nop 0
    buffer_load_dwordx4 v126, s[8:11], s83 offen lds
    s_waitcnt vmcnt(10)
    s_add_u32 m0, s74, 105472
    s_nop 0
    buffer_load_dwordx4 v127, s[8:11], s83 offen lds
    s_waitcnt vmcnt(10)
    s_add_u32 m0, s74, 106496
    s_nop 0
    buffer_load_dwordx4 v128, s[8:11], s83 offen lds
    s_waitcnt vmcnt(10)
    s_add_u32 s83, s83, 491520
    v_lshrrev_b32 v4, 2, v0
    v_mul_u32_u24 v4, 160, v4
    v_lshl_add_u32 v4, s50, 3, v4
    v_and_b32 v5, 3, v0
    v_lshlrev_b32 v6, 3, v5
    v_min_u32 v5, 2, v5
    v_mul_u32_u24 v5, 48, v5
    s_mul_i32 s66, s53, 48
    s_cmp_eq_u32 s53, 3
    s_cselect_b64 vcc, -1, 0
    s_cselect_b32 s66, 32, s66
    s_lshr_b32 s67, s46, 2
    s_mul_i32 s67, s67, 5120
    s_add_u32 s66, s66, s67
    s_add_u32 s66, s66, 61440
    v_cndmask_b32 v5, v6, v5, vcc
    v_add3_u32 v56, v4, v5, s66
    v_add_u32 v57, 51200, v56
    v_mov_b32 v60, 0x3f803f80
    v_mov_b32 v61, 0x3f803f80
    v_mov_b32 v62, 0x3f803f80
    v_mov_b32 v63, 0x3f803f80
    s_mul_i32 s66, s46, 1280
    s_add_u32 s66, s66, 122880
    s_mul_i32 s67, s46, 2560
    s_add_u32 s67, s67, 143360
    v_cmp_eq_u32 vcc, 0, v3
    v_lshlrev_b32 v4, 3, v2
    v_lshl_add_u32 v5, v3, 8, v4
    v_add_u32 v64, s66, v5
    v_add_u32 v65, s67, v5
    v_add_u32 v5, s66, v4
    v_add_u32 v6, s67, v4
    v_cndmask_b32 v66, v6, v5, vcc
    v_lshrrev_b32 v5, 1, v3
    v_mul_u32_u24 v5, 320, v5
    v_lshl_add_u32 v5, v2, 4, v5
    v_and_b32 v6, 1, v3
    v_lshl_add_u32 v5, v6, 3, v5
    v_add_u32 v67, s67, v5
    v_lshrrev_b32 v5, 3, v2
    v_mul_u32_u24 v5, 320, v5
    v_and_b32 v6, 7, v2
    v_lshl_add_u32 v5, v6, 1, v5
    v_add_u32 v68, s67, v5
    v_add_u32 v69, s67, v1
    s_mul_i32 s85, s45, 163840
    s_mul_i32 s66, s3, 0x500000
    s_add_u32 s85, s85, s66
    s_mul_i32 s66, s53, 2560
    s_add_u32 s85, s85, s66
    s_add_u32 s85, s85, 0xb00000
    s_lshl_b32 s66, s44, 1
    s_lshr_b32 s67, s46, 2
    s_add_u32 s66, s66, s67
    s_mul_i32 s87, s66, 10240
    s_add_u32 s87, s87, s85
    v_and_b32 v40, 31, v0
    v_lshrrev_b32 v41, 5, v0
    s_lshl_b32 s70, s53, 1
    s_lshr_b32 s66, s46, 2
    s_add_u32 s70, s70, s66
    s_mul_i32 s66, s66, 10240
    s_add_u32 s66, s66, 143360
    v_lshl_add_u32 v44, v40, 3, s66
    v_lshl_add_u32 v43, v41, 8, v44
    v_add_u32 v44, 1024, v44
    v_mul_u32_u24 v4, 20, v41
    v_add_u32 v4, v4, v40
    v_lshl_add_u32 v45, v4, 4, s66
    s_mul_i32 s67, s70, 1280
    s_add_u32 s67, s67, 122880
    s_xor_b32 s66, s70, 1
    s_mul_i32 s66, s66, 1280
    s_add_u32 s66, s66, 122880
    v_lshlrev_b32 v4, 3, v40
    v_lshl_add_u32 v5, v41, 8, v4
    v_add_u32 v94, s66, v5
    v_add_u32 v95, s67, v5
    s_sub_u32 s67, s67, s66
    v_mul_lo_u32 v5, v41, s67
    v_add3_u32 v96, v4, v5, s66
    v_cmp_eq_u32 vcc, 20, v40
    v_mov_b32 v4, 0x3f803f80
    v_mov_b32 v42, 0xdddddddd
    v_cndmask_b32 v72, 0, v4, vcc
    v_cndmask_b32 v73, 0, v4, vcc
    v_mov_b64 v[74:75], v[72:73]
    v_mov_b64 v[76:77], v[72:73]
    v_mov_b64 v[78:79], v[72:73]
    v_mov_b64 v[80:81], v[72:73]
    v_mov_b64 v[82:83], v[72:73]
    v_mov_b64 v[84:85], v[72:73]
    v_mov_b64 v[86:87], v[72:73]
    s_mul_i32 s66, s45, 5
    v_lshrrev_b32 v4, 4, v40
    v_mul_u32_u24 v4, 50176, v4
    v_lshl_add_u32 v4, v2, 4, v4
    v_add_u32 v5, s66, v41
    v_lshrrev_b32 v6, 3, v5
    v_lshl_add_u32 v46, v6, 10, v4
    v_and_b32 v6, 3, v5
    v_lshl_add_u32 v46, v6, 8, v46
    v_bfe_u32 v6, v5, 2, 1
    v_lshl_add_u32 v46, v6, 3, v46
    s_add_u32 s66, s66, 2
    v_add_u32 v5, s66, v41
    v_lshrrev_b32 v6, 3, v5
    v_lshl_add_u32 v47, v6, 10, v4
    v_and_b32 v6, 3, v5
    v_lshl_add_u32 v47, v6, 8, v47
    v_bfe_u32 v6, v5, 2, 1
    v_lshl_add_u32 v47, v6, 3, v47
    s_add_u32 s66, s66, 2
    v_add_u32 v5, s66, v41
    v_lshrrev_b32 v6, 3, v5
    v_lshl_add_u32 v48, v6, 10, v4
    v_and_b32 v6, 3, v5
    v_lshl_add_u32 v48, v6, 8, v48
    v_bfe_u32 v6, v5, 2, 1
    v_lshl_add_u32 v48, v6, 3, v48
    s_add_u32 s66, s66, 2
    s_mov_b32 s86, 0
    s_mul_i32 s76, s46, 2560
    s_and_b32 s66, s45, 7
    s_lshl_b32 s66, s66, 13
    s_lshr_b32 s67, s45, 3
    s_lshl_b32 s67, s67, 8
    s_add_u32 s66, s66, s67
    s_add_u32 s66, s66, 0x1521000
    s_lshl_b32 s67, s53, 5
    s_add_u32 s71, s66, s67
    s_lshl_b32 s67, s46, 3
    s_add_u32 s67, s67, s44
    s_lshl_b32 s67, s67, 2
    s_add_u32 s88, s67, s66
    s_add_u32 s72, s3, 1
    v_and_b32 v49, 7, v0
    v_lshlrev_b32 v49, 2, v49
    s_lshl_b32 s66, s44, 1
    s_lshr_b32 s67, s45, 4
    s_add_u32 s66, s66, s67
    s_lshl_b32 s66, s66, 3
    s_add_u32 s66, s66, s46
    s_and_b32 s69, s45, 15
    s_mul_i32 s92, s69, 120
    s_add_u32 s92, s92, s66
    s_lshl_b32 s92, s92, 10
    s_add_u32 s92, s92, 0x1600000
    s_cmp_ge_u32 s66, 120
    s_cmov_b32 s92, -1
    s_mul_i32 s67, s66, 171
    s_lshr_b32 s67, s67, 10
    s_mul_i32 s68, s67, 98112
    s_lshl_b32 s66, s66, 5
    s_add_u32 s66, s66, s68
    s_mul_i32 s69, s69, 192
    s_add_u32 s89, s66, s69
    s_lshl_b32 s66, s44, 2
    s_lshr_b32 s67, s45, 3
    s_add_u32 s66, s66, s67
    s_lshl_b32 s66, s66, 3
    s_add_u32 s66, s66, s46
    s_cmp_ge_u32 s66, 120
    s_cselect_b32 s67, 7, 0
    s_add_u32 s67, s67, s49
    s_mul_i32 s94, s67, 120
    s_add_u32 s94, s94, s66
    s_lshl_b32 s94, s94, 10
    s_add_u32 s94, s94, 0x1800000
    s_cmp_ge_u32 s66, 240
    s_cmov_b32 s94, -1
    s_mul_i32 s67, s66, 205
    s_lshr_b32 s67, s67, 10
    s_mul_i32 s68, s67, 5
    s_sub_u32 s66, s66, s68
    s_add_u32 s66, s66, s50
    s_cmp_eq_u32 s66, 5
    s_cselect_b32 s66, 0, s66
    s_lshl_b32 s66, s66, 5
    s_cmp_ge_u32 s67, 24
    s_cselect_b32 s90, 24, 0
    s_sub_u32 s67, s67, s90
    s_sub_u32 s68, s67, 1
    s_and_b32 s69, s68, 1
    s_lshr_b32 s68, s68, 1
    s_cmp_lt_u32 s67, 3
    s_cmov_b32 s68, 0
    s_cmov_b32 s69, s67
    s_cmp_ge_u32 s67, 17
    s_cmov_b32 s68, s67
    s_cmov_b32 s69, 2
    s_add_u32 s68, s68, s49
    s_and_b32 s68, s68, 7
    s_mul_i32 s68, s68, 3
    s_add_u32 s67, s68, s69
    s_add_u32 s67, s67, s90
    s_mul_i32 s67, s67, 40960
    s_add_u32 s66, s66, s67
    s_mul_i32 s68, s49, 160
    s_add_u32 s90, s66, s68
    s_lshl_b32 s66, s44, 2
    s_lshr_b32 s67, s45, 3
    s_add_u32 s66, s66, s67
    s_lshl_b32 s66, s66, 3
    s_add_u32 s66, s66, s46
    s_mul_i32 s95, s49, 100
    s_add_u32 s95, s95, s66
    s_lshl_b32 s95, s95, 10
    s_add_u32 s95, s95, 0x1a00000
    s_cmp_ge_u32 s66, 100
    s_cmov_b32 s95, -1
    s_mul_i32 s67, s66, 205
    s_lshr_b32 s67, s67, 10
    s_mul_i32 s68, s67, 5
    s_sub_u32 s66, s66, s68
    s_add_u32 s66, s66, s50
    s_cmp_eq_u32 s66, 5
    s_cselect_b32 s66, 0, s66
    s_lshl_b32 s66, s66, 5
    s_mul_i32 s67, s67, 40960
    s_add_u32 s66, s66, s67
    s_mul_i32 s68, s49, 160
    s_add_u32 s91, s66, s68
    s_waitcnt vmcnt(5)
    s_barrier
    s_add_u32 m0, s74, 122880
    s_nop 0
    buffer_load_dwordx4 v124, s[8:11], s83 offen lds
    s_waitcnt vmcnt(10)
    s_add_u32 m0, s74, 123904
    s_nop 0
    buffer_load_dwordx4 v125, s[8:11], s83 offen lds
    s_waitcnt vmcnt(10)
    s_add_u32 m0, s74, 124928
    s_nop 0
    buffer_load_dwordx4 v126, s[8:11], s83 offen lds
    s_waitcnt vmcnt(10)
    s_add_u32 m0, s74, 125952
    s_nop 0
    buffer_load_dwordx4 v127, s[8:11], s83 offen lds
    s_waitcnt vmcnt(10)
    s_add_u32 m0, s74, 126976
    s_nop 0
    buffer_load_dwordx4 v128, s[8:11], s83 offen lds
    s_waitcnt vmcnt(10)
    s_add_u32 s83, s83, 491520
    ds_read_b64_tr_b16 v[212:213], v56 offset:0
    ds_read_b64_tr_b16 v[214:215], v56 offset:2560
    ds_read_b64_tr_b16 v[216:217], v56 offset:10240
    ds_read_b64_tr_b16 v[218:219], v56 offset:12800
    ds_read_b64_tr_b16 v[220:221], v56 offset:20480
    ds_read_b64_tr_b16 v[222:223], v56 offset:23040
    ds_read_b64_tr_b16 v[224:225], v56 offset:30720
    ds_read_b64_tr_b16 v[226:227], v56 offset:33280
    s_waitcnt lgkmcnt(0)
    v_mfma_f32_16x16x32_bf16 v[28:31], v[60:63], v[212:215], 0
    v_mfma_f32_16x16x32_bf16 v[28:31], v[60:63], v[216:219], v[28:31]
    v_mfma_f32_16x16x32_bf16 v[28:31], v[60:63], v[220:223], v[28:31]
    v_mfma_f32_16x16x32_bf16 v[28:31], v[60:63], v[224:227], v[28:31]
    s_lshl_b32 s66, s46, 10
    v_add_u32 v4, s66, v1
    v_add_u32 v5, 40960, v4
    ds_write_b128 v4, v[212:215] offset:0
    ds_write_b128 v4, v[216:219] offset:8192
    ds_write_b128 v4, v[220:223] offset:16384
    ds_write_b128 v4, v[224:227] offset:24576
    s_add_u32 m0, s74, 143360
    s_nop 0
    buffer_load_dwordx4 v124, s[8:11], s83 offen lds
    s_waitcnt vmcnt(10)
    s_add_u32 m0, s74, 144384
    s_nop 0
    buffer_load_dwordx4 v125, s[8:11], s83 offen lds
    s_waitcnt vmcnt(10)
    s_add_u32 m0, s74, 145408
    s_nop 0
    buffer_load_dwordx4 v126, s[8:11], s83 offen lds
    s_waitcnt vmcnt(10)
    s_add_u32 m0, s74, 146432
    s_nop 0
    buffer_load_dwordx4 v127, s[8:11], s83 offen lds
    s_waitcnt vmcnt(10)
    s_add_u32 m0, s74, 147456
    s_nop 0
    buffer_load_dwordx4 v128, s[8:11], s83 offen lds
    s_waitcnt vmcnt(10)
    s_add_u32 s83, s83, 491520
    s_waitcnt vmcnt(5)
L_q0_conv:
    s_barrier
    ds_read_b64_tr_b16 v[228:229], v56 offset:40960
    ds_read_b64_tr_b16 v[230:231], v56 offset:43520
    ds_read_b64_tr_b16 v[232:233], v57 offset:0
    ds_read_b64_tr_b16 v[234:235], v57 offset:2560
    ds_read_b64_tr_b16 v[236:237], v57 offset:10240
    ds_read_b64_tr_b16 v[238:239], v57 offset:12800
    ds_read_b64_tr_b16 v[240:241], v57 offset:20480
    ds_read_b64_tr_b16 v[242:243], v57 offset:23040
    s_waitcnt lgkmcnt(0)
    v_mfma_f32_16x16x32_bf16 v[28:31], v[60:63], v[228:231], v[28:31]
    v_mfma_f32_16x16x32_bf16 v[28:31], v[60:63], v[232:235], v[28:31]
    v_mfma_f32_16x16x32_bf16 v[28:31], v[60:63], v[236:239], v[28:31]
    v_mfma_f32_16x16x32_bf16 v[28:31], v[60:63], v[240:243], v[28:31]
    s_lshl_b32 s66, s46, 10
    v_add_u32 v4, s66, v1
    v_add_u32 v5, 40960, v4
    ds_write_b128 v4, v[228:231] offset:32768
    ds_write_b128 v5, v[232:235] offset:0
    ds_write_b128 v5, v[236:239] offset:8192
    ds_write_b128 v5, v[240:243] offset:16384
    v_add_u32 v52, 65536, v1
    s_lshl_b32 s66, s44, 3
    s_add_u32 s66, s66, s46
    s_mul_i32 s81, s66, 43008
    s_add_u32 s84, s81, 20480
    s_add_u32 s82, s81, 21504
    s_lshl_b32 s68, s46, 8
    s_add_u32 s68, s68, s80
    v_lshlrev_b32 v6, 2, v2
    s_lshl_b32 s75, s3, 2
    s_add_u32 s75, s75, 2
    s_mov_b32 s74, s68
    s_lshr_b32 s69, s46, 2
    s_add_u32 s69, s69, s75
    s_sub_u32 s69, s69, 1
    s_branch L_q1_a
L_qkv1:
    s_mul_i32 s66, s46, 1280
    s_add_u32 s66, s66, 122880
    s_mul_i32 s67, s46, 2560
    s_add_u32 s67, s67, 143360
    v_cmp_eq_u32 vcc, 0, v3
    v_lshlrev_b32 v4, 3, v2
    v_lshl_add_u32 v5, v3, 8, v4
    v_add_u32 v64, s66, v5
    v_add_u32 v65, s67, v5
    v_add_u32 v5, s66, v4
    v_add_u32 v6, s67, v4
    v_cndmask_b32 v66, v6, v5, vcc
    v_lshrrev_b32 v5, 1, v3
    v_mul_u32_u24 v5, 320, v5
    v_lshl_add_u32 v5, v2, 4, v5
    v_and_b32 v6, 1, v3
    v_lshl_add_u32 v5, v6, 3, v5
    v_add_u32 v67, s67, v5
    v_lshrrev_b32 v5, 3, v2
    v_mul_u32_u24 v5, 320, v5
    v_and_b32 v6, 7, v2
    v_lshl_add_u32 v5, v6, 1, v5
    v_add_u32 v68, s67, v5
    v_add_u32 v69, s67, v1
    s_mul_i32 s85, s45, 163840
    s_mul_i32 s66, s3, 0x500000
    s_add_u32 s85, s85, s66
    s_mul_i32 s66, s53, 2560
    s_add_u32 s85, s85, s66
    s_add_u32 s85, s85, 0xb00000
    s_lshl_b32 s66, s44, 1
    s_lshr_b32 s67, s46, 2
    s_add_u32 s66, s66, s67
    s_mul_i32 s87, s66, 10240
    s_add_u32 s87, s87, s85
    v_and_b32 v40, 31, v0
    v_lshrrev_b32 v41, 5, v0
    s_lshl_b32 s70, s53, 1
    s_lshr_b32 s66, s46, 2
    s_add_u32 s70, s70, s66
    s_mul_i32 s66, s66, 10240
    s_add_u32 s66, s66, 143360
    v_lshl_add_u32 v44, v40, 3, s66
    v_lshl_add_u32 v43, v41, 8, v44
    v_add_u32 v44, 1024, v44
    v_mul_u32_u24 v4, 20, v41
    v_add_u32 v4, v4, v40
    v_lshl_add_u32 v45, v4, 4, s66
    s_mul_i32 s67, s70, 1280
    s_add_u32 s67, s67, 122880
    s_xor_b32 s66, s70, 1
    s_mul_i32 s66, s66, 1280
    s_add_u32 s66, s66, 122880
    v_lshlrev_b32 v4, 3, v40
    v_lshl_add_u32 v5, v41, 8, v4
    v_add_u32 v94, s66, v5
    v_add_u32 v95, s67, v5
    s_sub_u32 s67, s67, s66
    v_mul_lo_u32 v5, v41, s67
    v_add3_u32 v96, v4, v5, s66
    v_cmp_eq_u32 vcc, 20, v40
    v_mov_b32 v4, 0x3f803f80
    v_mov_b32 v42, 0xdddddddd
    v_cndmask_b32 v72, 0, v4, vcc
    v_cndmask_b32 v73, 0, v4, vcc
    v_mov_b64 v[74:75], v[72:73]
    v_mov_b64 v[76:77], v[72:73]
    v_mov_b64 v[78:79], v[72:73]
    v_mov_b64 v[80:81], v[72:73]
    v_mov_b64 v[82:83], v[72:73]
    v_mov_b64 v[84:85], v[72:73]
    v_mov_b64 v[86:87], v[72:73]
    s_mul_i32 s66, s45, 5
    v_lshrrev_b32 v4, 4, v40
    v_mul_u32_u24 v4, 50176, v4
    v_lshl_add_u32 v4, v2, 4, v4
    v_add_u32 v5, s66, v41
    v_lshrrev_b32 v6, 3, v5
    v_lshl_add_u32 v46, v6, 10, v4
    v_and_b32 v6, 3, v5
    v_lshl_add_u32 v46, v6, 8, v46
    v_bfe_u32 v6, v5, 2, 1
    v_lshl_add_u32 v46, v6, 3, v46
    s_add_u32 s66, s66, 2
    v_add_u32 v5, s66, v41
    v_lshrrev_b32 v6, 3, v5
    v_lshl_add_u32 v47, v6, 10, v4
    v_and_b32 v6, 3, v5
    v_lshl_add_u32 v47, v6, 8, v47
    v_bfe_u32 v6, v5, 2, 1
    v_lshl_add_u32 v47, v6, 3, v47
    s_add_u32 s66, s66, 2
    v_add_u32 v5, s66, v41
    v_lshrrev_b32 v6, 3, v5
    v_lshl_add_u32 v48, v6, 10, v4
    v_and_b32 v6, 3, v5
    v_lshl_add_u32 v48, v6, 8, v48
    v_bfe_u32 v6, v5, 2, 1
    v_lshl_add_u32 v48, v6, 3, v48
    s_add_u32 s66, s66, 2
    s_mov_b32 s86, 0
    s_mul_i32 s76, s46, 2560
    s_and_b32 s66, s45, 7
    s_lshl_b32 s66, s66, 13
    s_lshr_b32 s67, s45, 3
    s_lshl_b32 s67, s67, 8
    s_add_u32 s66, s66, s67
    s_add_u32 s66, s66, 0x1521000
    s_lshl_b32 s67, s53, 5
    s_add_u32 s71, s66, s67
    s_lshl_b32 s67, s46, 3
    s_add_u32 s67, s67, s44
    s_lshl_b32 s67, s67, 2
    s_add_u32 s88, s67, s66
    s_add_u32 s72, s3, 1
    v_and_b32 v49, 7, v0
    v_lshlrev_b32 v49, 2, v49
    v_add_u32 v52, 65536, v1
    s_lshl_b32 s66, s44, 3
    s_add_u32 s66, s66, s46
    s_mul_i32 s81, s66, 43008
    s_add_u32 s84, s81, 20480
    s_add_u32 s82, s81, 21504
    s_lshl_b32 s68, s46, 8
    s_add_u32 s68, s68, s80
    v_lshlrev_b32 v6, 2, v2
    s_lshl_b32 s75, s3, 2
    s_add_u32 s75, s75, 2
    s_mov_b32 s74, s68
    s_lshr_b32 s69, s46, 2
    s_add_u32 s69, s69, s75
    s_sub_u32 s69, s69, 1
L_q1_w:
    s_waitcnt lgkmcnt(0)
    s_barrier
L_q1_a:
    buffer_load_dword v7, v6, s[4:7], s68 offen sc1
    s_waitcnt vmcnt(0)
    v_cmp_gt_u32 vcc, s69, v7
    s_cbranch_vccnz L3_poll
L4_seen:
    s_cmp_ge_u32 s46, 4
    s_cbranch_scc1 L_q1_c
    buffer_load_dwordx4 v[156:159], v1, s[4:7], s81 offen offset:0 sc1
    buffer_load_dwordx4 v[160:163], v1, s[4:7], s82 offen offset:0 sc1
    buffer_load_dwordx4 v[164:167], v1, s[4:7], s81 offen offset:1024 sc1
    buffer_load_dwordx4 v[168:171], v1, s[4:7], s82 offen offset:1024 sc1
    v_mov_b64 v[124:125], 0
    v_mov_b64 v[126:127], 0
    v_mov_b64 v[128:129], 0
    v_mov_b64 v[130:131], 0
    v_mov_b64 v[132:133], 0
    v_mov_b64 v[134:135], 0
    v_mov_b64 v[136:137], 0
    v_mov_b64 v[138:139], 0
    v_mov_b64 v[140:141], 0
    v_mov_b64 v[142:143], 0
    v_mov_b64 v[144:145], 0
    v_mov_b64 v[146:147], 0
    v_mov_b64 v[148:149], 0
    v_mov_b64 v[150:151], 0
    v_mov_b64 v[152:153], 0
    v_mov_b64 v[154:155], 0
    s_mul_i32 s66, s46, 1280
    s_add_u32 s66, s66, 122880
    s_mul_i32 s67, s46, 2560
    s_add_u32 s67, s67, 143360
    v_cmp_eq_u32 vcc, 0, v3
    v_lshlrev_b32 v4, 3, v2
    v_lshl_add_u32 v5, v3, 8, v4
    v_add_u32 v64, s66, v5
    v_add_u32 v65, s67, v5
    v_add_u32 v5, s66, v4
    v_add_u32 v6, s67, v4
    v_cndmask_b32 v66, v6, v5, vcc
    v_lshrrev_b32 v5, 1, v3
    v_mul_u32_u24 v5, 320, v5
    v_lshl_add_u32 v5, v2, 4, v5
    v_and_b32 v6, 1, v3
    v_lshl_add_u32 v5, v6, 3, v5
    v_add_u32 v67, s67, v5
    v_lshrrev_b32 v5, 3, v2
    v_mul_u32_u24 v5, 320, v5
    v_and_b32 v6, 7, v2
    v_lshl_add_u32 v5, v6, 1, v5
    v_add_u32 v68, s67, v5
    v_add_u32 v69, s67, v1
    s_mul_i32 s85, s45, 163840
    s_mul_i32 s66, s3, 0x500000
    s_add_u32 s85, s85, s66
    s_mul_i32 s66, s53, 2560
    s_add_u32 s85, s85, s66
    s_add_u32 s85, s85, 0xb00000
    s_lshl_b32 s66, s44, 1
    s_lshr_b32 s67, s46, 2
    s_add_u32 s66, s66, s67
    s_mul_i32 s87, s66, 10240
    s_add_u32 s87, s87, s85
    s_cmp_lg_u32 s3, 0
    s_cbranch_scc1 L_q1_loop
    s_branch L_q1_d
L_q1_c:
    v_lshrrev_b32 v5, 1, v3
    v_mul_u32_u24 v5, 20480, v5
    v_lshl_add_u32 v5, v3, 9, v5
    v_lshl_add_u32 v5, v2, 4, v5
    buffer_load_dwordx4 v[100:103], v5, s[4:7], s84 offen offset:0 sc1
    buffer_load_dwordx4 v[104:107], v5, s[4:7], s84 offen offset:256 sc1
    s_cmp_lg_u32 s3, 0
    s_cbranch_scc1 L_q1_late
L_q1_d:
    s_barrier
    s_cmp_eq_u32 s46, 3
    s_cbranch_scc0 L_cpb
    s_getpc_b64 s[66:67]
L_pcb:
    s_lshl_b32 s68, s45, 11
    s_cmp_lt_u32 s68, L_last-L_pcb
    s_cbranch_scc0 L_cpb
    v_lshlrev_b32 v4, 7, v2
    v_add_u32 v4, s68, v4
    v_min_u32 v4, L_last-L_pcb, v4
    global_load_dword v99, v4, s[66:67]
L_cpb:
    ds_read_b64_tr_b16 v[244:245], v57 offset:30720
    ds_read_b64_tr_b16 v[246:247], v57 offset:33280
    ds_read_b64_tr_b16 v[248:249], v57 offset:40960
    ds_read_b64_tr_b16 v[250:251], v57 offset:43520
    s_waitcnt lgkmcnt(0)
    v_mfma_f32_16x16x32_bf16 v[28:31], v[60:63], v[244:247], v[28:31]
    v_mfma_f32_16x16x32_bf16 v[28:31], v[60:63], v[248:251], v[28:31]
    s_lshl_b32 s66, s46, 10
    v_add_u32 v4, s66, v1
    v_add_u32 v5, 40960, v4
    ds_write_b128 v5, v[244:247] offset:24576
    ds_write_b128 v5, v[248:251] offset:32768
    s_lshl_b32 s66, s46, 2
    s_add_u32 s66, s66, 81920
    v_lshl_add_u32 v6, v2, 5, s66
    s_mov_b32 s66, 81920
    v_lshl_add_u32 v7, v2, 5, s66
    ds_write_b32 v6, v28
    s_waitcnt lgkmcnt(0)
    s_barrier
    ds_read_b128 v[28:31], v7
    ds_read_b128 v[108:111], v7 offset:16
    s_waitcnt lgkmcnt(0)
    v_add_f32 v28, v28, v108
    v_cvt_pk_bf16_f32 v4, v28, v28
    v_and_b32 v4, 0xffff0000, v4
    v_sub_f32 v4, v28, v4
    v_cvt_pk_bf16_f32 v28, v28, v4
    v_add_f32 v29, v29, v109
    v_cvt_pk_bf16_f32 v4, v29, v29
    v_and_b32 v4, 0xffff0000, v4
    v_sub_f32 v4, v29, v4
    v_cvt_pk_bf16_f32 v29, v29, v4
    v_add_f32 v30, v30, v110
    v_cvt_pk_bf16_f32 v4, v30, v30
    v_and_b32 v4, 0xffff0000, v4
    v_sub_f32 v4, v30, v4
    v_cvt_pk_bf16_f32 v30, v30, v4
    v_add_f32 v31, v31, v111
    v_cvt_pk_bf16_f32 v4, v31, v31
    v_and_b32 v4, 0xffff0000, v4
    v_sub_f32 v4, v31, v4
    v_cvt_pk_bf16_f32 v31, v31, v4
    s_cmp_lt_u32 s46, 4
    s_cbranch_scc1 L_q1_loop
L_q1_late:
    s_waitcnt vmcnt(0)
    v_add_f32 v100, v100, v102
    v_add_f32 v101, v101, v103
    v_add_f32 v100, v100, v104
    v_add_f32 v101, v101, v105
    v_add_f32 v100, v100, v106
    v_add_f32 v101, v101, v107
    v_mov_b32 v192, v100
    v_mov_b32 v193, v101
    s_nop 1
    v_permlane16_swap_b32 v100, v192
    v_permlane16_swap_b32 v101, v193
    v_add_f32 v100, v100, v192
    v_add_f32 v101, v101, v193
    buffer_load_dwordx4 v[156:159], v1, s[4:7], s81 offen offset:0 sc1
    buffer_load_dwordx4 v[160:163], v1, s[4:7], s82 offen offset:0 sc1
    buffer_load_dwordx4 v[164:167], v1, s[4:7], s81 offen offset:1024 sc1
    buffer_load_dwordx4 v[168:171], v1, s[4:7], s82 offen offset:1024 sc1
    v_mul_f32 v100, 0xbacccccd, v100
    v_mul_f32 v101, 0x3acccccd, v101
    v_cmp_eq_u32 vcc, 0, v3
    v_cmp_eq_u32 s[68:69], 2, v3
    v_fma_f32 v101, -v100, v100, v101
    v_max_f32 v101, 0, v101
    v_add_f32 v101, 0x3727c5ac, v101
    v_rsq_f32 v102, v101
    v_cvt_pk_bf16_f32 v104, v100, v100
    v_and_b32 v103, 0xffff0000, v104
    v_sub_f32 v103, v100, v103
    v_mov_b32 v88, v102
    v_mov_b32 v89, v102
    v_cvt_pk_bf16_f32 v105, v103, v103
    s_nop 0
    v_permlane32_swap_b32 v88, v89
    v_cndmask_b32 v184, 0, v104, vcc
    v_cndmask_b32 v185, 0, v105, vcc
    v_mov_b64 v[186:187], 0
    v_cndmask_b32 v188, 0, v104, s[68:69]
    v_cndmask_b32 v189, 0, v105, s[68:69]
    v_mov_b64 v[190:191], 0
    v_lshlrev_b32 v4, 4, v3
    ds_bpermute_b32 v56, v4, v102 offset:0
    ds_bpermute_b32 v57, v4, v102 offset:4
    ds_bpermute_b32 v58, v4, v102 offset:8
    ds_bpermute_b32 v59, v4, v102 offset:12
    ds_bpermute_b32 v60, v4, v102 offset:128
    ds_bpermute_b32 v61, v4, v102 offset:132
    ds_bpermute_b32 v62, v4, v102 offset:136
    ds_bpermute_b32 v63, v4, v102 offset:140
    v_mov_b32 v108, v28
    v_mov_b32 v109, v28
    v_mov_b64 v[110:111], 0
    v_mov_b32 v112, v29
    v_mov_b32 v113, v29
    v_mov_b64 v[114:115], 0
    v_mov_b32 v116, v30
    v_mov_b32 v117, v30
    v_mov_b64 v[118:119], 0
    v_mov_b32 v120, v31
    v_mov_b32 v121, v31
    v_mov_b64 v[122:123], 0
    v_mul_f32 v90, 0x3ea52b5c, v88
    v_mul_f32 v91, 0x3ea52b5c, v89
    v_cndmask_b32 v92, v88, v90, vcc
    v_cndmask_b32 v93, v89, v91, vcc
    v_mfma_f32_16x16x32_bf16 v[128:131], v[112:115], v[184:187], 0
    v_mfma_f32_16x16x32_bf16 v[144:147], v[112:115], v[188:191], 0
    v_mfma_f32_16x16x32_bf16 v[132:135], v[184:187], v[116:119], 0
    v_mfma_f32_16x16x32_bf16 v[148:151], v[188:191], v[116:119], 0
    v_mfma_f32_16x16x32_bf16 v[136:139], v[120:123], v[184:187], 0
    v_mfma_f32_16x16x32_bf16 v[152:155], v[120:123], v[188:191], 0
    v_mfma_f32_16x16x32_bf16 v[124:127], v[108:111], v[184:187], 0
    v_mfma_f32_16x16x32_bf16 v[140:143], v[108:111], v[188:191], 0
    s_waitcnt lgkmcnt(0)
L_q1_loop:
    ds_read_b128 v[108:111], v1 offset:0
    ds_read_b128 v[112:115], v1 offset:1024
    ds_read_b128 v[116:119], v1 offset:2048
    ds_read_b128 v[120:123], v1 offset:3072
    ds_read_b128 v[204:207], v1 offset:4096
    ds_read_b128 v[208:211], v1 offset:5120
    s_waitcnt vmcnt(2) lgkmcnt(4)
    v_mfma_f32_16x16x32_bf16 v[124:127], v[108:111], v[156:159], v[124:127]
    buffer_load_dwordx4 v[172:175], v1, s[4:7], s81 offen offset:2048 sc1
    v_mfma_f32_16x16x32_bf16 v[140:143], v[108:111], v[160:163], v[140:143]
    ds_read_b128 v[108:111], v1 offset:6144
    v_mfma_f32_16x16x32_bf16 v[128:131], v[112:115], v[156:159], v[128:131]
    buffer_load_dwordx4 v[176:179], v1, s[4:7], s82 offen offset:2048 sc1
    v_mfma_f32_16x16x32_bf16 v[144:147], v[112:115], v[160:163], v[144:147]
    ds_read_b128 v[112:115], v1 offset:7168
    s_waitcnt lgkmcnt(4)
    v_mfma_f32_16x16x32_bf16 v[132:135], v[156:159], v[116:119], v[132:135]
    buffer_load_dwordx4 v[180:183], v1, s[4:7], s81 offen offset:3072 sc1
    s_add_u32 s81, s81, 4096
    v_mfma_f32_16x16x32_bf16 v[148:151], v[160:163], v[116:119], v[148:151]
    ds_read_b128 v[116:119], v1 offset:8192
    v_mfma_f32_16x16x32_bf16 v[136:139], v[120:123], v[156:159], v[136:139]
    v_mfma_f32_16x16x32_bf16 v[152:155], v[120:123], v[160:163], v[152:155]
    ds_read_b128 v[120:123], v1 offset:9216
    s_waitcnt vmcnt(3) lgkmcnt(4)
    v_mfma_f32_16x16x32_bf16 v[124:127], v[204:207], v[164:167], v[124:127]
    buffer_load_dwordx4 v[184:187], v1, s[4:7], s82 offen offset:3072 sc1
    s_add_u32 s82, s82, 4096
    v_mfma_f32_16x16x32_bf16 v[140:143], v[204:207], v[168:171], v[140:143]
    ds_read_b128 v[204:207], v1 offset:10240
    v_mfma_f32_16x16x32_bf16 v[128:131], v[208:211], v[164:167], v[128:131]
    buffer_load_dwordx4 v[188:191], v1, s[4:7], s81 offen offset:0 sc1
    v_mfma_f32_16x16x32_bf16 v[144:147], v[208:211], v[168:171], v[144:147]
    ds_read_b128 v[208:211], v1 offset:11264
    s_waitcnt lgkmcnt(4)
    v_mfma_f32_16x16x32_bf16 v[132:135], v[164:167], v[108:111], v[132:135]
    buffer_load_dwordx4 v[192:195], v1, s[4:7], s82 offen offset:0 sc1
    v_mfma_f32_16x16x32_bf16 v[148:151], v[168:171], v[108:111], v[148:151]
    ds_read_b128 v[108:111], v1 offset:12288
    v_mfma_f32_16x16x32_bf16 v[136:139], v[112:115], v[164:167], v[136:139]
    v_mfma_f32_16x16x32_bf16 v[152:155], v[112:115], v[168:171], v[152:155]
    ds_read_b128 v[112:115], v1 offset:13312
    s_waitcnt vmcnt(4) lgkmcnt(4)
    v_mfma_f32_16x16x32_bf16 v[124:127], v[116:119], v[172:175], v[124:127]
    buffer_load_dwordx4 v[196:199], v1, s[4:7], s81 offen offset:1024 sc1
    v_mfma_f32_16x16x32_bf16 v[140:143], v[116:119], v[176:179], v[140:143]
    ds_read_b128 v[116:119], v1 offset:14336
    v_mfma_f32_16x16x32_bf16 v[128:131], v[120:123], v[172:175], v[128:131]
    buffer_load_dwordx4 v[200:203], v1, s[4:7], s82 offen offset:1024 sc1
    v_mfma_f32_16x16x32_bf16 v[144:147], v[120:123], v[176:179], v[144:147]
    ds_read_b128 v[120:123], v1 offset:15360
    s_waitcnt lgkmcnt(4)
    v_mfma_f32_16x16x32_bf16 v[132:135], v[172:175], v[204:207], v[132:135]
    buffer_load_dwordx4 v[156:159], v1, s[4:7], s81 offen offset:2048 sc1
    v_mfma_f32_16x16x32_bf16 v[148:151], v[176:179], v[204:207], v[148:151]
    ds_read_b128 v[204:207], v1 offset:16384
    v_mfma_f32_16x16x32_bf16 v[136:139], v[208:211], v[172:175], v[136:139]
    v_mfma_f32_16x16x32_bf16 v[152:155], v[208:211], v[176:179], v[152:155]
    ds_read_b128 v[208:211], v1 offset:17408
    s_waitcnt vmcnt(5) lgkmcnt(4)
    v_mfma_f32_16x16x32_bf16 v[124:127], v[108:111], v[180:183], v[124:127]
    buffer_load_dwordx4 v[160:163], v1, s[4:7], s82 offen offset:2048 sc1
    v_mfma_f32_16x16x32_bf16 v[140:143], v[108:111], v[184:187], v[140:143]
    ds_read_b128 v[108:111], v1 offset:18432
    v_mfma_f32_16x16x32_bf16 v[128:131], v[112:115], v[180:183], v[128:131]
    buffer_load_dwordx4 v[164:167], v1, s[4:7], s81 offen offset:3072 sc1
    s_add_u32 s81, s81, 4096
    v_mfma_f32_16x16x32_bf16 v[144:147], v[112:115], v[184:187], v[144:147]
    ds_read_b128 v[112:115], v1 offset:19456
    s_waitcnt lgkmcnt(4)
    v_mfma_f32_16x16x32_bf16 v[132:135], v[180:183], v[116:119], v[132:135]
    buffer_load_dwordx4 v[168:171], v1, s[4:7], s82 offen offset:3072 sc1
    s_add_u32 s82, s82, 4096
    v_mfma_f32_16x16x32_bf16 v[148:151], v[184:187], v[116:119], v[148:151]
    ds_read_b128 v[116:119], v1 offset:20480
    v_mfma_f32_16x16x32_bf16 v[136:139], v[120:123], v[180:183], v[136:139]
    v_mfma_f32_16x16x32_bf16 v[152:155], v[120:123], v[184:187], v[152:155]
    ds_read_b128 v[120:123], v1 offset:21504
    s_waitcnt vmcnt(6) lgkmcnt(4)
    v_mfma_f32_16x16x32_bf16 v[124:127], v[204:207], v[188:191], v[124:127]
    buffer_load_dwordx4 v[172:175], v1, s[4:7], s81 offen offset:0 sc1
    v_mfma_f32_16x16x32_bf16 v[140:143], v[204:207], v[192:195], v[140:143]
    ds_read_b128 v[204:207], v1 offset:22528
    v_mfma_f32_16x16x32_bf16 v[128:131], v[208:211], v[188:191], v[128:131]
    buffer_load_dwordx4 v[176:179], v1, s[4:7], s82 offen offset:0 sc1
    v_mfma_f32_16x16x32_bf16 v[144:147], v[208:211], v[192:195], v[144:147]
    ds_read_b128 v[208:211], v1 offset:23552
    s_waitcnt lgkmcnt(4)
    v_mfma_f32_16x16x32_bf16 v[132:135], v[188:191], v[108:111], v[132:135]
    buffer_load_dwordx4 v[180:183], v1, s[4:7], s81 offen offset:1024 sc1
    v_mfma_f32_16x16x32_bf16 v[148:151], v[192:195], v[108:111], v[148:151]
    ds_read_b128 v[108:111], v1 offset:24576
    v_mfma_f32_16x16x32_bf16 v[136:139], v[112:115], v[188:191], v[136:139]
    v_mfma_f32_16x16x32_bf16 v[152:155], v[112:115], v[192:195], v[152:155]
    ds_read_b128 v[112:115], v1 offset:25600
    s_waitcnt vmcnt(7) lgkmcnt(4)
    v_mfma_f32_16x16x32_bf16 v[124:127], v[116:119], v[196:199], v[124:127]
    buffer_load_dwordx4 v[184:187], v1, s[4:7], s82 offen offset:1024 sc1
    v_mfma_f32_16x16x32_bf16 v[140:143], v[116:119], v[200:203], v[140:143]
    ds_read_b128 v[116:119], v1 offset:26624
    v_mfma_f32_16x16x32_bf16 v[128:131], v[120:123], v[196:199], v[128:131]
    buffer_load_dwordx4 v[188:191], v1, s[4:7], s81 offen offset:2048 sc1
    v_mfma_f32_16x16x32_bf16 v[144:147], v[120:123], v[200:203], v[144:147]
    ds_read_b128 v[120:123], v1 offset:27648
    s_waitcnt lgkmcnt(4)
    v_mfma_f32_16x16x32_bf16 v[132:135], v[196:199], v[204:207], v[132:135]
    buffer_load_dwordx4 v[192:195], v1, s[4:7], s82 offen offset:2048 sc1
    v_mfma_f32_16x16x32_bf16 v[148:151], v[200:203], v[204:207], v[148:151]
    ds_read_b128 v[204:207], v1 offset:28672
    v_mfma_f32_16x16x32_bf16 v[136:139], v[208:211], v[196:199], v[136:139]
    v_mfma_f32_16x16x32_bf16 v[152:155], v[208:211], v[200:203], v[152:155]
    ds_read_b128 v[208:211], v1 offset:29696
    s_waitcnt vmcnt(8) lgkmcnt(4)
    v_mfma_f32_16x16x32_bf16 v[124:127], v[108:111], v[156:159], v[124:127]
    buffer_load_dwordx4 v[196:199], v1, s[4:7], s81 offen offset:3072 sc1
    s_add_u32 s81, s81, 4096
    v_mfma_f32_16x16x32_bf16 v[140:143], v[108:111], v[160:163], v[140:143]
    ds_read_b128 v[108:111], v1 offset:30720
    v_mfma_f32_16x16x32_bf16 v[128:131], v[112:115], v[156:159], v[128:131]
    buffer_load_dwordx4 v[200:203], v1, s[4:7], s82 offen offset:3072 sc1
    s_add_u32 s82, s82, 4096
    v_mfma_f32_16x16x32_bf16 v[144:147], v[112:115], v[160:163], v[144:147]
    ds_read_b128 v[112:115], v1 offset:31744
    s_waitcnt lgkmcnt(4)
    v_mfma_f32_16x16x32_bf16 v[132:135], v[156:159], v[116:119], v[132:135]
    v_mfma_f32_16x16x32_bf16 v[148:151], v[160:163], v[116:119], v[148:151]
    ds_read_b128 v[116:119], v1 offset:32768
    v_mfma_f32_16x16x32_bf16 v[136:139], v[120:123], v[156:159], v[136:139]
    v_mfma_f32_16x16x32_bf16 v[152:155], v[120:123], v[160:163], v[152:155]
    ds_read_b128 v[120:123], v1 offset:33792
    s_waitcnt vmcnt(8) lgkmcnt(4)
    v_mfma_f32_16x16x32_bf16 v[124:127], v[204:207], v[164:167], v[124:127]
    buffer_load_dwordx4 v[156:159], v1, s[4:7], s81 offen offset:0 sc1
    v_mfma_f32_16x16x32_bf16 v[140:143], v[204:207], v[168:171], v[140:143]
    ds_read_b128 v[204:207], v1 offset:34816
    v_mfma_f32_16x16x32_bf16 v[128:131], v[208:211], v[164:167], v[128:131]
    buffer_load_dwordx4 v[160:163], v1, s[4:7], s82 offen offset:0 sc1
    v_mfma_f32_16x16x32_bf16 v[144:147], v[208:211], v[168:171], v[144:147]
    ds_read_b128 v[208:211], v1 offset:35840
    s_waitcnt lgkmcnt(4)
    v_mfma_f32_16x16x32_bf16 v[132:135], v[164:167], v[108:111], v[132:135]
    v_mfma_f32_16x16x32_bf16 v[148:151], v[168:171], v[108:111], v[148:151]
    ds_read_b128 v[108:111], v1 offset:36864
    v_mfma_f32_16x16x32_bf16 v[136:139], v[112:115], v[164:167], v[136:139]
    v_mfma_f32_16x16x32_bf16 v[152:155], v[112:115], v[168:171], v[152:155]
    ds_read_b128 v[112:115], v1 offset:37888
    s_waitcnt vmcnt(8) lgkmcnt(4)
    v_mfma_f32_16x16x32_bf16 v[124:127], v[116:119], v[172:175], v[124:127]
    buffer_load_dwordx4 v[164:167], v1, s[4:7], s81 offen offset:1024 sc1
    v_mfma_f32_16x16x32_bf16 v[140:143], v[116:119], v[176:179], v[140:143]
    ds_read_b128 v[116:119], v1 offset:38912
    v_mfma_f32_16x16x32_bf16 v[128:131], v[120:123], v[172:175], v[128:131]
    buffer_load_dwordx4 v[168:171], v1, s[4:7], s82 offen offset:1024 sc1
    v_mfma_f32_16x16x32_bf16 v[144:147], v[120:123], v[176:179], v[144:147]
    ds_read_b128 v[120:123], v1 offset:39936
    s_waitcnt lgkmcnt(4)
    v_mfma_f32_16x16x32_bf16 v[132:135], v[172:175], v[204:207], v[132:135]
    v_mfma_f32_16x16x32_bf16 v[148:151], v[176:179], v[204:207], v[148:151]
    ds_read_b128 v[204:207], v1 offset:40960
    v_mfma_f32_16x16x32_bf16 v[136:139], v[208:211], v[172:175], v[136:139]
    v_mfma_f32_16x16x32_bf16 v[152:155], v[208:211], v[176:179], v[152:155]
    ds_read_b128 v[208:211], v1 offset:41984
    s_waitcnt vmcnt(8) lgkmcnt(4)
    v_mfma_f32_16x16x32_bf16 v[124:127], v[108:111], v[180:183], v[124:127]
    buffer_load_dwordx4 v[172:175], v1, s[4:7], s81 offen offset:2048 sc1
    v_mfma_f32_16x16x32_bf16 v[140:143], v[108:111], v[184:187], v[140:143]
    ds_read_b128 v[108:111], v1 offset:43008
    v_mfma_f32_16x16x32_bf16 v[128:131], v[112:115], v[180:183], v[128:131]
    buffer_load_dwordx4 v[176:179], v1, s[4:7], s82 offen offset:2048 sc1
    v_mfma_f32_16x16x32_bf16 v[144:147], v[112:115], v[184:187], v[144:147]
    ds_read_b128 v[112:115], v1 offset:44032
    s_waitcnt lgkmcnt(4)
    v_mfma_f32_16x16x32_bf16 v[132:135], v[180:183], v[116:119], v[132:135]
    v_mfma_f32_16x16x32_bf16 v[148:151], v[184:187], v[116:119], v[148:151]
    ds_read_b128 v[116:119], v1 offset:45056
    v_mfma_f32_16x16x32_bf16 v[136:139], v[120:123], v[180:183], v[136:139]
    v_mfma_f32_16x16x32_bf16 v[152:155], v[120:123], v[184:187], v[152:155]
    ds_read_b128 v[120:123], v1 offset:46080
    s_waitcnt vmcnt(8) lgkmcnt(4)
    v_mfma_f32_16x16x32_bf16 v[124:127], v[204:207], v[188:191], v[124:127]
    buffer_load_dwordx4 v[180:183], v1, s[4:7], s81 offen offset:3072 sc1
    s_add_u32 s81, s81, 4096
    v_mfma_f32_16x16x32_bf16 v[140:143], v[204:207], v[192:195], v[140:143]
    ds_read_b128 v[204:207], v1 offset:47104
    v_mfma_f32_16x16x32_bf16 v[128:131], v[208:211], v[188:191], v[128:131]
    buffer_load_dwordx4 v[184:187], v1, s[4:7], s82 offen offset:3072 sc1
    s_add_u32 s82, s82, 4096
    v_mfma_f32_16x16x32_bf16 v[144:147], v[208:211], v[192:195], v[144:147]
    ds_read_b128 v[208:211], v1 offset:48128
    s_waitcnt lgkmcnt(4)
    v_mfma_f32_16x16x32_bf16 v[132:135], v[188:191], v[108:111], v[132:135]
    v_mfma_f32_16x16x32_bf16 v[148:151], v[192:195], v[108:111], v[148:151]
    ds_read_b128 v[108:111], v1 offset:49152
    v_mfma_f32_16x16x32_bf16 v[136:139], v[112:115], v[188:191], v[136:139]
    v_mfma_f32_16x16x32_bf16 v[152:155], v[112:115], v[192:195], v[152:155]
    ds_read_b128 v[112:115], v1 offset:50176
    s_waitcnt vmcnt(8) lgkmcnt(4)
    v_mfma_f32_16x16x32_bf16 v[124:127], v[116:119], v[196:199], v[124:127]
    buffer_load_dwordx4 v[188:191], v1, s[4:7], s81 offen offset:0 sc1
    v_mfma_f32_16x16x32_bf16 v[140:143], v[116:119], v[200:203], v[140:143]
    ds_read_b128 v[116:119], v1 offset:51200
    v_mfma_f32_16x16x32_bf16 v[128:131], v[120:123], v[196:199], v[128:131]
    buffer_load_dwordx4 v[192:195], v1, s[4:7], s82 offen offset:0 sc1
    v_mfma_f32_16x16x32_bf16 v[144:147], v[120:123], v[200:203], v[144:147]
    ds_read_b128 v[120:123], v1 offset:52224
    s_waitcnt lgkmcnt(4)
    v_mfma_f32_16x16x32_bf16 v[132:135], v[196:199], v[204:207], v[132:135]
    v_mfma_f32_16x16x32_bf16 v[148:151], v[200:203], v[204:207], v[148:151]
    ds_read_b128 v[204:207], v1 offset:53248
    v_mfma_f32_16x16x32_bf16 v[136:139], v[208:211], v[196:199], v[136:139]
    v_mfma_f32_16x16x32_bf16 v[152:155], v[208:211], v[200:203], v[152:155]
    ds_read_b128 v[208:211], v1 offset:54272
    s_waitcnt vmcnt(8) lgkmcnt(4)
    v_mfma_f32_16x16x32_bf16 v[124:127], v[108:111], v[156:159], v[124:127]
    buffer_load_dwordx4 v[196:199], v1, s[4:7], s81 offen offset:1024 sc1
    v_mfma_f32_16x16x32_bf16 v[140:143], v[108:111], v[160:163], v[140:143]
    ds_read_b128 v[108:111], v1 offset:55296
    v_mfma_f32_16x16x32_bf16 v[128:131], v[112:115], v[156:159], v[128:131]
    buffer_load_dwordx4 v[200:203], v1, s[4:7], s82 offen offset:1024 sc1
    v_mfma_f32_16x16x32_bf16 v[144:147], v[112:115], v[160:163], v[144:147]
    ds_read_b128 v[112:115], v1 offset:56320
    s_waitcnt lgkmcnt(4)
    v_mfma_f32_16x16x32_bf16 v[132:135], v[156:159], v[116:119], v[132:135]
    v_mfma_f32_16x16x32_bf16 v[148:151], v[160:163], v[116:119], v[148:151]
    ds_read_b128 v[116:119], v1 offset:57344
    v_mfma_f32_16x16x32_bf16 v[136:139], v[120:123], v[156:159], v[136:139]
    v_mfma_f32_16x16x32_bf16 v[152:155], v[120:123], v[160:163], v[152:155]
    ds_read_b128 v[120:123], v1 offset:58368
    s_waitcnt vmcnt(8) lgkmcnt(4)
    v_mfma_f32_16x16x32_bf16 v[124:127], v[204:207], v[164:167], v[124:127]
    buffer_load_dwordx4 v[156:159], v1, s[4:7], s81 offen offset:2048 sc1
    v_mfma_f32_16x16x32_bf16 v[140:143], v[204:207], v[168:171], v[140:143]
    ds_read_b128 v[204:207], v1 offset:59392
    v_mfma_f32_16x16x32_bf16 v[128:131], v[208:211], v[164:167], v[128:131]
    buffer_load_dwordx4 v[160:163], v1, s[4:7], s82 offen offset:2048 sc1
    v_mfma_f32_16x16x32_bf16 v[144:147], v[208:211], v[168:171], v[144:147]
    ds_read_b128 v[208:211], v1 offset:60416
    s_waitcnt lgkmcnt(4)
    v_mfma_f32_16x16x32_bf16 v[132:135], v[164:167], v[108:111], v[132:135]
    v_mfma_f32_16x16x32_bf16 v[148:151], v[168:171], v[108:111], v[148:151]
    ds_read_b128 v[108:111], v1 offset:61440
    v_mfma_f32_16x16x32_bf16 v[136:139], v[112:115], v[164:167], v[136:139]
    v_mfma_f32_16x16x32_bf16 v[152:155], v[112:115], v[168:171], v[152:155]
    ds_read_b128 v[112:115], v1 offset:62464
    s_waitcnt vmcnt(8) lgkmcnt(4)
    v_mfma_f32_16x16x32_bf16 v[124:127], v[116:119], v[172:175], v[124:127]
    buffer_load_dwordx4 v[164:167], v1, s[4:7], s81 offen offset:3072 sc1
    s_add_u32 s81, s81, 4096
    v_mfma_f32_16x16x32_bf16 v[140:143], v[116:119], v[176:179], v[140:143]
    ds_read_b128 v[116:119], v1 offset:63488
    v_mfma_f32_16x16x32_bf16 v[128:131], v[120:123], v[172:175], v[128:131]
    buffer_load_dwordx4 v[168:171], v1, s[4:7], s82 offen offset:3072 sc1
    s_add_u32 s82, s82, 4096
    v_mfma_f32_16x16x32_bf16 v[144:147], v[120:123], v[176:179], v[144:147]
    ds_read_b128 v[120:123], v1 offset:64512
    s_waitcnt lgkmcnt(4)
    v_mfma_f32_16x16x32_bf16 v[132:135], v[172:175], v[204:207], v[132:135]
    v_mfma_f32_16x16x32_bf16 v[148:151], v[176:179], v[204:207], v[148:151]
    ds_read_b128 v[204:207], v52 offset:0
    v_mfma_f32_16x16x32_bf16 v[136:139], v[208:211], v[172:175], v[136:139]
    v_mfma_f32_16x16x32_bf16 v[152:155], v[208:211], v[176:179], v[152:155]
    ds_read_b128 v[208:211], v52 offset:1024
    s_waitcnt vmcnt(8) lgkmcnt(4)
    v_mfma_f32_16x16x32_bf16 v[124:127], v[108:111], v[180:183], v[124:127]
    v_mfma_f32_16x16x32_bf16 v[140:143], v[108:111], v[184:187], v[140:143]
    ds_read_b128 v[108:111], v52 offset:2048
    v_mfma_f32_16x16x32_bf16 v[128:131], v[112:115], v[180:183], v[128:131]
    v_mfma_f32_16x16x32_bf16 v[144:147], v[112:115], v[184:187], v[144:147]
    ds_read_b128 v[112:115], v52 offset:3072
    s_waitcnt lgkmcnt(4)
    v_mfma_f32_16x16x32_bf16 v[132:135], v[180:183], v[116:119], v[132:135]
    v_mfma_f32_16x16x32_bf16 v[148:151], v[184:187], v[116:119], v[148:151]
    ds_read_b128 v[116:119], v52 offset:4096
    v_mfma_f32_16x16x32_bf16 v[136:139], v[120:123], v[180:183], v[136:139]
    v_mfma_f32_16x16x32_bf16 v[152:155], v[120:123], v[184:187], v[152:155]
    ds_read_b128 v[120:123], v52 offset:5120
    s_waitcnt vmcnt(6) lgkmcnt(4)
    v_mfma_f32_16x16x32_bf16 v[124:127], v[204:207], v[188:191], v[124:127]
    v_mfma_f32_16x16x32_bf16 v[140:143], v[204:207], v[192:195], v[140:143]
    ds_read_b128 v[204:207], v52 offset:6144
    v_mfma_f32_16x16x32_bf16 v[128:131], v[208:211], v[188:191], v[128:131]
    v_mfma_f32_16x16x32_bf16 v[144:147], v[208:211], v[192:195], v[144:147]
    ds_read_b128 v[208:211], v52 offset:7168
    s_waitcnt lgkmcnt(4)
    v_mfma_f32_16x16x32_bf16 v[132:135], v[188:191], v[108:111], v[132:135]
    v_mfma_f32_16x16x32_bf16 v[148:151], v[192:195], v[108:111], v[148:151]
    ds_read_b128 v[108:111], v52 offset:8192
    v_mfma_f32_16x16x32_bf16 v[136:139], v[112:115], v[188:191], v[136:139]
    v_mfma_f32_16x16x32_bf16 v[152:155], v[112:115], v[192:195], v[152:155]
    ds_read_b128 v[112:115], v52 offset:9216
    s_cmp_lt_u32 s46, 4
    s_cbranch_scc1 L5_st
L6_stb:
    s_waitcnt vmcnt(4) lgkmcnt(4)
    v_mfma_f32_16x16x32_bf16 v[124:127], v[116:119], v[196:199], v[124:127]
    v_mfma_f32_16x16x32_bf16 v[140:143], v[116:119], v[200:203], v[140:143]
    ds_read_b128 v[116:119], v52 offset:10240
    v_mfma_f32_16x16x32_bf16 v[128:131], v[120:123], v[196:199], v[128:131]
    v_mfma_f32_16x16x32_bf16 v[144:147], v[120:123], v[200:203], v[144:147]
    ds_read_b128 v[120:123], v52 offset:11264
    s_waitcnt lgkmcnt(4)
    v_mfma_f32_16x16x32_bf16 v[132:135], v[196:199], v[204:207], v[132:135]
    v_mfma_f32_16x16x32_bf16 v[148:151], v[200:203], v[204:207], v[148:151]
    ds_read_b128 v[204:207], v52 offset:12288
    v_mfma_f32_16x16x32_bf16 v[136:139], v[208:211], v[196:199], v[136:139]
    v_mfma_f32_16x16x32_bf16 v[152:155], v[208:211], v[200:203], v[152:155]
    ds_read_b128 v[208:211], v52 offset:13312
    s_waitcnt vmcnt(2) lgkmcnt(4)
    v_mfma_f32_16x16x32_bf16 v[124:127], v[108:111], v[156:159], v[124:127]
    v_mfma_f32_16x16x32_bf16 v[140:143], v[108:111], v[160:163], v[140:143]
    ds_read_b128 v[108:111], v52 offset:14336
    v_mfma_f32_16x16x32_bf16 v[128:131], v[112:115], v[156:159], v[128:131]
    v_mfma_f32_16x16x32_bf16 v[144:147], v[112:115], v[160:163], v[144:147]
    ds_read_b128 v[112:115], v52 offset:15360
    s_waitcnt lgkmcnt(4)
    v_mfma_f32_16x16x32_bf16 v[132:135], v[156:159], v[116:119], v[132:135]
    v_mfma_f32_16x16x32_bf16 v[148:151], v[160:163], v[116:119], v[148:151]
    v_mfma_f32_16x16x32_bf16 v[136:139], v[120:123], v[156:159], v[136:139]
    v_mfma_f32_16x16x32_bf16 v[152:155], v[120:123], v[160:163], v[152:155]
    s_waitcnt vmcnt(0) lgkmcnt(2)
    v_mfma_f32_16x16x32_bf16 v[124:127], v[204:207], v[164:167], v[124:127]
    v_mfma_f32_16x16x32_bf16 v[140:143], v[204:207], v[168:171], v[140:143]
    v_mfma_f32_16x16x32_bf16 v[128:131], v[208:211], v[164:167], v[128:131]
    v_mfma_f32_16x16x32_bf16 v[144:147], v[208:211], v[168:171], v[144:147]
    s_waitcnt lgkmcnt(0)
    v_mfma_f32_16x16x32_bf16 v[132:135], v[164:167], v[108:111], v[132:135]
    v_mfma_f32_16x16x32_bf16 v[148:151], v[168:171], v[108:111], v[148:151]
    v_mfma_f32_16x16x32_bf16 v[136:139], v[112:115], v[164:167], v[136:139]
    v_mfma_f32_16x16x32_bf16 v[152:155], v[112:115], v[168:171], v[152:155]
    s_cmp_ge_u32 s46, 4
    s_cbranch_scc1 L_q_epi
    s_waitcnt vmcnt(0)
    v_add_f32 v100, v100, v102
    v_add_f32 v101, v101, v103
    v_add_f32 v100, v100, v104
    v_add_f32 v101, v101, v105
    v_add_f32 v100, v100, v106
    v_add_f32 v101, v101, v107
    v_mov_b32 v192, v100
    v_mov_b32 v193, v101
    s_nop 1
    v_permlane16_swap_b32 v100, v192
    v_permlane16_swap_b32 v101, v193
    v_add_f32 v100, v100, v192
    v_add_f32 v101, v101, v193
    v_mul_f32 v100, 0xbacccccd, v100
    v_mul_f32 v101, 0x3acccccd, v101
    v_cmp_eq_u32 vcc, 0, v3
    v_cmp_eq_u32 s[68:69], 2, v3
    v_fma_f32 v101, -v100, v100, v101
    v_max_f32 v101, 0, v101
    v_add_f32 v101, 0x3727c5ac, v101
    v_rsq_f32 v102, v101
    v_cvt_pk_bf16_f32 v104, v100, v100
    v_and_b32 v103, 0xffff0000, v104
    v_sub_f32 v103, v100, v103
    v_mov_b32 v88, v102
    v_mov_b32 v89, v102
    v_cvt_pk_bf16_f32 v105, v103, v103
    s_nop 0
    v_permlane32_swap_b32 v88, v89
    v_cndmask_b32 v184, 0, v104, vcc
    v_cndmask_b32 v185, 0, v105, vcc
    v_mov_b64 v[186:187], 0
    v_cndmask_b32 v188, 0, v104, s[68:69]
    v_cndmask_b32 v189, 0, v105, s[68:69]
    v_mov_b64 v[190:191], 0
    v_lshlrev_b32 v4, 4, v3
    ds_bpermute_b32 v56, v4, v102 offset:0
    ds_bpermute_b32 v57, v4, v102 offset:4
    ds_bpermute_b32 v58, v4, v102 offset:8
    ds_bpermute_b32 v59, v4, v102 offset:12
    ds_bpermute_b32 v60, v4, v102 offset:128
    ds_bpermute_b32 v61, v4, v102 offset:132
    ds_bpermute_b32 v62, v4, v102 offset:136
    ds_bpermute_b32 v63, v4, v102 offset:140
    v_mov_b32 v108, v28
    v_mov_b32 v109, v28
    v_mov_b64 v[110:111], 0
    v_mov_b32 v112, v29
    v_mov_b32 v113, v29
    v_mov_b64 v[114:115], 0
    v_mov_b32 v116, v30
    v_mov_b32 v117, v30
    v_mov_b64 v[118:119], 0
    v_mov_b32 v120, v31
    v_mov_b32 v121, v31
    v_mov_b64 v[122:123], 0
    v_mul_f32 v90, 0x3ea52b5c, v88
    v_mul_f32 v91, 0x3ea52b5c, v89
    v_cndmask_b32 v92, v88, v90, vcc
    v_cndmask_b32 v93, v89, v91, vcc
    v_mfma_f32_16x16x32_bf16 v[128:131], v[112:115], v[184:187], v[128:131]
    v_mfma_f32_16x16x32_bf16 v[144:147], v[112:115], v[188:191], v[144:147]
    v_mfma_f32_16x16x32_bf16 v[132:135], v[184:187], v[116:119], v[132:135]
    v_mfma_f32_16x16x32_bf16 v[148:151], v[188:191], v[116:119], v[148:151]
    v_mfma_f32_16x16x32_bf16 v[136:139], v[120:123], v[184:187], v[136:139]
    v_mfma_f32_16x16x32_bf16 v[152:155], v[120:123], v[188:191], v[152:155]
    v_mfma_f32_16x16x32_bf16 v[124:127], v[108:111], v[184:187], v[124:127]
    v_mfma_f32_16x16x32_bf16 v[140:143], v[108:111], v[188:191], v[140:143]
    s_waitcnt lgkmcnt(0)
L_q_epi:
    s_nop 2
    v_mul_f32 v128, v128, v88
    v_mul_f32 v129, v129, v88
    v_mul_f32 v130, v130, v88
    v_mul_f32 v131, v131, v88
    v_mul_f32 v144, v144, v89
    v_mul_f32 v145, v145, v89
    v_mul_f32 v146, v146, v89
    v_mul_f32 v147, v147, v89
    v_cvt_pk_bf16_f32 v110, v128, v129
    v_cvt_pk_bf16_f32 v111, v130, v131
    ds_write_b64 v65, v[110:111] offset:0
    v_cvt_pk_bf16_f32 v118, v144, v145
    v_cvt_pk_bf16_f32 v119, v146, v147
    ds_write_b64 v65, v[118:119] offset:128
    v_mul_f32 v132, v132, v56
    v_mul_f32 v133, v133, v57
    v_mul_f32 v134, v134, v58
    v_mul_f32 v135, v135, v59
    v_mul_f32 v148, v148, v60
    v_mul_f32 v149, v149, v61
    v_mul_f32 v150, v150, v62
    v_mul_f32 v151, v151, v63
    v_cvt_pk_bf16_f32 v112, v132, v133
    v_cvt_pk_bf16_f32 v113, v134, v135
    ds_write_b64 v67, v[112:113] offset:1280
    v_cvt_pk_bf16_f32 v120, v148, v149
    v_cvt_pk_bf16_f32 v121, v150, v151
    ds_write_b64 v67, v[120:121] offset:1920
    v_mul_f32 v136, v136, v92
    v_mul_f32 v137, v137, v92
    v_mul_f32 v138, v138, v92
    v_mul_f32 v139, v139, v92
    v_mul_f32 v152, v152, v93
    v_mul_f32 v153, v153, v93
    v_mul_f32 v154, v154, v93
    v_mul_f32 v155, v155, v93
    v_cvt_pk_bf16_f32 v114, v136, v137
    v_cvt_pk_bf16_f32 v115, v138, v139
    v_cvt_pk_bf16_f32 v122, v152, v153
    v_cvt_pk_bf16_f32 v123, v154, v155
    s_mov_b32 exec_hi, 0
    ds_write_b64 v66, v[114:115] offset:1024
    ds_write_b64 v66, v[122:123] offset:1152
    s_bfm_b64 exec, 16, 32
    ds_write_b16 v68, v114 offset:1536
    ds_write_b16_d16_hi v68, v114 offset:1552
    ds_write_b16 v68, v115 offset:1568
    ds_write_b16_d16_hi v68, v115 offset:1584
    ds_write_b16 v68, v122 offset:2176
    ds_write_b16_d16_hi v68, v122 offset:2192
    ds_write_b16 v68, v123 offset:2208
    ds_write_b16_d16_hi v68, v123 offset:2224
    s_mov_b64 exec, -1
    v_mul_f32 v124, v124, v90
    v_mul_f32 v125, v125, v90
    v_mul_f32 v126, v126, v90
    v_mul_f32 v127, v127, v90
    v_mul_f32 v140, v140, v91
    v_mul_f32 v141, v141, v91
    v_mul_f32 v142, v142, v91
    v_mul_f32 v143, v143, v91
    v_cvt_pk_bf16_f32 v108, v124, v125
    v_cvt_pk_bf16_f32 v109, v126, v127
    s_waitcnt lgkmcnt(8)
    ds_write_b64 v64, v[108:109] offset:0
    v_cvt_pk_bf16_f32 v116, v140, v141
    v_cvt_pk_bf16_f32 v117, v142, v143
    ds_write_b64 v64, v[116:117] offset:128
    s_waitcnt lgkmcnt(0)
    ds_read_b128 v[188:191], v69 offset:0
    ds_read_b128 v[192:195], v69 offset:1024
    ds_read_b128 v[196:199], v69 offset:2048
    s_cmp_ge_u32 s46, 4
    s_cbranch_scc1 L_att_late
    s_waitcnt lgkmcnt(0)
    buffer_store_dwordx4 v[188:191], v1, s[4:7], s87 offen offset:0 sc1
    buffer_store_dwordx4 v[192:195], v1, s[4:7], s87 offen offset:1024 sc1
    s_mov_b32 exec_hi, 0
    buffer_store_dwordx4 v[196:199], v1, s[4:7], s87 offen offset:2048 sc1
    s_mov_b64 exec, -1
    s_setprio 0
    v_and_b32 v40, 31, v0
    v_lshrrev_b32 v41, 5, v0
    s_lshl_b32 s70, s53, 1
    s_lshr_b32 s66, s46, 2
    s_add_u32 s70, s70, s66
    s_mul_i32 s66, s66, 10240
    s_add_u32 s66, s66, 143360
    v_lshl_add_u32 v44, v40, 3, s66
    v_lshl_add_u32 v43, v41, 8, v44
    v_add_u32 v44, 1024, v44
    v_mul_u32_u24 v4, 20, v41
    v_add_u32 v4, v4, v40
    v_lshl_add_u32 v45, v4, 4, s66
    s_mul_i32 s67, s70, 1280
    s_add_u32 s67, s67, 122880
    s_xor_b32 s66, s70, 1
    s_mul_i32 s66, s66, 1280
    s_add_u32 s66, s66, 122880
    v_lshlrev_b32 v4, 3, v40
    v_lshl_add_u32 v5, v41, 8, v4
    v_add_u32 v94, s66, v5
    v_add_u32 v95, s67, v5
    s_sub_u32 s67, s67, s66
    v_mul_lo_u32 v5, v41, s67
    v_add3_u32 v96, v4, v5, s66
    v_cmp_eq_u32 vcc, 20, v40
    v_mov_b32 v4, 0x3f803f80
    v_mov_b32 v42, 0xdddddddd
    v_cndmask_b32 v72, 0, v4, vcc
    v_cndmask_b32 v73, 0, v4, vcc
    v_mov_b64 v[74:75], v[72:73]
    v_mov_b64 v[76:77], v[72:73]
    v_mov_b64 v[78:79], v[72:73]
    v_mov_b64 v[80:81], v[72:73]
    v_mov_b64 v[82:83], v[72:73]
    v_mov_b64 v[84:85], v[72:73]
    v_mov_b64 v[86:87], v[72:73]
    s_mul_i32 s66, s45, 5
    v_lshrrev_b32 v4, 4, v40
    v_mul_u32_u24 v4, 50176, v4
    v_lshl_add_u32 v4, v2, 4, v4
    v_add_u32 v5, s66, v41
    v_lshrrev_b32 v6, 3, v5
    v_lshl_add_u32 v46, v6, 10, v4
    v_and_b32 v6, 3, v5
    v_lshl_add_u32 v46, v6, 8, v46
    v_bfe_u32 v6, v5, 2, 1
    v_lshl_add_u32 v46, v6, 3, v46
    s_add_u32 s66, s66, 2
    v_add_u32 v5, s66, v41
    v_lshrrev_b32 v6, 3, v5
    v_lshl_add_u32 v47, v6, 10, v4
    v_and_b32 v6, 3, v5
    v_lshl_add_u32 v47, v6, 8, v47
    v_bfe_u32 v6, v5, 2, 1
    v_lshl_add_u32 v47, v6, 3, v47
    s_add_u32 s66, s66, 2
    v_add_u32 v5, s66, v41
    v_lshrrev_b32 v6, 3, v5
    v_lshl_add_u32 v48, v6, 10, v4
    v_and_b32 v6, 3, v5
    v_lshl_add_u32 v48, v6, 8, v48
    v_bfe_u32 v6, v5, 2, 1
    v_lshl_add_u32 v48, v6, 3, v48
    s_add_u32 s66, s66, 2
    s_mov_b32 s86, 0
    s_mul_i32 s76, s46, 2560
    s_and_b32 s66, s45, 7
    s_lshl_b32 s66, s66, 13
    s_lshr_b32 s67, s45, 3
    s_lshl_b32 s67, s67, 8
    s_add_u32 s66, s66, s67
    s_add_u32 s66, s66, 0x1521000
    s_lshl_b32 s67, s53, 5
    s_add_u32 s71, s66, s67
    s_lshl_b32 s67, s46, 3
    s_add_u32 s67, s67, s44
    s_lshl_b32 s67, s67, 2
    s_add_u32 s88, s67, s66
    s_add_u32 s72, s3, 1
    v_and_b32 v49, 7, v0
    v_lshlrev_b32 v49, 2, v49
    v_mov_b32 v4, s72
    v_mov_b32 v5, 0
    s_waitcnt vmcnt(0)
    s_mov_b64 exec, 1
    buffer_store_dword v4, v5, s[4:7], s88 offen sc1
    s_mov_b64 exec, -1
L_att_late:
    s_barrier
    s_setprio 3
    s_cmp_ge_u32 s46, 4
    s_cbranch_scc1 L7_ask
    buffer_load_dword v7, v49, s[4:7], s71 offen sc1
L7_ask:
    ds_read_b64 v[60:61], v96 offset:1024
    ds_read2st64_b64 v[52:55], v94 offset0:0 offset1:1
    ds_read2st64_b64 v[56:59], v95 offset0:0 offset1:1
    ds_read_b64 v[62:63], v44 offset:0
    ds_read2st64_b64 v[64:67], v43 offset0:0 offset1:1
    ds_read2st64_b64 v[68:71], v43 offset0:5 offset1:6
    s_mov_b64 exec, s[64:65]
    ds_read_b128 v[72:75], v45 offset:1280
    ds_read_b128 v[76:79], v45 offset:1920
    s_mov_b64 exec, -1
    s_waitcnt lgkmcnt(4)
    v_mfma_f32_32x32x4_2b_bf16 v[120:151], v[62:63], v[60:61], 0
    ds_read_b64 v[62:63], v44 offset:2560
    v_mov_b64 v[88:89], 0
    v_mov_b64 v[90:91], 0
    v_mov_b64 v[92:93], 0
    v_mov_b64 v[94:95], 0
    v_mov_b64 v[96:97], 0
    v_mov_b64 v[98:99], 0
    v_mov_b64 v[100:101], 0
    v_mov_b64 v[102:103], 0
    v_mov_b64 v[104:105], 0
    v_mov_b64 v[106:107], 0
    v_mov_b64 v[108:109], 0
    v_mov_b64 v[110:111], 0
    v_mov_b64 v[112:113], 0
    v_mov_b64 v[114:115], 0
    v_mov_b64 v[116:117], 0
    v_mov_b64 v[118:119], 0
    s_waitcnt lgkmcnt(4)
    v_mfma_f32_32x32x16_bf16 v[120:135], v[64:67], v[52:55], v[120:135]
    v_mfma_f32_32x32x16_bf16 v[136:151], v[64:67], v[56:59], v[136:151]
    s_cmp_ge_u32 s46, 4
    s_cbranch_scc1 L8_as
L9_asb:
    s_nop 8
    v_exp_f32 v120, v120
    v_exp_f32 v121, v121
    s_waitcnt lgkmcnt(0)
    v_exp_f32 v122, v122
    v_exp_f32 v123, v123
    v_exp_f32 v124, v124
    v_exp_f32 v125, v125
    v_mfma_f32_32x32x4_2b_bf16 v[152:183], v[62:63], v[60:61], 0
    ds_read_b64 v[62:63], v44 offset:5120
    v_exp_f32 v126, v126
    v_exp_f32 v127, v127
    v_exp_f32 v128, v128
    s_cmp_lt_u32 s46, 4
    s_cbranch_scc1 L10_as
L11_asb:
    v_exp_f32 v129, v129
    v_exp_f32 v130, v130
    v_exp_f32 v131, v131
    v_exp_f32 v132, v132
    v_exp_f32 v133, v133
    v_smfmac_f32_32x32x32_bf16 v[88:103], v[72:75], v[120:127], v42
    s_mov_b64 exec, s[64:65]
    ds_read_b128 v[80:83], v45 offset:3840
    ds_read_b128 v[84:87], v45 offset:4480
    s_mov_b64 exec, -1
    v_exp_f32 v134, v134
    v_exp_f32 v135, v135
    v_exp_f32 v136, v136
    v_exp_f32 v137, v137
    v_smfmac_f32_32x32x32_bf16 v[88:103], v[76:79], v[128:135], v42
    ds_read2st64_b64 v[64:67], v43 offset0:10 offset1:11
    v_exp_f32 v138, v138
    v_exp_f32 v139, v139
    v_exp_f32 v140, v140
    v_exp_f32 v141, v141
    v_mfma_f32_32x32x16_bf16 v[152:167], v[68:71], v[52:55], v[152:167]
    v_exp_f32 v142, v142
    v_exp_f32 v143, v143
    v_exp_f32 v144, v144
    v_exp_f32 v145, v145
    v_smfmac_f32_32x32x32_bf16 v[104:119], v[72:75], v[136:143], v42
    v_exp_f32 v146, v146
    v_exp_f32 v147, v147
    v_exp_f32 v148, v148
    v_exp_f32 v149, v149
    v_mfma_f32_32x32x16_bf16 v[168:183], v[68:71], v[56:59], v[168:183]
    v_exp_f32 v150, v150
    v_exp_f32 v151, v151
    s_setprio 2
    v_exp_f32 v152, v152
    v_exp_f32 v153, v153
    v_smfmac_f32_32x32x32_bf16 v[104:119], v[76:79], v[144:151], v42
    s_waitcnt lgkmcnt(0)
    v_exp_f32 v154, v154
    v_exp_f32 v155, v155
    v_exp_f32 v156, v156
    v_exp_f32 v157, v157
    v_mfma_f32_32x32x4_2b_bf16 v[120:151], v[62:63], v[60:61], 0
    ds_read_b64 v[62:63], v44 offset:7680
    v_exp_f32 v158, v158
    v_exp_f32 v159, v159
    v_exp_f32 v160, v160
    v_exp_f32 v161, v161
    v_exp_f32 v162, v162
    v_exp_f32 v163, v163
    v_exp_f32 v164, v164
    v_exp_f32 v165, v165
    v_smfmac_f32_32x32x32_bf16 v[88:103], v[80:83], v[152:159], v42
    s_mov_b64 exec, s[64:65]
    ds_read_b128 v[72:75], v45 offset:6400
    ds_read_b128 v[76:79], v45 offset:7040
    s_mov_b64 exec, -1
    v_exp_f32 v166, v166
    v_exp_f32 v167, v167
    v_exp_f32 v168, v168
    v_exp_f32 v169, v169
    v_smfmac_f32_32x32x32_bf16 v[88:103], v[84:87], v[160:167], v42
    ds_read2st64_b64 v[68:71], v43 offset0:15 offset1:16
    v_exp_f32 v170, v170
    v_exp_f32 v171, v171
    v_exp_f32 v172, v172
    v_exp_f32 v173, v173
    v_mfma_f32_32x32x16_bf16 v[120:135], v[64:67], v[52:55], v[120:135]
    v_exp_f32 v174, v174
    v_exp_f32 v175, v175
    v_exp_f32 v176, v176
    v_exp_f32 v177, v177
    v_smfmac_f32_32x32x32_bf16 v[104:119], v[80:83], v[168:175], v42
    v_exp_f32 v178, v178
    v_exp_f32 v179, v179
    v_exp_f32 v180, v180
    s_cmp_ge_u32 s46, 4
    s_cbranch_scc1 L14_as
L15_asb:
    s_lshl_b32 s66, s44, 3
    s_add_u32 s66, s66, s70
    s_mul_i32 s87, s66, 100352
    s_add_u32 s87, s87, 0x300000
    s_lshl_b32 s88, s70, 8
    s_add_u32 s88, s88, s80
    s_lshl_b32 s66, s45, 2
    s_add_u32 s88, s88, s66
    s_add_u32 s88, s88, 128
    v_exp_f32 v181, v181
    v_mfma_f32_32x32x16_bf16 v[136:151], v[64:67], v[56:59], v[136:151]
    v_exp_f32 v182, v182
    v_exp_f32 v183, v183
    s_setprio 1
    v_exp_f32 v120, v120
    v_exp_f32 v121, v121
    v_smfmac_f32_32x32x32_bf16 v[104:119], v[84:87], v[176:183], v42
    s_waitcnt lgkmcnt(0)
    v_exp_f32 v122, v122
    v_exp_f32 v123, v123
    v_exp_f32 v124, v124
    v_exp_f32 v125, v125
    v_mfma_f32_32x32x4_2b_bf16 v[152:183], v[62:63], v[60:61], 0
    v_exp_f32 v126, v126
    v_exp_f32 v127, v127
    v_exp_f32 v128, v128
    v_exp_f32 v129, v129
    v_exp_f32 v130, v130
    v_exp_f32 v131, v131
    v_exp_f32 v132, v132
    v_exp_f32 v133, v133
    v_smfmac_f32_32x32x32_bf16 v[88:103], v[72:75], v[120:127], v42
    s_mov_b64 exec, s[64:65]
    ds_read_b128 v[80:83], v45 offset:8960
    ds_read_b128 v[84:87], v45 offset:9600
    s_mov_b64 exec, -1
    v_exp_f32 v134, v134
    v_exp_f32 v135, v135
    v_exp_f32 v136, v136
    v_exp_f32 v137, v137
    v_smfmac_f32_32x32x32_bf16 v[88:103], v[76:79], v[128:135], v42
    v_exp_f32 v138, v138
    v_exp_f32 v139, v139
    v_exp_f32 v140, v140
    v_exp_f32 v141, v141
    v_mfma_f32_32x32x16_bf16 v[152:167], v[68:71], v[52:55], v[152:167]
    v_exp_f32 v142, v142
    v_exp_f32 v143, v143
    v_exp_f32 v144, v144
    v_exp_f32 v145, v145
    v_smfmac_f32_32x32x32_bf16 v[104:119], v[72:75], v[136:143], v42
    s_setprio 0
    v_exp_f32 v146, v146
    v_exp_f32 v147, v147
    v_exp_f32 v148, v148
    v_exp_f32 v149, v149
    v_mfma_f32_32x32x16_bf16 v[168:183], v[68:71], v[56:59], v[168:183]
    v_exp_f32 v150, v150
    v_exp_f32 v151, v151
    s_waitcnt vmcnt(0)
    s_barrier
    s_setprio 3
    v_add_u32 v44, 0xfffdd000, v44
    ds_read_b64 v[62:63], v44 offset:0
    v_add_u32 v43, 0xfffdd000, v43
    ds_read2st64_b64 v[64:67], v43 offset0:0 offset1:1
    v_exp_f32 v152, v152
    v_exp_f32 v153, v153
    v_smfmac_f32_32x32x32_bf16 v[104:119], v[76:79], v[144:151], v42
    s_waitcnt lgkmcnt(0)
    v_exp_f32 v154, v154
    v_exp_f32 v155, v155
    v_exp_f32 v156, v156
    v_exp_f32 v157, v157
    v_mfma_f32_32x32x4_2b_bf16 v[120:151], v[62:63], v[60:61], 0
    ds_read_b64 v[62:63], v44 offset:2560
    v_exp_f32 v158, v158
    v_exp_f32 v159, v159
    v_exp_f32 v160, v160
    v_exp_f32 v161, v161
    s_lshr_b32 s73, s46, 2
    s_add_u32 s73, s73, s44
    s_add_u32 s73, s73, 3
    s_and_b32 s73, s73, 7
    s_mul_i32 s73, s73, 20480
    s_add_u32 s73, s73, s85
    s_add_u32 m0, s76, 20480
    s_nop 0
    buffer_load_dwordx4 v1, s[4:7], s73 offen offset:0 sc1 lds
    v_exp_f32 v162, v162
    v_exp_f32 v163, v163
    v_exp_f32 v164, v164
    v_exp_f32 v165, v165
    v_smfmac_f32_32x32x32_bf16 v[88:103], v[80:83], v[152:159], v42
    v_add_u32 v45, 0xfffdd000, v45
    s_mov_b64 exec, s[64:65]
    ds_read_b128 v[72:75], v45 offset:1280
    ds_read_b128 v[76:79], v45 offset:1920
    s_mov_b64 exec, -1
    s_add_u32 m0, s76, 20480
    s_nop 0
    buffer_load_dwordx4 v1, s[4:7], s73 offen offset:1024 sc1 lds
    v_exp_f32 v166, v166
    v_exp_f32 v167, v167
    v_exp_f32 v168, v168
    v_exp_f32 v169, v169
    v_smfmac_f32_32x32x32_bf16 v[88:103], v[84:87], v[160:167], v42
    ds_read2st64_b64 v[68:71], v43 offset0:5 offset1:6
    s_add_u32 m0, s76, 20480
    s_mov_b32 exec_hi, 0
    buffer_load_dwordx4 v1, s[4:7], s73 offen offset:2048 sc1 lds
    s_mov_b64 exec, -1
    v_exp_f32 v170, v170
    v_exp_f32 v171, v171
    v_exp_f32 v172, v172
    v_exp_f32 v173, v173
    v_mfma_f32_32x32x16_bf16 v[120:135], v[64:67], v[52:55], v[120:135]
    v_exp_f32 v174, v174
    v_exp_f32 v175, v175
    v_exp_f32 v176, v176
    v_exp_f32 v177, v177
    v_smfmac_f32_32x32x32_bf16 v[104:119], v[80:83], v[168:175], v42
    v_exp_f32 v178, v178
    v_exp_f32 v179, v179
    v_exp_f32 v180, v180
    v_exp_f32 v181, v181
    v_mfma_f32_32x32x16_bf16 v[136:151], v[64:67], v[56:59], v[136:151]
    v_exp_f32 v182, v182
    v_exp_f32 v183, v183
    s_setprio 2
    v_exp_f32 v120, v120
    v_exp_f32 v121, v121
    v_smfmac_f32_32x32x32_bf16 v[104:119], v[84:87], v[176:183], v42
    s_waitcnt lgkmcnt(0)
    v_exp_f32 v122, v122
    v_exp_f32 v123, v123
    v_exp_f32 v124, v124
    s_cmp_lg_u32 s3, 0
    s_cbranch_scc1 L16_l0
    v_lshrrev_b32 v4, 1, v0
    v_and_b32 v5, 1, v0
    v_lshlrev_b32 v5, 4, v5
    v_mul_u32_u24 v50, 3072, v4
    v_add_u32 v50, v50, v5
    v_mul_u32_u24 v51, 1280, v4
    v_add_u32 v51, v51, v5
    s_lshl_b32 s66, s46, 11
    s_add_u32 m0, s66, 102400
    s_cmp_eq_u32 s92, -1
    s_cbranch_scc1 L17_pk
    buffer_load_dwordx4 v50, s[16:19], s89 offen lds
L17_pk:
    s_lshl_b32 s66, s46, 11
    s_add_u32 m0, s66, 103424
    s_cmp_eq_u32 s94, -1
    s_cbranch_scc1 L18_pk
    buffer_load_dwordx4 v51, s[20:23], s90 offen lds
L18_pk:
    s_lshl_b32 s66, s46, 10
    s_add_u32 m0, s66, 133120
    s_cmp_eq_u32 s95, -1
    s_cbranch_scc1 L19_pk
    buffer_load_dwordx4 v51, s[12:15], s91 offen lds
L19_pk:
L16_l0:
    v_exp_f32 v125, v125
    v_mfma_f32_32x32x4_2b_bf16 v[152:183], v[62:63], v[60:61], 0
    ds_read_b64 v[62:63], v44 offset:5120
    v_exp_f32 v126, v126
    v_exp_f32 v127, v127
    v_exp_f32 v128, v128
    v_exp_f32 v129, v129
    v_exp_f32 v130, v130
    v_exp_f32 v131, v131
    v_exp_f32 v132, v132
    v_exp_f32 v133, v133
    v_smfmac_f32_32x32x32_bf16 v[88:103], v[72:75], v[120:127], v42
    s_mov_b64 exec, s[64:65]
    ds_read_b128 v[80:83], v45 offset:3840
    ds_read_b128 v[84:87], v45 offset:4480
    s_mov_b64 exec, -1
    v_exp_f32 v134, v134
    v_exp_f32 v135, v135
    v_exp_f32 v136, v136
    v_exp_f32 v137, v137
    v_smfmac_f32_32x32x32_bf16 v[88:103], v[76:79], v[128:135], v42
    ds_read2st64_b64 v[64:67], v43 offset0:10 offset1:11
    v_exp_f32 v138, v138
    v_exp_f32 v139, v139
    v_exp_f32 v140, v140
    v_exp_f32 v141, v141
    v_mfma_f32_32x32x16_bf16 v[152:167], v[68:71], v[52:55], v[152:167]
    v_exp_f32 v142, v142
    v_exp_f32 v143, v143
    v_exp_f32 v144, v144
    v_exp_f32 v145, v145
    v_smfmac_f32_32x32x32_bf16 v[104:119], v[72:75], v[136:143], v42
    v_exp_f32 v146, v146
    v_exp_f32 v147, v147
    v_exp_f32 v148, v148
    v_exp_f32 v149, v149
    v_mfma_f32_32x32x16_bf16 v[168:183], v[68:71], v[56:59], v[168:183]
    v_exp_f32 v150, v150
    v_exp_f32 v151, v151
    s_setprio 1
    v_exp_f32 v152, v152
    v_exp_f32 v153, v153
    v_smfmac_f32_32x32x32_bf16 v[104:119], v[76:79], v[144:151], v42
    s_waitcnt lgkmcnt(0)
    v_exp_f32 v154, v154
    v_exp_f32 v155, v155
    v_exp_f32 v156, v156
    v_exp_f32 v157, v157
    v_mfma_f32_32x32x4_2b_bf16 v[120:151], v[62:63], v[60:61], 0
    ds_read_b64 v[62:63], v44 offset:7680
    v_exp_f32 v158, v158
    v_exp_f32 v159, v159
    v_exp_f32 v160, v160
    v_exp_f32 v161, v161
    v_exp_f32 v162, v162
    v_exp_f32 v163, v163
    v_exp_f32 v164, v164
    v_exp_f32 v165, v165
    v_smfmac_f32_32x32x32_bf16 v[88:103], v[80:83], v[152:159], v42
    s_mov_b64 exec, s[64:65]
    ds_read_b128 v[72:75], v45 offset:6400
    ds_read_b128 v[76:79], v45 offset:7040
    s_mov_b64 exec, -1
    v_exp_f32 v166, v166
    v_exp_f32 v167, v167
    v_exp_f32 v168, v168
    v_exp_f32 v169, v169
    v_smfmac_f32_32x32x32_bf16 v[88:103], v[84:87], v[160:167], v42
    ds_read2st64_b64 v[68:71], v43 offset0:15 offset1:16
    v_exp_f32 v170, v170
    v_exp_f32 v171, v171
    v_exp_f32 v172, v172
    v_exp_f32 v173, v173
    v_mfma_f32_32x32x16_bf16 v[120:135], v[64:67], v[52:55], v[120:135]
    v_exp_f32 v174, v174
    v_exp_f32 v175, v175
    v_exp_f32 v176, v176
    v_exp_f32 v177, v177
    v_smfmac_f32_32x32x32_bf16 v[104:119], v[80:83], v[168:175], v42
    v_exp_f32 v178, v178
    s_setprio 0
    v_exp_f32 v179, v179
    v_exp_f32 v180, v180
    v_exp_f32 v181, v181
    v_mfma_f32_32x32x16_bf16 v[136:151], v[64:67], v[56:59], v[136:151]
    v_exp_f32 v182, v182
    v_exp_f32 v183, v183
    s_waitcnt vmcnt(0)
    s_barrier
    s_setprio 3
    v_exp_f32 v120, v120
    v_exp_f32 v121, v121
    v_smfmac_f32_32x32x32_bf16 v[104:119], v[84:87], v[176:183], v42
    s_waitcnt lgkmcnt(0)
    v_exp_f32 v122, v122
    v_exp_f32 v123, v123
    v_exp_f32 v124, v124
    v_exp_f32 v125, v125
    v_mfma_f32_32x32x4_2b_bf16 v[152:183], v[62:63], v[60:61], 0
    ds_read_b64 v[62:63], v44 offset:20480
    v_exp_f32 v126, v126
    v_exp_f32 v127, v127
    v_exp_f32 v128, v128
    v_exp_f32 v129, v129
    s_lshr_b32 s73, s46, 2
    s_add_u32 s73, s73, s44
    s_add_u32 s73, s73, 5
    s_and_b32 s73, s73, 7
    s_mul_i32 s73, s73, 20480
    s_add_u32 s73, s73, s85
    s_add_u32 m0, s76, 40960
    s_nop 0
    buffer_load_dwordx4 v1, s[4:7], s73 offen offset:0 sc1 lds
    v_exp_f32 v130, v130
    v_exp_f32 v131, v131
    v_exp_f32 v132, v132
    v_exp_f32 v133, v133
    v_smfmac_f32_32x32x32_bf16 v[88:103], v[72:75], v[120:127], v42
    s_mov_b64 exec, s[64:65]
    ds_read_b128 v[80:83], v45 offset:8960
    ds_read_b128 v[84:87], v45 offset:9600
    s_mov_b64 exec, -1
    v_exp_f32 v134, v134
    v_exp_f32 v135, v135
    v_exp_f32 v136, v136
    v_exp_f32 v137, v137
    v_smfmac_f32_32x32x32_bf16 v[88:103], v[76:79], v[128:135], v42
    ds_read2st64_b64 v[64:67], v43 offset0:40 offset1:41
    v_exp_f32 v138, v138
    v_exp_f32 v139, v139
    v_exp_f32 v140, v140
    v_exp_f32 v141, v141
    v_mfma_f32_32x32x16_bf16 v[152:167], v[68:71], v[52:55], v[152:167]
    v_exp_f32 v142, v142
    v_exp_f32 v143, v143
    v_exp_f32 v144, v144
    v_exp_f32 v145, v145
    v_smfmac_f32_32x32x32_bf16 v[104:119], v[72:75], v[136:143], v42
    v_exp_f32 v146, v146
    v_exp_f32 v147, v147
    v_exp_f32 v148, v148
    v_exp_f32 v149, v149
    v_mfma_f32_32x32x16_bf16 v[168:183], v[68:71], v[56:59], v[168:183]
    v_exp_f32 v150, v150
    v_exp_f32 v151, v151
    v_exp_f32 v152, v152
    v_exp_f32 v153, v153
    v_smfmac_f32_32x32x32_bf16 v[104:119], v[76:79], v[144:151], v42
    s_waitcnt lgkmcnt(0)
    s_add_u32 m0, s76, 40960
    s_nop 0
    buffer_load_dwordx4 v1, s[4:7], s73 offen offset:1024 sc1 lds
    v_exp_f32 v154, v154
    v_exp_f32 v155, v155
    v_exp_f32 v156, v156
    v_exp_f32 v157, v157
    v_mfma_f32_32x32x4_2b_bf16 v[120:151], v[62:63], v[60:61], 0
    ds_read_b64 v[62:63], v44 offset:23040
    v_exp_f32 v158, v158
    v_exp_f32 v159, v159
    v_exp_f32 v160, v160
    v_exp_f32 v161, v161
    v_exp_f32 v162, v162
    v_exp_f32 v163, v163
    v_exp_f32 v164, v164
    v_exp_f32 v165, v165
    v_smfmac_f32_32x32x32_bf16 v[88:103], v[80:83], v[152:159], v42
    s_mov_b64 exec, s[64:65]
    ds_read_b128 v[72:75], v45 offset:21760
    ds_read_b128 v[76:79], v45 offset:22400
    s_mov_b64 exec, -1
    v_exp_f32 v166, v166
    v_exp_f32 v167, v167
    v_exp_f32 v168, v168
    v_exp_f32 v169, v169
    v_smfmac_f32_32x32x32_bf16 v[88:103], v[84:87], v[160:167], v42
    ds_read2st64_b64 v[68:71], v43 offset0:45 offset1:46
    v_exp_f32 v170, v170
    v_exp_f32 v171, v171
    v_exp_f32 v172, v172
    s_cmp_lg_u32 s3, 0
    s_cbranch_scc1 L20_l0
    s_lshl_b32 s66, s46, 11
    s_add_u32 s66, s66, 102400
    v_lshl_add_u32 v4, v0, 3, s66
    s_lshl_b32 s66, s46, 10
    s_add_u32 s66, s66, 133120
    v_lshl_add_u32 v5, v0, 3, s66
    s_waitcnt vmcnt(2)
    ds_read_b64_tr_b16 v[188:189], v4 offset:0
    ds_read_b64_tr_b16 v[190:191], v4 offset:512
    ds_read_b64_tr_b16 v[192:193], v4 offset:1024
    ds_read_b64_tr_b16 v[194:195], v4 offset:1536
    ds_read_b64_tr_b16 v[196:197], v5 offset:0
    ds_read_b64_tr_b16 v[198:199], v5 offset:512
L20_l0:
    v_exp_f32 v173, v173
    v_mfma_f32_32x32x16_bf16 v[120:135], v[64:67], v[52:55], v[120:135]
    v_exp_f32 v174, v174
    v_exp_f32 v175, v175
    v_exp_f32 v176, v176
    v_exp_f32 v177, v177
    v_smfmac_f32_32x32x32_bf16 v[104:119], v[80:83], v[168:175], v42
    s_add_u32 m0, s76, 40960
    s_mov_b32 exec_hi, 0
    buffer_load_dwordx4 v1, s[4:7], s73 offen offset:2048 sc1 lds
    s_mov_b64 exec, -1
    v_exp_f32 v178, v178
    v_exp_f32 v179, v179
    v_exp_f32 v180, v180
    v_exp_f32 v181, v181
    v_mfma_f32_32x32x16_bf16 v[136:151], v[64:67], v[56:59], v[136:151]
    v_exp_f32 v182, v182
    v_exp_f32 v183, v183
    s_setprio 2
    v_exp_f32 v120, v120
    v_exp_f32 v121, v121
    v_smfmac_f32_32x32x32_bf16 v[104:119], v[84:87], v[176:183], v42
    s_waitcnt lgkmcnt(0)
    v_exp_f32 v122, v122
    v_exp_f32 v123, v123
    s_add_u32 s71, s71, 128
    buffer_load_dword v7, v49, s[4:7], s71 offen sc1
    s_cmp_lg_u32 s3, 0
    s_cbranch_scc1 L21_l0
    s_cmp_eq_u32 s92, -1
    s_cbranch_scc1 L22_pks
    buffer_store_dwordx4 v[188:191], v1, s[4:7], s92 offen sc1
L22_pks:
    s_cmp_eq_u32 s94, -1
    s_cbranch_scc1 L23_pks
    buffer_store_dwordx4 v[192:195], v1, s[4:7], s94 offen sc1
L23_pks:
    s_cmp_eq_u32 s95, -1
    s_cbranch_scc1 L24_pks
    buffer_store_dwordx4 v[196:199], v1, s[4:7], s95 offen sc1
L24_pks:
L21_l0:
    v_exp_f32 v124, v124
    v_exp_f32 v125, v125
    v_mfma_f32_32x32x4_2b_bf16 v[152:183], v[62:63], v[60:61], 0
    ds_read_b64 v[62:63], v44 offset:25600
    v_exp_f32 v126, v126
    v_exp_f32 v127, v127
    v_exp_f32 v128, v128
    v_exp_f32 v129, v129
    v_exp_f32 v130, v130
    v_exp_f32 v131, v131
    v_exp_f32 v132, v132
    v_exp_f32 v133, v133
    v_smfmac_f32_32x32x32_bf16 v[88:103], v[72:75], v[120:127], v42
    s_mov_b64 exec, s[64:65]
    ds_read_b128 v[80:83], v45 offset:24320
    ds_read_b128 v[84:87], v45 offset:24960
    s_mov_b64 exec, -1
    v_exp_f32 v134, v134
    v_exp_f32 v135, v135
    v_exp_f32 v136, v136
    v_exp_f32 v137, v137
    v_smfmac_f32_32x32x32_bf16 v[88:103], v[76:79], v[128:135], v42
    ds_read2st64_b64 v[64:67], v43 offset0:50 offset1:51
    v_exp_f32 v138, v138
    v_exp_f32 v139, v139
    v_exp_f32 v140, v140
    v_exp_f32 v141, v141
    v_mfma_f32_32x32x16_bf16 v[152:167], v[68:71], v[52:55], v[152:167]
    v_exp_f32 v142, v142
    v_exp_f32 v143, v143
    v_exp_f32 v144, v144
    v_exp_f32 v145, v145
    v_smfmac_f32_32x32x32_bf16 v[104:119], v[72:75], v[136:143], v42
    v_exp_f32 v146, v146
    v_exp_f32 v147, v147
    v_exp_f32 v148, v148
    v_exp_f32 v149, v149
    v_mfma_f32_32x32x16_bf16 v[168:183], v[68:71], v[56:59], v[168:183]
    v_exp_f32 v150, v150
    v_exp_f32 v151, v151
    s_setprio 1
    v_exp_f32 v152, v152
    v_exp_f32 v153, v153
    v_smfmac_f32_32x32x32_bf16 v[104:119], v[76:79], v[144:151], v42
    s_waitcnt lgkmcnt(0)
    v_exp_f32 v154, v154
    v_exp_f32 v155, v155
    v_exp_f32 v156, v156
    v_exp_f32 v157, v157
    v_mfma_f32_32x32x4_2b_bf16 v[120:151], v[62:63], v[60:61], 0
    ds_read_b64 v[62:63], v44 offset:28160
    v_exp_f32 v158, v158
    v_exp_f32 v159, v159
    v_exp_f32 v160, v160
    v_exp_f32 v161, v161
    v_exp_f32 v162, v162
    v_exp_f32 v163, v163
    v_exp_f32 v164, v164
    v_exp_f32 v165, v165
    v_smfmac_f32_32x32x32_bf16 v[88:103], v[80:83], v[152:159], v42
    s_mov_b64 exec, s[64:65]
    ds_read_b128 v[72:75], v45 offset:26880
    ds_read_b128 v[76:79], v45 offset:27520
    s_mov_b64 exec, -1
    v_exp_f32 v166, v166
    v_exp_f32 v167, v167
    v_exp_f32 v168, v168
    v_exp_f32 v169, v169
    v_smfmac_f32_32x32x32_bf16 v[88:103], v[84:87], v[160:167], v42
    ds_read2st64_b64 v[68:71], v43 offset0:55 offset1:56
    v_exp_f32 v170, v170
    v_exp_f32 v171, v171
    v_exp_f32 v172, v172
    v_exp_f32 v173, v173
    v_mfma_f32_32x32x16_bf16 v[120:135], v[64:67], v[52:55], v[120:135]
    v_exp_f32 v174, v174
    v_exp_f32 v175, v175
    v_exp_f32 v176, v176
    v_exp_f32 v177, v177
    v_smfmac_f32_32x32x32_bf16 v[104:119], v[80:83], v[168:175], v42
    v_exp_f32 v178, v178
    s_setprio 0
    v_exp_f32 v179, v179
    v_exp_f32 v180, v180
    v_exp_f32 v181, v181
    v_mfma_f32_32x32x16_bf16 v[136:151], v[64:67], v[56:59], v[136:151]
    v_exp_f32 v182, v182
    v_exp_f32 v183, v183
    s_cmp_lg_u32 s3, 0
    s_cbranch_scc1 L25_l0
    s_waitcnt vmcnt(0)
L25_l0:
    s_waitcnt vmcnt(1)
    s_barrier
    s_setprio 3
    v_exp_f32 v120, v120
    v_exp_f32 v121, v121
    v_smfmac_f32_32x32x32_bf16 v[104:119], v[84:87], v[176:183], v42
    s_waitcnt lgkmcnt(0)
    v_exp_f32 v122, v122
    v_exp_f32 v123, v123
    s_cmp_lg_u32 s3, 0
    s_cbranch_scc1 L26_l0
    s_lshl_b32 s77, s49, 13
    s_add_u32 s77, s77, 0x1520c00
    s_lshl_b32 s66, s44, 2
    s_lshr_b32 s68, s45, 3
    s_add_u32 s66, s66, s68
    s_lshl_b32 s66, s66, 2
    s_add_u32 s66, s66, s77
    v_mov_b32 v4, 1
    v_mov_b32 v5, 0
    v_lshlrev_b32 v50, 2, v40
    s_cmp_eq_u32 s46, 0
    s_cselect_b64 exec, 1, 0
    s_cbranch_execz L27_pkf
    buffer_store_dword v4, v5, s[4:7], s66 offen sc1
L27_pkf:
    s_mov_b64 exec, -1
L26_l0:
    v_exp_f32 v124, v124
    v_exp_f32 v125, v125
    v_mfma_f32_32x32x4_2b_bf16 v[152:183], v[62:63], v[60:61], 0
    ds_read_b64 v[62:63], v44 offset:40960
    v_exp_f32 v126, v126
    v_exp_f32 v127, v127
    s_waitcnt vmcnt(0)
    v_cmp_gt_u32 vcc, s72, v7
    s_cbranch_vccnz L28_lpoll
L29_lseen:
    v_exp_f32 v128, v128
    v_exp_f32 v129, v129
    s_lshr_b32 s73, s46, 2
    s_mul_i32 s66, s73, 10240
    s_lshl_b32 s73, s73, 1
    s_add_u32 s73, s73, s44
    s_add_u32 s73, s73, 7
    s_and_b32 s73, s73, 7
    s_mul_i32 s73, s73, 20480
    s_add_u32 s73, s73, s85
    s_add_u32 s73, s73, s66
    s_add_u32 m0, s76, 61440
    s_nop 0
    buffer_load_dwordx4 v1, s[4:7], s73 offen offset:0 sc1 lds
    v_exp_f32 v130, v130
    v_exp_f32 v131, v131
    v_exp_f32 v132, v132
    v_exp_f32 v133, v133
    v_smfmac_f32_32x32x32_bf16 v[88:103], v[72:75], v[120:127], v42
    s_mov_b64 exec, s[64:65]
    ds_read_b128 v[80:83], v45 offset:29440
    ds_read_b128 v[84:87], v45 offset:30080
    s_mov_b64 exec, -1
    v_exp_f32 v134, v134
    v_exp_f32 v135, v135
    v_exp_f32 v136, v136
    v_exp_f32 v137, v137
    v_smfmac_f32_32x32x32_bf16 v[88:103], v[76:79], v[128:135], v42
    ds_read2st64_b64 v[64:67], v43 offset0:80 offset1:81
    v_exp_f32 v138, v138
    v_exp_f32 v139, v139
    v_exp_f32 v140, v140
    v_exp_f32 v141, v141
    v_mfma_f32_32x32x16_bf16 v[152:167], v[68:71], v[52:55], v[152:167]
    v_exp_f32 v142, v142
    v_exp_f32 v143, v143
    v_exp_f32 v144, v144
    v_exp_f32 v145, v145
    v_smfmac_f32_32x32x32_bf16 v[104:119], v[72:75], v[136:143], v42
    v_exp_f32 v146, v146
    v_exp_f32 v147, v147
    v_exp_f32 v148, v148
    v_exp_f32 v149, v149
    v_mfma_f32_32x32x16_bf16 v[168:183], v[68:71], v[56:59], v[168:183]
    v_exp_f32 v150, v150
    v_exp_f32 v151, v151
    v_exp_f32 v152, v152
    v_exp_f32 v153, v153
    v_smfmac_f32_32x32x32_bf16 v[104:119], v[76:79], v[144:151], v42
    s_waitcnt lgkmcnt(0)
    s_add_u32 m0, s76, 61440
    s_nop 0
    buffer_load_dwordx4 v1, s[4:7], s73 offen offset:1024 sc1 lds
    v_exp_f32 v154, v154
    v_exp_f32 v155, v155
    v_exp_f32 v156, v156
    v_exp_f32 v157, v157
    v_mfma_f32_32x32x4_2b_bf16 v[120:151], v[62:63], v[60:61], 0
    ds_read_b64 v[62:63], v44 offset:43520
    v_exp_f32 v158, v158
    v_exp_f32 v159, v159
    v_exp_f32 v160, v160
    v_exp_f32 v161, v161
    v_exp_f32 v162, v162
    v_exp_f32 v163, v163
    v_exp_f32 v164, v164
    v_exp_f32 v165, v165
    v_smfmac_f32_32x32x32_bf16 v[88:103], v[80:83], v[152:159], v42
    s_mov_b64 exec, s[64:65]
    ds_read_b128 v[72:75], v45 offset:42240
    ds_read_b128 v[76:79], v45 offset:42880
    s_mov_b64 exec, -1
    v_exp_f32 v166, v166
    v_exp_f32 v167, v167
    v_exp_f32 v168, v168
    v_exp_f32 v169, v169
    v_smfmac_f32_32x32x32_bf16 v[88:103], v[84:87], v[160:167], v42
    ds_read2st64_b64 v[68:71], v43 offset0:85 offset1:86
    v_exp_f32 v170, v170
    v_exp_f32 v171, v171
    v_exp_f32 v172, v172
    v_exp_f32 v173, v173
    v_mfma_f32_32x32x16_bf16 v[120:135], v[64:67], v[52:55], v[120:135]
    v_exp_f32 v174, v174
    v_exp_f32 v175, v175
    v_exp_f32 v176, v176
    v_exp_f32 v177, v177
    v_smfmac_f32_32x32x32_bf16 v[104:119], v[80:83], v[168:175], v42
    s_add_u32 m0, s76, 61440
    s_mov_b32 exec_hi, 0
    buffer_load_dwordx4 v1, s[4:7], s73 offen offset:2048 sc1 lds
    s_mov_b64 exec, -1
    v_exp_f32 v178, v178
    v_exp_f32 v179, v179
    v_exp_f32 v180, v180
    v_exp_f32 v181, v181
    v_mfma_f32_32x32x16_bf16 v[136:151], v[64:67], v[56:59], v[136:151]
    v_exp_f32 v182, v182
    v_exp_f32 v183, v183
    s_setprio 2
    v_exp_f32 v120, v120
    v_exp_f32 v121, v121
    v_smfmac_f32_32x32x32_bf16 v[104:119], v[84:87], v[176:183], v42
    s_waitcnt lgkmcnt(0)
    v_exp_f32 v122, v122
    v_exp_f32 v123, v123
    v_exp_f32 v124, v124
    v_exp_f32 v125, v125
    v_mfma_f32_32x32x4_2b_bf16 v[152:183], v[62:63], v[60:61], 0
    ds_read_b64 v[62:63], v44 offset:46080
    v_exp_f32 v126, v126
    v_exp_f32 v127, v127
    v_exp_f32 v128, v128
    v_exp_f32 v129, v129
    s_lshr_b32 s73, s46, 2
    s_add_u32 s73, s73, s44
    s_add_u32 s73, s73, 10
    s_and_b32 s73, s73, 7
    s_mul_i32 s73, s73, 20480
    s_add_u32 s73, s73, s85
    s_add_u32 s73, s73, 10240
    s_add_u32 m0, s76, 81920
    s_nop 0
    buffer_load_dwordx4 v1, s[4:7], s73 offen offset:0 sc1 lds
    v_exp_f32 v130, v130
    v_exp_f32 v131, v131
    v_exp_f32 v132, v132
    v_exp_f32 v133, v133
    v_smfmac_f32_32x32x32_bf16 v[88:103], v[72:75], v[120:127], v42
    s_mov_b64 exec, s[64:65]
    ds_read_b128 v[80:83], v45 offset:44800
    ds_read_b128 v[84:87], v45 offset:45440
    s_mov_b64 exec, -1
    v_exp_f32 v134, v134
    v_exp_f32 v135, v135
    v_exp_f32 v136, v136
    v_exp_f32 v137, v137
    v_smfmac_f32_32x32x32_bf16 v[88:103], v[76:79], v[128:135], v42
    ds_read2st64_b64 v[64:67], v43 offset0:90 offset1:91
    v_exp_f32 v138, v138
    v_exp_f32 v139, v139
    v_exp_f32 v140, v140
    v_exp_f32 v141, v141
    v_mfma_f32_32x32x16_bf16 v[152:167], v[68:71], v[52:55], v[152:167]
    v_exp_f32 v142, v142
    v_exp_f32 v143, v143
    v_exp_f32 v144, v144
    v_exp_f32 v145, v145
    v_smfmac_f32_32x32x32_bf16 v[104:119], v[72:75], v[136:143], v42
    v_exp_f32 v146, v146
    v_exp_f32 v147, v147
    v_exp_f32 v148, v148
    v_exp_f32 v149, v149
    v_mfma_f32_32x32x16_bf16 v[168:183], v[68:71], v[56:59], v[168:183]
    v_exp_f32 v150, v150
    v_exp_f32 v151, v151
    s_setprio 1
    v_exp_f32 v152, v152
    v_exp_f32 v153, v153
    v_smfmac_f32_32x32x32_bf16 v[104:119], v[76:79], v[144:151], v42
    s_waitcnt lgkmcnt(0)
    s_add_u32 m0, s76, 81920
    s_nop 0
    buffer_load_dwordx4 v1, s[4:7], s73 offen offset:1024 sc1 lds
    v_exp_f32 v154, v154
    v_exp_f32 v155, v155
    v_exp_f32 v156, v156
    v_exp_f32 v157, v157
    v_mfma_f32_32x32x4_2b_bf16 v[120:151], v[62:63], v[60:61], 0
    ds_read_b64 v[62:63], v44 offset:48640
    v_exp_f32 v158, v158
    v_exp_f32 v159, v159
    v_exp_f32 v160, v160
    v_exp_f32 v161, v161
    v_exp_f32 v162, v162
    v_exp_f32 v163, v163
    v_exp_f32 v164, v164
    v_exp_f32 v165, v165
    v_smfmac_f32_32x32x32_bf16 v[88:103], v[80:83], v[152:159], v42
    s_mov_b64 exec, s[64:65]
    ds_read_b128 v[72:75], v45 offset:47360
    ds_read_b128 v[76:79], v45 offset:48000
    s_mov_b64 exec, -1
    v_exp_f32 v166, v166
    v_exp_f32 v167, v167
    v_exp_f32 v168, v168
    v_exp_f32 v169, v169
    v_smfmac_f32_32x32x32_bf16 v[88:103], v[84:87], v[160:167], v42
    ds_read2st64_b64 v[68:71], v43 offset0:95 offset1:96
    v_exp_f32 v170, v170
    v_exp_f32 v171, v171
    v_exp_f32 v172, v172
    v_exp_f32 v173, v173
    v_mfma_f32_32x32x16_bf16 v[120:135], v[64:67], v[52:55], v[120:135]
    v_exp_f32 v174, v174
    v_exp_f32 v175, v175
    v_exp_f32 v176, v176
    v_exp_f32 v177, v177
    v_smfmac_f32_32x32x32_bf16 v[104:119], v[80:83], v[168:175], v42
    s_add_u32 m0, s76, 81920
    s_mov_b32 exec_hi, 0
    buffer_load_dwordx4 v1, s[4:7], s73 offen offset:2048 sc1 lds
    s_mov_b64 exec, -1
    v_exp_f32 v178, v178
    s_setprio 0
    v_exp_f32 v179, v179
    v_exp_f32 v180, v180
    v_exp_f32 v181, v181
    v_mfma_f32_32x32x16_bf16 v[136:151], v[64:67], v[56:59], v[136:151]
    v_exp_f32 v182, v182
    v_exp_f32 v183, v183
    s_waitcnt vmcnt(3)
    s_barrier
    s_setprio 3
    v_exp_f32 v120, v120
    v_exp_f32 v121, v121
    v_smfmac_f32_32x32x32_bf16 v[104:119], v[84:87], v[176:183], v42
    s_waitcnt lgkmcnt(0)
    v_exp_f32 v122, v122
    v_exp_f32 v123, v123
    v_exp_f32 v124, v124
    v_exp_f32 v125, v125
    v_mfma_f32_32x32x4_2b_bf16 v[152:183], v[62:63], v[60:61], 0
    v_add_u32 v44, 0xf000, v44
    ds_read_b64 v[62:63], v44 offset:0
    v_exp_f32 v126, v126
    v_exp_f32 v127, v127
    v_exp_f32 v128, v128
    v_exp_f32 v129, v129
    s_lshr_b32 s73, s46, 2
    s_add_u32 s73, s73, s44
    s_add_u32 s73, s73, 12
    s_and_b32 s73, s73, 7
    s_mul_i32 s73, s73, 20480
    s_add_u32 s73, s73, s85
    s_add_u32 s73, s73, 10240
    s_add_u32 m0, s76, 102400
    s_nop 0
    buffer_load_dwordx4 v1, s[4:7], s73 offen offset:0 sc1 lds
    v_exp_f32 v130, v130
    v_exp_f32 v131, v131
    v_exp_f32 v132, v132
    v_exp_f32 v133, v133
    v_smfmac_f32_32x32x32_bf16 v[88:103], v[72:75], v[120:127], v42
    s_mov_b64 exec, s[64:65]
    ds_read_b128 v[80:83], v45 offset:49920
    ds_read_b128 v[84:87], v45 offset:50560
    s_mov_b64 exec, -1
    v_exp_f32 v134, v134
    v_exp_f32 v135, v135
    v_exp_f32 v136, v136
    v_exp_f32 v137, v137
    v_smfmac_f32_32x32x32_bf16 v[88:103], v[76:79], v[128:135], v42
    ds_read2st64_b64 v[64:67], v43 offset0:120 offset1:121
    v_exp_f32 v138, v138
    v_exp_f32 v139, v139
    v_exp_f32 v140, v140
    v_exp_f32 v141, v141
    v_mfma_f32_32x32x16_bf16 v[152:167], v[68:71], v[52:55], v[152:167]
    v_exp_f32 v142, v142
    v_exp_f32 v143, v143
    v_exp_f32 v144, v144
    v_exp_f32 v145, v145
    v_smfmac_f32_32x32x32_bf16 v[104:119], v[72:75], v[136:143], v42
    v_exp_f32 v146, v146
    v_exp_f32 v147, v147
    v_exp_f32 v148, v148
    v_exp_f32 v149, v149
    v_mfma_f32_32x32x16_bf16 v[168:183], v[68:71], v[56:59], v[168:183]
    v_exp_f32 v150, v150
    v_exp_f32 v151, v151
    v_exp_f32 v152, v152
    v_exp_f32 v153, v153
    v_smfmac_f32_32x32x32_bf16 v[104:119], v[76:79], v[144:151], v42
    s_waitcnt lgkmcnt(0)
    s_add_u32 m0, s76, 102400
    s_nop 0
    buffer_load_dwordx4 v1, s[4:7], s73 offen offset:1024 sc1 lds
    v_exp_f32 v154, v154
    v_exp_f32 v155, v155
    v_exp_f32 v156, v156
    v_exp_f32 v157, v157
    v_mfma_f32_32x32x4_2b_bf16 v[120:151], v[62:63], v[60:61], 0
    ds_read_b64 v[62:63], v44 offset:2560
    v_exp_f32 v158, v158
    v_exp_f32 v159, v159
    v_exp_f32 v160, v160
    v_exp_f32 v161, v161
    v_exp_f32 v162, v162
    v_exp_f32 v163, v163
    v_exp_f32 v164, v164
    v_exp_f32 v165, v165
    v_smfmac_f32_32x32x32_bf16 v[88:103], v[80:83], v[152:159], v42
    v_add_u32 v45, 0xf000, v45
    s_mov_b64 exec, s[64:65]
    ds_read_b128 v[72:75], v45 offset:1280
    ds_read_b128 v[76:79], v45 offset:1920
    s_mov_b64 exec, -1
    v_exp_f32 v166, v166
    s_cmp_lg_u32 s3, 0
    s_cbranch_scc1 L32_l0
    buffer_load_dword v184, v50, s[4:7], s77 offen sc1
    buffer_load_dword v7, v50, s[4:7], s80 offen offset:3200 sc1
L32_l0:
    v_exp_f32 v167, v167
    v_exp_f32 v168, v168
    v_exp_f32 v169, v169
    v_smfmac_f32_32x32x32_bf16 v[88:103], v[84:87], v[160:167], v42
    ds_read2st64_b64 v[68:71], v43 offset0:125 offset1:126
    v_exp_f32 v170, v170
    v_exp_f32 v171, v171
    v_exp_f32 v172, v172
    v_exp_f32 v173, v173
    v_mfma_f32_32x32x16_bf16 v[120:135], v[64:67], v[52:55], v[120:135]
    v_exp_f32 v174, v174
    v_exp_f32 v175, v175
    v_exp_f32 v176, v176
    v_exp_f32 v177, v177
    v_smfmac_f32_32x32x32_bf16 v[104:119], v[80:83], v[168:175], v42
    s_add_u32 m0, s76, 102400
    s_mov_b32 exec_hi, 0
    buffer_load_dwordx4 v1, s[4:7], s73 offen offset:2048 sc1 lds
    s_mov_b64 exec, -1
    v_exp_f32 v178, v178
    v_exp_f32 v179, v179
    v_exp_f32 v180, v180
    v_exp_f32 v181, v181
    v_mfma_f32_32x32x16_bf16 v[136:151], v[64:67], v[56:59], v[136:151]
    v_exp_f32 v182, v182
    v_exp_f32 v183, v183
    s_setprio 2
    v_exp_f32 v120, v120
    v_exp_f32 v121, v121
    v_smfmac_f32_32x32x32_bf16 v[104:119], v[84:87], v[176:183], v42
    s_waitcnt lgkmcnt(0)
    v_exp_f32 v122, v122
    v_exp_f32 v123, v123
    v_exp_f32 v124, v124
    v_exp_f32 v125, v125
    v_mfma_f32_32x32x4_2b_bf16 v[152:183], v[62:63], v[60:61], 0
    ds_read_b64 v[62:63], v44 offset:5120
    v_exp_f32 v126, v126
    v_exp_f32 v127, v127
    v_exp_f32 v128, v128
    v_exp_f32 v129, v129
    s_lshr_b32 s73, s46, 2
    s_add_u32 s73, s73, s44
    s_add_u32 s73, s73, 14
    s_and_b32 s73, s73, 7
    s_mul_i32 s73, s73, 20480
    s_add_u32 s73, s73, s85
    s_add_u32 s73, s73, 10240
    s_add_u32 m0, s76, 122880
    s_nop 0
    buffer_load_dwordx4 v1, s[4:7], s73 offen offset:0 sc1 lds
    v_exp_f32 v130, v130
    v_exp_f32 v131, v131
    v_exp_f32 v132, v132
    v_exp_f32 v133, v133
    v_smfmac_f32_32x32x32_bf16 v[88:103], v[72:75], v[120:127], v42
    s_mov_b64 exec, s[64:65]
    ds_read_b128 v[80:83], v45 offset:3840
    ds_read_b128 v[84:87], v45 offset:4480
    s_mov_b64 exec, -1
    v_exp_f32 v134, v134
    v_exp_f32 v135, v135
    v_exp_f32 v136, v136
    v_exp_f32 v137, v137
    v_smfmac_f32_32x32x32_bf16 v[88:103], v[76:79], v[128:135], v42
    ds_read2st64_b64 v[64:67], v43 offset0:130 offset1:131
    v_exp_f32 v138, v138
    v_exp_f32 v139, v139
    v_exp_f32 v140, v140
    v_exp_f32 v141, v141
    v_mfma_f32_32x32x16_bf16 v[152:167], v[68:71], v[52:55], v[152:167]
    v_exp_f32 v142, v142
    v_exp_f32 v143, v143
    v_exp_f32 v144, v144
    v_exp_f32 v145, v145
    v_smfmac_f32_32x32x32_bf16 v[104:119], v[72:75], v[136:143], v42
    v_exp_f32 v146, v146
    v_exp_f32 v147, v147
    v_exp_f32 v148, v148
    v_exp_f32 v149, v149
    v_mfma_f32_32x32x16_bf16 v[168:183], v[68:71], v[56:59], v[168:183]
    v_exp_f32 v150, v150
    s_cmp_lg_u32 s3, 0
    s_cbranch_scc1 L33_l0
    s_waitcnt vmcnt(2)
    v_min_u32 v4, v184, v7
    v_cmp_eq_u32 vcc, 0, v4
    s_cbranch_vccnz L34_ppoll
L35_pseen:
    v_readfirstlane_b32 s66, v7
    s_nop 1
    v_cmp_ne_u32 vcc, s66, v7
    s_cmp_eq_u64 vcc, 0
    s_cselect_b32 s47, 1, 0
L33_l0:
    v_exp_f32 v151, v151
    s_setprio 1
    v_exp_f32 v152, v152
    v_exp_f32 v153, v153
    v_smfmac_f32_32x32x32_bf16 v[104:119], v[76:79], v[144:151], v42
    s_waitcnt lgkmcnt(0)
    s_add_u32 m0, s76, 122880
    s_nop 0
    buffer_load_dwordx4 v1, s[4:7], s73 offen offset:1024 sc1 lds
    v_exp_f32 v154, v154
    v_exp_f32 v155, v155
    s_and_b32 s66, s45, 15
    s_lshl_b32 s66, s66, 1
    s_lshr_b32 s78, s46, 2
    s_add_u32 s66, s66, s78
    s_mul_i32 s66, s66, 61440
    s_lshl_b32 s78, s53, 10
    s_add_u32 s78, s78, s66
    s_add_u32 s78, s78, 0x1600000
    s_add_u32 s66, s78, 0
    buffer_load_dwordx4 v[188:191], v1, s[4:7], s66 offen sc1
    v_exp_f32 v156, v156
    v_exp_f32 v157, v157
    v_mfma_f32_32x32x4_2b_bf16 v[120:151], v[62:63], v[60:61], 0
    ds_read_b64 v[62:63], v44 offset:7680
    v_exp_f32 v158, v158
    v_exp_f32 v159, v159
    v_exp_f32 v160, v160
    v_exp_f32 v161, v161
    s_mul_i32 s83, s49, 102400
    s_add_u32 s83, s83, 0x1a00000
    s_lshl_b32 s74, s46, 10
    s_add_u32 m0, s74, 0
    s_add_u32 s66, m0, s83
    buffer_load_dwordx4 v1, s[4:7], s66 offen sc1 lds
    v_exp_f32 v162, v162
    v_exp_f32 v163, v163
    v_exp_f32 v164, v164
    v_exp_f32 v165, v165
    v_smfmac_f32_32x32x32_bf16 v[88:103], v[80:83], v[152:159], v42
    s_mov_b64 exec, s[64:65]
    ds_read_b128 v[72:75], v45 offset:6400
    ds_read_b128 v[76:79], v45 offset:7040
    s_mov_b64 exec, -1
    v_exp_f32 v166, v166
    v_exp_f32 v167, v167
    v_exp_f32 v168, v168
    v_exp_f32 v169, v169
    v_smfmac_f32_32x32x32_bf16 v[88:103], v[84:87], v[160:167], v42
    ds_read2st64_b64 v[68:71], v43 offset0:135 offset1:136
    v_exp_f32 v170, v170
    v_exp_f32 v171, v171
    s_add_u32 s66, s78, 4096
    buffer_load_dwordx4 v[192:195], v1, s[4:7], s66 offen sc1
    v_exp_f32 v172, v172
    v_exp_f32 v173, v173
    v_mfma_f32_32x32x16_bf16 v[120:135], v[64:67], v[52:55], v[120:135]
    v_exp_f32 v174, v174
    v_exp_f32 v175, v175
    v_exp_f32 v176, v176
    v_exp_f32 v177, v177
    v_smfmac_f32_32x32x32_bf16 v[104:119], v[80:83], v[168:175], v42
    s_add_u32 m0, s76, 122880
    s_mov_b32 exec_hi, 0
    buffer_load_dwordx4 v1, s[4:7], s73 offen offset:2048 sc1 lds
    s_mov_b64 exec, -1
    s_add_u32 m0, s74, 8192
    s_add_u32 s66, m0, s83
    buffer_load_dwordx4 v1, s[4:7], s66 offen sc1 lds
    v_exp_f32 v178, v178
    s_setprio 0
    v_exp_f32 v179, v179
    v_exp_f32 v180, v180
    v_exp_f32 v181, v181
    v_mfma_f32_32x32x16_bf16 v[136:151], v[64:67], v[56:59], v[136:151]
    v_exp_f32 v182, v182
    v_exp_f32 v183, v183
    s_waitcnt vmcnt(10)
    s_barrier
    s_setprio 3
    v_exp_f32 v120, v120
    v_exp_f32 v121, v121
    v_smfmac_f32_32x32x32_bf16 v[104:119], v[84:87], v[176:183], v42
    s_waitcnt lgkmcnt(0)
    v_exp_f32 v122, v122
    v_exp_f32 v123, v123
    s_add_u32 s66, s78, 8192
    buffer_load_dwordx4 v[196:199], v1, s[4:7], s66 offen sc1
    v_exp_f32 v124, v124
    v_exp_f32 v125, v125
    v_mfma_f32_32x32x4_2b_bf16 v[152:183], v[62:63], v[60:61], 0
    ds_read_b64 v[62:63], v44 offset:20480
    v_exp_f32 v126, v126
    v_exp_f32 v127, v127
    v_exp_f32 v128, v128
    v_exp_f32 v129, v129
    s_add_u32 m0, s74, 16384
    s_add_u32 s66, m0, s83
    buffer_load_dwordx4 v1, s[4:7], s66 offen sc1 lds
    v_exp_f32 v130, v130
    v_exp_f32 v131, v131
    v_exp_f32 v132, v132
    v_exp_f32 v133, v133
    v_smfmac_f32_32x32x32_bf16 v[88:103], v[72:75], v[120:127], v42
    s_mov_b64 exec, s[64:65]
    ds_read_b128 v[80:83], v45 offset:8960
    ds_read_b128 v[84:87], v45 offset:9600
    s_mov_b64 exec, -1
    v_exp_f32 v134, v134
    v_exp_f32 v135, v135
    v_exp_f32 v136, v136
    v_exp_f32 v137, v137
    v_smfmac_f32_32x32x32_bf16 v[88:103], v[76:79], v[128:135], v42
    ds_read2st64_b64 v[64:67], v43 offset0:160 offset1:161
    v_exp_f32 v138, v138
    v_exp_f32 v139, v139
    s_add_u32 s66, s78, 12288
    buffer_load_dwordx4 v[200:203], v1, s[4:7], s66 offen sc1
    v_exp_f32 v140, v140
    v_exp_f32 v141, v141
    v_mfma_f32_32x32x16_bf16 v[152:167], v[68:71], v[52:55], v[152:167]
    v_exp_f32 v142, v142
    v_exp_f32 v143, v143
    v_exp_f32 v144, v144
    v_exp_f32 v145, v145
    v_smfmac_f32_32x32x32_bf16 v[104:119], v[72:75], v[136:143], v42
    s_add_u32 m0, s74, 24576
    s_add_u32 s66, m0, s83
    buffer_load_dwordx4 v1, s[4:7], s66 offen sc1 lds
    v_exp_f32 v146, v146
    v_exp_f32 v147, v147
    v_exp_f32 v148, v148
    v_exp_f32 v149, v149
    v_mfma_f32_32x32x16_bf16 v[168:183], v[68:71], v[56:59], v[168:183]
    v_exp_f32 v150, v150
    v_exp_f32 v151, v151
    v_exp_f32 v152, v152
    v_exp_f32 v153, v153
    v_smfmac_f32_32x32x32_bf16 v[104:119], v[76:79], v[144:151], v42
    s_waitcnt lgkmcnt(0)
    v_exp_f32 v154, v154
    v_exp_f32 v155, v155
    s_add_u32 s66, s78, 16384
    buffer_load_dwordx4 v[204:207], v1, s[4:7], s66 offen sc1
    v_exp_f32 v156, v156
    v_exp_f32 v157, v157
    v_mfma_f32_32x32x4_2b_bf16 v[120:151], v[62:63], v[60:61], 0
    ds_read_b64 v[62:63], v44 offset:23040
    v_exp_f32 v158, v158
    v_exp_f32 v159, v159
    v_exp_f32 v160, v160
    v_exp_f32 v161, v161
    s_add_u32 m0, s74, 32768
    s_add_u32 s66, m0, s83
    buffer_load_dwordx4 v1, s[4:7], s66 offen sc1 lds
    v_exp_f32 v162, v162
    v_exp_f32 v163, v163
    v_exp_f32 v164, v164
    v_exp_f32 v165, v165
    v_smfmac_f32_32x32x32_bf16 v[88:103], v[80:83], v[152:159], v42
    s_mov_b64 exec, s[64:65]
    ds_read_b128 v[72:75], v45 offset:21760
    ds_read_b128 v[76:79], v45 offset:22400
    s_mov_b64 exec, -1
    v_exp_f32 v166, v166
    v_exp_f32 v167, v167
    v_exp_f32 v168, v168
    v_exp_f32 v169, v169
    v_smfmac_f32_32x32x32_bf16 v[88:103], v[84:87], v[160:167], v42
    ds_read2st64_b64 v[68:71], v43 offset0:165 offset1:166
    v_exp_f32 v170, v170
    v_exp_f32 v171, v171
    s_add_u32 s66, s78, 20480
    buffer_load_dwordx4 v[208:211], v1, s[4:7], s66 offen sc1
    v_exp_f32 v172, v172
    v_exp_f32 v173, v173
    v_mfma_f32_32x32x16_bf16 v[120:135], v[64:67], v[52:55], v[120:135]
    v_exp_f32 v174, v174
    v_exp_f32 v175, v175
    v_exp_f32 v176, v176
    v_exp_f32 v177, v177
    v_smfmac_f32_32x32x32_bf16 v[104:119], v[80:83], v[168:175], v42
    s_add_u32 m0, s74, 40960
    s_add_u32 s66, m0, s83
    buffer_load_dwordx4 v1, s[4:7], s66 offen sc1 lds
    v_exp_f32 v178, v178
    v_exp_f32 v179, v179
    v_exp_f32 v180, v180
    v_exp_f32 v181, v181
    v_mfma_f32_32x32x16_bf16 v[136:151], v[64:67], v[56:59], v[136:151]
    v_exp_f32 v182, v182
    v_exp_f32 v183, v183
    s_setprio 2
    v_exp_f32 v120, v120
    v_exp_f32 v121, v121
    v_smfmac_f32_32x32x32_bf16 v[104:119], v[84:87], v[176:183], v42
    s_waitcnt lgkmcnt(0)
    v_exp_f32 v122, v122
    v_exp_f32 v123, v123
    s_add_u32 s66, s78, 24576
    buffer_load_dwordx4 v[36:39], v1, s[4:7], s66 offen sc1
    v_exp_f32 v124, v124
    v_exp_f32 v125, v125
    v_mfma_f32_32x32x4_2b_bf16 v[152:183], v[62:63], v[60:61], 0
    ds_read_b64 v[62:63], v44 offset:25600
    v_exp_f32 v126, v126
    v_exp_f32 v127, v127
    v_exp_f32 v128, v128
    v_exp_f32 v129, v129
    s_add_u32 m0, s74, 49152
    s_add_u32 s66, m0, s83
    buffer_load_dwordx4 v1, s[4:7], s66 offen sc1 lds
    v_exp_f32 v130, v130
    v_exp_f32 v131, v131
    v_exp_f32 v132, v132
    v_exp_f32 v133, v133
    v_smfmac_f32_32x32x32_bf16 v[88:103], v[72:75], v[120:127], v42
    s_mov_b64 exec, s[64:65]
    ds_read_b128 v[80:83], v45 offset:24320
    ds_read_b128 v[84:87], v45 offset:24960
    s_mov_b64 exec, -1
    v_exp_f32 v134, v134
    v_exp_f32 v135, v135
    v_exp_f32 v136, v136
    v_exp_f32 v137, v137
    v_smfmac_f32_32x32x32_bf16 v[88:103], v[76:79], v[128:135], v42
    ds_read2st64_b64 v[64:67], v43 offset0:170 offset1:171
    v_exp_f32 v138, v138
    v_exp_f32 v139, v139
    s_cmp_ge_u32 s46, 4
    s_cbranch_scc1 L40_plh
    s_add_u32 s66, s78, 28672
    buffer_load_dwordx4 v[32:35], v1, s[4:7], s66 offen sc1
L41_pld:
    v_exp_f32 v140, v140
    v_exp_f32 v141, v141
    v_mfma_f32_32x32x16_bf16 v[152:167], v[68:71], v[52:55], v[152:167]
    v_exp_f32 v142, v142
    v_exp_f32 v143, v143
    v_exp_f32 v144, v144
    v_exp_f32 v145, v145
    v_smfmac_f32_32x32x32_bf16 v[104:119], v[72:75], v[136:143], v42
    v_exp_f32 v146, v146
    v_exp_f32 v147, v147
    v_exp_f32 v148, v148
    v_exp_f32 v149, v149
    v_mfma_f32_32x32x16_bf16 v[168:183], v[68:71], v[56:59], v[168:183]
    v_exp_f32 v150, v150
    v_exp_f32 v151, v151
    s_setprio 1
    v_exp_f32 v152, v152
    v_exp_f32 v153, v153
    v_smfmac_f32_32x32x32_bf16 v[104:119], v[76:79], v[144:151], v42
    s_waitcnt lgkmcnt(0)
    v_exp_f32 v154, v154
    v_exp_f32 v155, v155
    s_cmp_ge_u32 s46, 4
    s_cbranch_scc1 L42_plh
    s_lshl_b32 s66, s53, 10
    s_add_u32 m0, s66, 147456
    s_add_u32 s66, s78, 45056
    buffer_load_dwordx4 v1, s[4:7], s66 offen sc1 lds
L43_pld:
    v_exp_f32 v156, v156
    v_exp_f32 v157, v157
    v_mfma_f32_32x32x4_2b_bf16 v[120:151], v[62:63], v[60:61], 0
    ds_read_b64 v[62:63], v44 offset:28160
    v_exp_f32 v158, v158
    v_exp_f32 v159, v159
    v_exp_f32 v160, v160
    v_exp_f32 v161, v161
    v_exp_f32 v162, v162
    v_exp_f32 v163, v163
    v_exp_f32 v164, v164
    v_exp_f32 v165, v165
    v_smfmac_f32_32x32x32_bf16 v[88:103], v[80:83], v[152:159], v42
    s_mov_b64 exec, s[64:65]
    ds_read_b128 v[72:75], v45 offset:26880
    ds_read_b128 v[76:79], v45 offset:27520
    s_mov_b64 exec, -1
    v_exp_f32 v166, v166
    v_exp_f32 v167, v167
    v_exp_f32 v168, v168
    v_exp_f32 v169, v169
    v_smfmac_f32_32x32x32_bf16 v[88:103], v[84:87], v[160:167], v42
    ds_read2st64_b64 v[68:71], v43 offset0:175 offset1:176
    v_exp_f32 v170, v170
    v_exp_f32 v171, v171
    s_cmp_ge_u32 s46, 4
    s_cbranch_scc1 L44_plh
    s_lshl_b32 s66, s53, 10
    s_add_u32 m0, s66, 151552
    s_add_u32 s66, s78, 49152
    buffer_load_dwordx4 v1, s[4:7], s66 offen sc1 lds
L45_pld:
    v_exp_f32 v172, v172
    v_exp_f32 v173, v173
    v_mfma_f32_32x32x16_bf16 v[120:135], v[64:67], v[52:55], v[120:135]
    v_exp_f32 v174, v174
    v_exp_f32 v175, v175
    v_exp_f32 v176, v176
    v_exp_f32 v177, v177
    v_smfmac_f32_32x32x32_bf16 v[104:119], v[80:83], v[168:175], v42
    v_exp_f32 v178, v178
    s_setprio 0
    v_exp_f32 v179, v179
    v_exp_f32 v180, v180
    v_exp_f32 v181, v181
    v_mfma_f32_32x32x16_bf16 v[136:151], v[64:67], v[56:59], v[136:151]
    v_exp_f32 v182, v182
    v_exp_f32 v183, v183
    s_waitcnt vmcnt(20)
    s_barrier
    s_setprio 3
    v_exp_f32 v120, v120
    v_exp_f32 v121, v121
    v_smfmac_f32_32x32x32_bf16 v[104:119], v[84:87], v[176:183], v42
    s_waitcnt lgkmcnt(0)
    v_exp_f32 v122, v122
    v_exp_f32 v123, v123
    s_cmp_ge_u32 s46, 4
    s_cbranch_scc1 L46_plh
    s_lshl_b32 s66, s53, 10
    s_add_u32 m0, s66, 155648
    s_add_u32 s66, s78, 53248
    buffer_load_dwordx4 v1, s[4:7], s66 offen sc1 lds
L47_pld:
    v_exp_f32 v124, v124
    v_exp_f32 v125, v125
    v_mfma_f32_32x32x4_2b_bf16 v[152:183], v[62:63], v[60:61], 0
    ds_read_b64 v[62:63], v44 offset:40960
    v_exp_f32 v126, v126
    v_exp_f32 v127, v127
    v_exp_f32 v128, v128
    v_exp_f32 v129, v129
    s_add_u32 m0, s74, 57344
    s_add_u32 s66, m0, s83
    buffer_load_dwordx4 v1, s[4:7], s66 offen sc1 lds
    v_exp_f32 v130, v130
    v_exp_f32 v131, v131
    v_exp_f32 v132, v132
    v_exp_f32 v133, v133
    v_smfmac_f32_32x32x32_bf16 v[88:103], v[72:75], v[120:127], v42
    s_mov_b64 exec, s[64:65]
    ds_read_b128 v[80:83], v45 offset:29440
    ds_read_b128 v[84:87], v45 offset:30080
    s_mov_b64 exec, -1
    v_exp_f32 v134, v134
    v_exp_f32 v135, v135
    v_exp_f32 v136, v136
    v_exp_f32 v137, v137
    v_smfmac_f32_32x32x32_bf16 v[88:103], v[76:79], v[128:135], v42
    ds_read2st64_b64 v[64:67], v43 offset0:200 offset1:201
    v_exp_f32 v138, v138
    v_exp_f32 v139, v139
    s_cmp_ge_u32 s46, 4
    s_cbranch_scc1 L48_plh
    s_lshl_b32 s66, s53, 10
    s_add_u32 m0, s66, 159744
    s_add_u32 s66, s78, 57344
    buffer_load_dwordx4 v1, s[4:7], s66 offen sc1 lds
L49_pld:
    v_exp_f32 v140, v140
    v_exp_f32 v141, v141
    v_mfma_f32_32x32x16_bf16 v[152:167], v[68:71], v[52:55], v[152:167]
    v_exp_f32 v142, v142
    v_exp_f32 v143, v143
    v_exp_f32 v144, v144
    v_exp_f32 v145, v145
    v_smfmac_f32_32x32x32_bf16 v[104:119], v[72:75], v[136:143], v42
    s_add_u32 m0, s74, 65536
    s_add_u32 s66, m0, s83
    buffer_load_dwordx4 v1, s[4:7], s66 offen sc1 lds
    v_exp_f32 v146, v146
    v_exp_f32 v147, v147
    s_and_b32 s66, s45, 15
    s_mul_i32 s66, s66, 122880
    s_lshr_b32 s67, s45, 4
    s_lshl_b32 s67, s67, 3
    s_add_u32 s67, s67, s46
    s_mul_i32 s67, s67, 1280
    s_add_u32 s67, s67, s66
    s_add_u32 s67, s67, 0x1800000
    v_min_u32 v51, 9, v0
    v_lshlrev_b32 v51, 7, v51
    buffer_load_dword v185, v51, s[4:7], s67 offen sc1
    v_exp_f32 v148, v148
    v_exp_f32 v149, v149
    v_mfma_f32_32x32x16_bf16 v[168:183], v[68:71], v[56:59], v[168:183]
    v_exp_f32 v150, v150
    v_exp_f32 v151, v151
    v_exp_f32 v152, v152
    v_exp_f32 v153, v153
    v_smfmac_f32_32x32x32_bf16 v[104:119], v[76:79], v[144:151], v42
    s_waitcnt lgkmcnt(0)
    v_exp_f32 v154, v154
    v_exp_f32 v155, v155
    v_exp_f32 v156, v156
    v_exp_f32 v157, v157
    v_mfma_f32_32x32x4_2b_bf16 v[120:151], v[62:63], v[60:61], 0
    ds_read_b64 v[62:63], v44 offset:43520
    v_exp_f32 v158, v158
    v_exp_f32 v159, v159
    v_exp_f32 v160, v160
    v_exp_f32 v161, v161
    s_add_u32 m0, s74, 73728
    s_add_u32 s66, m0, s83
    buffer_load_dwordx4 v1, s[4:7], s66 offen sc1 lds
    v_exp_f32 v162, v162
    v_exp_f32 v163, v163
    v_exp_f32 v164, v164
    v_exp_f32 v165, v165
    v_smfmac_f32_32x32x32_bf16 v[88:103], v[80:83], v[152:159], v42
    s_mov_b64 exec, s[64:65]
    ds_read_b128 v[72:75], v45 offset:42240
    ds_read_b128 v[76:79], v45 offset:42880
    s_mov_b64 exec, -1
    v_exp_f32 v166, v166
    v_exp_f32 v167, v167
    v_exp_f32 v168, v168
    v_exp_f32 v169, v169
    v_smfmac_f32_32x32x32_bf16 v[88:103], v[84:87], v[160:167], v42
    ds_read2st64_b64 v[68:71], v43 offset0:205 offset1:206
    v_exp_f32 v170, v170
    v_exp_f32 v171, v171
    v_exp_f32 v172, v172
    v_exp_f32 v173, v173
    v_mfma_f32_32x32x16_bf16 v[120:135], v[64:67], v[52:55], v[120:135]
    v_exp_f32 v174, v174
    v_exp_f32 v175, v175
    v_exp_f32 v176, v176
    v_exp_f32 v177, v177
    v_smfmac_f32_32x32x32_bf16 v[104:119], v[80:83], v[168:175], v42
    v_exp_f32 v178, v178
    v_exp_f32 v179, v179
    s_add_u32 s67, s67, 20480
    buffer_load_dword v186, v51, s[4:7], s67 offen sc1
    v_exp_f32 v180, v180
    v_exp_f32 v181, v181
    v_mfma_f32_32x32x16_bf16 v[136:151], v[64:67], v[56:59], v[136:151]
    v_exp_f32 v182, v182
    v_exp_f32 v183, v183
    s_setprio 2
    v_exp_f32 v120, v120
    v_exp_f32 v121, v121
    v_smfmac_f32_32x32x32_bf16 v[104:119], v[84:87], v[176:183], v42
    s_waitcnt lgkmcnt(0)
    v_exp_f32 v122, v122
    v_exp_f32 v123, v123
    v_exp_f32 v124, v124
    v_exp_f32 v125, v125
    v_mfma_f32_32x32x4_2b_bf16 v[152:183], v[62:63], v[60:61], 0
    ds_read_b64 v[62:63], v44 offset:46080
    v_exp_f32 v126, v126
    v_exp_f32 v127, v127
    v_exp_f32 v128, v128
    v_exp_f32 v129, v129
    v_exp_f32 v130, v130
    v_exp_f32 v131, v131
    v_exp_f32 v132, v132
    v_exp_f32 v133, v133
    v_smfmac_f32_32x32x32_bf16 v[88:103], v[72:75], v[120:127], v42
    s_mov_b64 exec, s[64:65]
    ds_read_b128 v[80:83], v45 offset:44800
    ds_read_b128 v[84:87], v45 offset:45440
    s_mov_b64 exec, -1
    v_exp_f32 v134, v134
    v_exp_f32 v135, v135
    v_exp_f32 v136, v136
    v_exp_f32 v137, v137
    v_smfmac_f32_32x32x32_bf16 v[88:103], v[76:79], v[128:135], v42
    ds_read2st64_b64 v[64:67], v43 offset0:210 offset1:211
    v_exp_f32 v138, v138
    v_exp_f32 v139, v139
    v_exp_f32 v140, v140
    v_exp_f32 v141, v141
    v_mfma_f32_32x32x16_bf16 v[152:167], v[68:71], v[52:55], v[152:167]
    v_exp_f32 v142, v142
    v_exp_f32 v143, v143
    v_exp_f32 v144, v144
    v_exp_f32 v145, v145
    v_smfmac_f32_32x32x32_bf16 v[104:119], v[72:75], v[136:143], v42
    v_exp_f32 v146, v146
    v_exp_f32 v147, v147
    s_add_u32 s67, s67, 20480
    buffer_load_dword v185, v51, s[4:7], s67 offen sc1
    v_exp_f32 v148, v148
    v_exp_f32 v149, v149
    v_mfma_f32_32x32x16_bf16 v[168:183], v[68:71], v[56:59], v[168:183]
    v_exp_f32 v150, v150
    v_exp_f32 v151, v151
    s_setprio 1
    v_exp_f32 v152, v152
    v_exp_f32 v153, v153
    v_smfmac_f32_32x32x32_bf16 v[104:119], v[76:79], v[144:151], v42
    s_waitcnt lgkmcnt(0)
    v_exp_f32 v154, v154
    v_exp_f32 v155, v155
    v_exp_f32 v156, v156
    v_exp_f32 v157, v157
    v_mfma_f32_32x32x4_2b_bf16 v[120:151], v[62:63], v[60:61], 0
    ds_read_b64 v[62:63], v44 offset:48640
    v_exp_f32 v158, v158
    v_exp_f32 v159, v159
    v_exp_f32 v160, v160
    v_exp_f32 v161, v161
    v_exp_f32 v162, v162
    v_exp_f32 v163, v163
    v_exp_f32 v164, v164
    v_exp_f32 v165, v165
    v_smfmac_f32_32x32x32_bf16 v[88:103], v[80:83], v[152:159], v42
    s_mov_b64 exec, s[64:65]
    ds_read_b128 v[72:75], v45 offset:47360
    ds_read_b128 v[76:79], v45 offset:48000
    s_mov_b64 exec, -1
    v_exp_f32 v166, v166
    v_exp_f32 v167, v167
    v_exp_f32 v168, v168
    v_exp_f32 v169, v169
    v_smfmac_f32_32x32x32_bf16 v[88:103], v[84:87], v[160:167], v42
    ds_read2st64_b64 v[68:71], v43 offset0:215 offset1:216
    v_exp_f32 v170, v170
    v_exp_f32 v171, v171
    v_exp_f32 v172, v172
    v_exp_f32 v173, v173
    v_mfma_f32_32x32x16_bf16 v[120:135], v[64:67], v[52:55], v[120:135]
    v_exp_f32 v174, v174
    v_exp_f32 v175, v175
    v_exp_f32 v176, v176
    v_exp_f32 v177, v177
    v_smfmac_f32_32x32x32_bf16 v[104:119], v[80:83], v[168:175], v42
    v_exp_f32 v178, v178
    s_setprio 0
    v_exp_f32 v179, v179
    s_add_u32 s67, s67, 20480
    buffer_load_dword v186, v51, s[4:7], s67 offen sc1
    v_exp_f32 v180, v180
    v_exp_f32 v181, v181
    v_mfma_f32_32x32x16_bf16 v[136:151], v[64:67], v[56:59], v[136:151]
    v_exp_f32 v182, v182
    v_exp_f32 v183, v183
    s_waitcnt vmcnt(23)
    s_barrier
    s_setprio 3
    v_exp_f32 v120, v120
    v_exp_f32 v121, v121
    v_smfmac_f32_32x32x32_bf16 v[104:119], v[84:87], v[176:183], v42
    s_waitcnt lgkmcnt(0)
    v_exp_f32 v122, v122
    v_exp_f32 v123, v123
    v_exp_f32 v124, v124
    v_exp_f32 v125, v125
    v_mfma_f32_32x32x4_2b_bf16 v[152:183], v[62:63], v[60:61], 0
    v_add_u32 v44, 0xf000, v44
    ds_read_b64 v[62:63], v44 offset:0
    v_exp_f32 v126, v126
    v_exp_f32 v127, v127
    v_exp_f32 v128, v128
    v_exp_f32 v129, v129
    s_add_u32 m0, s76, 81920
    s_add_u32 s66, m0, s83
    buffer_load_dwordx4 v1, s[4:7], s66 offen sc1 lds
    v_exp_f32 v130, v130
    v_exp_f32 v131, v131
    v_exp_f32 v132, v132
    v_exp_f32 v133, v133
    v_smfmac_f32_32x32x32_bf16 v[88:103], v[72:75], v[120:127], v42
    s_mov_b64 exec, s[64:65]
    ds_read_b128 v[80:83], v45 offset:49920
    ds_read_b128 v[84:87], v45 offset:50560
    s_mov_b64 exec, -1
    v_exp_f32 v134, v134
    v_exp_f32 v135, v135
    v_exp_f32 v136, v136
    v_exp_f32 v137, v137
    v_smfmac_f32_32x32x32_bf16 v[88:103], v[76:79], v[128:135], v42
    v_add_u32 v43, 0x1e000, v43
    ds_read2st64_b64 v[64:67], v43 offset0:0 offset1:1
    v_exp_f32 v138, v138
    v_exp_f32 v139, v139
    v_exp_f32 v140, v140
    v_exp_f32 v141, v141
    v_mfma_f32_32x32x16_bf16 v[152:167], v[68:71], v[52:55], v[152:167]
    v_exp_f32 v142, v142
    v_exp_f32 v143, v143
    v_exp_f32 v144, v144
    v_exp_f32 v145, v145
    v_smfmac_f32_32x32x32_bf16 v[104:119], v[72:75], v[136:143], v42
    s_add_u32 m0, s76, 82944
    s_add_u32 s66, m0, s83
    buffer_load_dwordx4 v1, s[4:7], s66 offen sc1 lds
    v_exp_f32 v146, v146
    v_exp_f32 v147, v147
    s_add_u32 s67, s67, 20480
    buffer_load_dword v185, v51, s[4:7], s67 offen sc1
    v_exp_f32 v148, v148
    v_exp_f32 v149, v149
    v_mfma_f32_32x32x16_bf16 v[168:183], v[68:71], v[56:59], v[168:183]
    v_exp_f32 v150, v150
    v_exp_f32 v151, v151
    v_exp_f32 v152, v152
    v_exp_f32 v153, v153
    v_smfmac_f32_32x32x32_bf16 v[104:119], v[76:79], v[144:151], v42
    s_waitcnt lgkmcnt(0)
    v_exp_f32 v154, v154
    v_exp_f32 v155, v155
    v_exp_f32 v156, v156
    v_exp_f32 v157, v157
    v_mfma_f32_32x32x4_2b_bf16 v[120:151], v[62:63], v[60:61], 0
    ds_read_b64 v[62:63], v44 offset:2560
    v_exp_f32 v158, v158
    v_exp_f32 v159, v159
    v_exp_f32 v160, v160
    v_exp_f32 v161, v161
    s_add_u32 m0, s76, 83968
    s_add_u32 s66, m0, s83
    s_mov_b32 exec_hi, 0
    buffer_load_dwordx4 v1, s[4:7], s66 offen sc1 lds
    s_mov_b64 exec, -1
    v_exp_f32 v162, v162
    v_exp_f32 v163, v163
    v_exp_f32 v164, v164
    v_exp_f32 v165, v165
    v_smfmac_f32_32x32x32_bf16 v[88:103], v[80:83], v[152:159], v42
    v_add_u32 v45, 0xf000, v45
    s_mov_b64 exec, s[64:65]
    ds_read_b128 v[72:75], v45 offset:1280
    ds_read_b128 v[76:79], v45 offset:1920
    s_mov_b64 exec, -1
    v_exp_f32 v166, v166
    v_exp_f32 v167, v167
    v_exp_f32 v168, v168
    v_exp_f32 v169, v169
    v_smfmac_f32_32x32x32_bf16 v[88:103], v[84:87], v[160:167], v42
    ds_read2st64_b64 v[68:71], v43 offset0:5 offset1:6
    v_exp_f32 v170, v170
    v_exp_f32 v171, v171
    v_exp_f32 v172, v172
    v_exp_f32 v173, v173
    v_mfma_f32_32x32x16_bf16 v[120:135], v[64:67], v[52:55], v[120:135]
    v_exp_f32 v174, v174
    v_exp_f32 v175, v175
    v_exp_f32 v176, v176
    v_exp_f32 v177, v177
    v_smfmac_f32_32x32x32_bf16 v[104:119], v[80:83], v[168:175], v42
    v_exp_f32 v178, v178
    v_exp_f32 v179, v179
    s_add_u32 s67, s67, 20480
    buffer_load_dword v186, v51, s[4:7], s67 offen sc1
    v_exp_f32 v180, v180
    v_exp_f32 v181, v181
    v_mfma_f32_32x32x16_bf16 v[136:151], v[64:67], v[56:59], v[136:151]
    v_exp_f32 v182, v182
    v_exp_f32 v183, v183
    s_setprio 2
    v_exp_f32 v120, v120
    v_exp_f32 v121, v121
    v_smfmac_f32_32x32x32_bf16 v[104:119], v[84:87], v[176:183], v42
    s_waitcnt lgkmcnt(0)
    v_exp_f32 v122, v122
    v_exp_f32 v123, v123
    v_exp_f32 v124, v124
    v_exp_f32 v125, v125
    v_mfma_f32_32x32x4_2b_bf16 v[152:183], v[62:63], v[60:61], 0
    ds_read_b64 v[62:63], v44 offset:5120
    v_exp_f32 v126, v126
    v_exp_f32 v127, v127
    v_exp_f32 v128, v128
    v_exp_f32 v129, v129
    v_exp_f32 v130, v130
    v_exp_f32 v131, v131
    s_cmp_lg_u32 s3, 0
    s_cbranch_scc1 L50_l0
    s_cmp_eq_u32 s46, 7
    s_cbranch_scc0 L51_ct
    s_getpc_b64 s[68:69]
L52_pc:
    s_lshl_b32 s66, s45, 10
    s_add_u32 s66, s66, L_att_fin-L52_pc
    v_and_b32 v4, 7, v0
    v_lshl_add_u32 v4, v4, 7, s66
    v_min_u32 v4, L_last-L52_pc, v4
    global_load_dword v187, v4, s[68:69]
L51_ct:
L50_l0:
    s_and_b32 s66, s45, 15
    s_mul_i32 s66, s66, 122880
    s_lshr_b32 s67, s45, 4
    s_lshl_b32 s67, s67, 3
    s_add_u32 s67, s67, s46
    s_mul_i32 s67, s67, 768
    s_add_u32 s67, s67, s66
    s_add_u32 s67, s67, 0x1608000
    v_min_u32 v51, 5, v0
    v_lshlrev_b32 v51, 7, v51
    buffer_load_dword v185, v51, s[4:7], s67 offen sc1
    v_exp_f32 v132, v132
    v_exp_f32 v133, v133
    v_smfmac_f32_32x32x32_bf16 v[88:103], v[72:75], v[120:127], v42
    s_mov_b64 exec, s[64:65]
    ds_read_b128 v[80:83], v45 offset:3840
    ds_read_b128 v[84:87], v45 offset:4480
    s_mov_b64 exec, -1
    v_exp_f32 v134, v134
    v_exp_f32 v135, v135
    v_exp_f32 v136, v136
    v_exp_f32 v137, v137
    v_smfmac_f32_32x32x32_bf16 v[88:103], v[76:79], v[128:135], v42
    ds_read2st64_b64 v[64:67], v43 offset0:10 offset1:11
    v_exp_f32 v138, v138
    v_exp_f32 v139, v139
    v_exp_f32 v140, v140
    v_exp_f32 v141, v141
    v_mfma_f32_32x32x16_bf16 v[152:167], v[68:71], v[52:55], v[152:167]
    v_exp_f32 v142, v142
    v_exp_f32 v143, v143
    v_exp_f32 v144, v144
    v_exp_f32 v145, v145
    v_smfmac_f32_32x32x32_bf16 v[104:119], v[72:75], v[136:143], v42
    v_exp_f32 v146, v146
    v_exp_f32 v147, v147
    s_add_u32 s67, s67, 77824
    buffer_load_dword v186, v51, s[4:7], s67 offen sc1
    v_exp_f32 v148, v148
    v_exp_f32 v149, v149
    v_mfma_f32_32x32x16_bf16 v[168:183], v[68:71], v[56:59], v[168:183]
    v_exp_f32 v150, v150
    v_exp_f32 v151, v151
    s_setprio 1
    v_exp_f32 v152, v152
    v_exp_f32 v153, v153
    v_smfmac_f32_32x32x32_bf16 v[104:119], v[76:79], v[144:151], v42
    s_waitcnt lgkmcnt(0)
    v_exp_f32 v154, v154
    v_exp_f32 v155, v155
    v_exp_f32 v156, v156
    v_exp_f32 v157, v157
    v_mfma_f32_32x32x4_2b_bf16 v[120:151], v[62:63], v[60:61], 0
    ds_read_b64 v[62:63], v44 offset:7680
    v_exp_f32 v158, v158
    v_exp_f32 v159, v159
    v_exp_f32 v160, v160
    v_exp_f32 v161, v161
    v_exp_f32 v162, v162
    v_exp_f32 v163, v163
    s_cmp_eq_u32 s46, 6
    s_cbranch_scc0 L53_bt
    v_lshlrev_b32 v4, 7, v40
    buffer_load_dword v187, v4, s[24:27], 0 offen
    buffer_load_dword v187, v4, s[28:31], 0 offen
L53_bt:
    s_lshl_b32 s67, s44, 5
    s_add_u32 s67, s67, s45
    s_lshl_b32 s67, s67, 3
    s_add_u32 s67, s67, s46
    s_mul_i32 s67, s67, 3136
    s_add_u32 s67, s67, 0x300000
    v_min_u32 v51, 12, v0
    v_lshlrev_b32 v51, 7, v51
    buffer_load_dword v185, v51, s[4:7], s67 offen sc1
    v_exp_f32 v164, v164
    v_exp_f32 v165, v165
    v_smfmac_f32_32x32x32_bf16 v[88:103], v[80:83], v[152:159], v42
    s_mov_b64 exec, s[64:65]
    ds_read_b128 v[72:75], v45 offset:6400
    ds_read_b128 v[76:79], v45 offset:7040
    s_mov_b64 exec, -1
    v_exp_f32 v166, v166
    v_exp_f32 v167, v167
    v_exp_f32 v168, v168
    v_exp_f32 v169, v169
    v_smfmac_f32_32x32x32_bf16 v[88:103], v[84:87], v[160:167], v42
    ds_read2st64_b64 v[68:71], v43 offset0:15 offset1:16
    v_exp_f32 v170, v170
    v_exp_f32 v171, v171
    v_exp_f32 v172, v172
    v_exp_f32 v173, v173
    v_mfma_f32_32x32x16_bf16 v[120:135], v[64:67], v[52:55], v[120:135]
    v_exp_f32 v174, v174
    v_exp_f32 v175, v175
    v_exp_f32 v176, v176
    v_exp_f32 v177, v177
    v_smfmac_f32_32x32x32_bf16 v[104:119], v[80:83], v[168:175], v42
    v_exp_f32 v178, v178
    s_setprio 0
    v_exp_f32 v179, v179
    s_add_u32 s67, s67, 1536
    buffer_load_dword v186, v51, s[4:7], s67 offen sc1
    v_exp_f32 v180, v180
    v_exp_f32 v181, v181
    v_mfma_f32_32x32x16_bf16 v[136:151], v[64:67], v[56:59], v[136:151]
    v_exp_f32 v182, v182
    v_exp_f32 v183, v183
    s_barrier
    s_setprio 3
    v_exp_f32 v120, v120
    v_exp_f32 v121, v121
    v_smfmac_f32_32x32x32_bf16 v[104:119], v[84:87], v[176:183], v42
    s_waitcnt lgkmcnt(0)
    v_exp_f32 v122, v122
    v_exp_f32 v123, v123
    v_exp_f32 v124, v124
    v_exp_f32 v125, v125
    v_mfma_f32_32x32x4_2b_bf16 v[152:183], v[62:63], v[60:61], 0
    v_exp_f32 v126, v126
    v_exp_f32 v127, v127
    v_exp_f32 v128, v128
    v_exp_f32 v129, v129
    v_exp_f32 v130, v130
    v_exp_f32 v131, v131
    s_lshl_b32 s67, s44, 5
    s_add_u32 s67, s67, s45
    s_lshl_b32 s67, s67, 3
    s_add_u32 s67, s67, s46
    s_mul_i32 s67, s67, 1344
    s_add_u32 s67, s67, 0x0
    v_min_u32 v51, 10, v0
    v_lshlrev_b32 v51, 7, v51
    buffer_load_dword v185, v51, s[4:7], s67 offen sc1
    v_exp_f32 v132, v132
    v_exp_f32 v133, v133
    v_smfmac_f32_32x32x32_bf16 v[88:103], v[72:75], v[120:127], v42
    s_mov_b64 exec, s[64:65]
    ds_read_b128 v[80:83], v45 offset:8960
    ds_read_b128 v[84:87], v45 offset:9600
    s_mov_b64 exec, -1
    v_exp_f32 v134, v134
    v_exp_f32 v135, v135
    v_exp_f32 v136, v136
    v_exp_f32 v137, v137
    v_smfmac_f32_32x32x32_bf16 v[88:103], v[76:79], v[128:135], v42
    v_exp_f32 v138, v138
    v_exp_f32 v139, v139
    v_exp_f32 v140, v140
    v_exp_f32 v141, v141
    v_mfma_f32_32x32x16_bf16 v[152:167], v[68:71], v[52:55], v[152:167]
    v_exp_f32 v142, v142
    v_exp_f32 v143, v143
    v_exp_f32 v144, v144
    v_exp_f32 v145, v145
    v_smfmac_f32_32x32x32_bf16 v[104:119], v[72:75], v[136:143], v42
    v_exp_f32 v146, v146
    v_exp_f32 v147, v147
    v_exp_f32 v148, v148
    v_exp_f32 v149, v149
    v_mfma_f32_32x32x16_bf16 v[168:183], v[68:71], v[56:59], v[168:183]
    v_exp_f32 v150, v150
    v_exp_f32 v151, v151
    v_exp_f32 v152, v152
    s_setprio 1
    v_exp_f32 v153, v153
    v_smfmac_f32_32x32x32_bf16 v[104:119], v[76:79], v[144:151], v42
    s_waitcnt lgkmcnt(0)
    v_exp_f32 v154, v154
    v_exp_f32 v155, v155
    v_exp_f32 v156, v156
    v_exp_f32 v157, v157
    s_lshl_b32 s68, s46, 11
    s_add_u32 s68, s68, 102400
    v_add_u32 v64, s68, v1
    s_lshr_b32 s68, s46, 2
    s_mul_i32 s68, s68, 24576
    s_lshl_b32 s69, s53, 10
    s_add_u32 s68, s68, s69
    s_add_u32 s68, s68, 118784
    v_add_u32 v65, s68, v1
    s_xor_b32 s66, s46, 4
    s_lshl_b32 s68, s66, 11
    s_add_u32 s68, s68, 102400
    v_add_u32 v66, s68, v1
    s_lshr_b32 s68, s66, 2
    s_mul_i32 s68, s68, 24576
    s_lshl_b32 s69, s53, 10
    s_add_u32 s68, s68, s69
    s_add_u32 s68, s68, 118784
    v_add_u32 v67, s68, v1
    v_exp_f32 v158, v158
    v_exp_f32 v159, v159
    v_exp_f32 v160, v160
    v_exp_f32 v161, v161
    v_exp_f32 v162, v162
    v_exp_f32 v163, v163
    v_exp_f32 v164, v164
    v_exp_f32 v165, v165
    v_smfmac_f32_32x32x32_bf16 v[88:103], v[80:83], v[152:159], v42
    v_exp_f32 v166, v166
    v_exp_f32 v167, v167
    v_exp_f32 v168, v168
    v_exp_f32 v169, v169
    v_smfmac_f32_32x32x32_bf16 v[88:103], v[84:87], v[160:167], v42
    v_exp_f32 v170, v170
    v_exp_f32 v171, v171
    v_exp_f32 v172, v172
    v_exp_f32 v173, v173
    v_exp_f32 v174, v174
    v_exp_f32 v175, v175
    v_exp_f32 v176, v176
    v_exp_f32 v177, v177
    v_smfmac_f32_32x32x32_bf16 v[104:119], v[80:83], v[168:175], v42
    v_exp_f32 v178, v178
    s_setprio 0
    v_exp_f32 v179, v179
    v_exp_f32 v180, v180
    v_exp_f32 v181, v181
    ds_write_b128 v64, v[88:91] offset:0
    ds_write_b128 v64, v[92:95] offset:1024
    ds_write_b128 v65, v[96:99] offset:0
    v_exp_f32 v182, v182
    v_exp_f32 v183, v183
    s_nop 1
    v_smfmac_f32_32x32x32_bf16 v[104:119], v[84:87], v[176:183], v42
L_att_fin:
    s_waitcnt vmcnt(0) lgkmcnt(0)
    s_barrier
    ds_read_b128 v[120:123], v66 offset:0
    ds_read_b128 v[124:127], v66 offset:1024
    ds_read_b128 v[128:131], v67 offset:0
    s_lshl_b32 s66, s46, 2
    s_add_u32 s66, s66, 143328
    v_mov_b32 v6, s66
    v_and_b32 v7, 7, v0
    v_lshlrev_b32 v7, 2, v7
    v_add_u32 v7, 143328, v7
    s_mov_b32 s66, 0x33800000
    s_mov_b32 s67, 0x57800000
    s_waitcnt lgkmcnt(0)
    v_add_f32 v4, v112, v128
    v_add_f32 v5, v112, v128
    v_pk_add_f32 v[104:105], v[104:105], v[120:121]
    v_pk_add_f32 v[106:107], v[106:107], v[122:123]
    v_permlane32_swap_b32 v5, v4
    v_pk_add_f32 v[108:109], v[108:109], v[124:125]
    v_pk_add_f32 v[110:111], v[110:111], v[126:127]
    v_rcp_f32 v132, v4
    v_pk_add_f32 v[112:113], v[112:113], v[128:129]
    v_pk_add_f32 v[114:115], v[114:115], v[130:131]
    v_mov_b32 v133, v132
    v_pk_mul_f32 v[104:105], v[104:105], v[132:133]
    v_pk_mul_f32 v[106:107], v[106:107], v[132:133]
    v_pk_mul_f32 v[108:109], v[108:109], v[132:133]
    v_pk_mul_f32 v[110:111], v[110:111], v[132:133]
    v_pk_mul_f32 v[112:113], v[112:113], v[132:133]
    v_pk_mul_f32 v[114:115], v[114:115], v[132:133]
    v_cvt_pk_bf16_f32 v120, v104, v105
    v_cvt_pk_bf16_f32 v121, v106, v107
    v_cvt_pk_bf16_f32 v122, v108, v109
    v_cvt_pk_bf16_f32 v123, v110, v111
    v_cvt_pk_bf16_f32 v124, v112, v113
    v_cvt_pk_bf16_f32 v125, v114, v115
    s_cmp_eq_u32 s47, 0
    s_cbranch_scc1 L54_slow
    buffer_store_dwordx2 v[120:121], v46, s[4:7], s87 offen nt
    buffer_store_dwordx2 v[122:123], v47, s[4:7], s87 offen nt
    s_mov_b32 exec_hi, 0
    buffer_store_dwordx2 v[124:125], v48, s[4:7], s87 offen nt
    s_mov_b64 exec, -1
L55_back:
    v_mov_b64 v[134:135], 0
    v_mov_b64 v[136:137], 0
    v_cmp_nle_f32 vcc, s66, v4
    v_cmp_nge_f32 s[68:69], s67, v4
    v_pk_fma_f32 v[134:135], v[104:105], v[136:137], v[134:135]
    v_pk_fma_f32 v[134:135], v[106:107], v[136:137], v[134:135]
    v_pk_fma_f32 v[134:135], v[108:109], v[136:137], v[134:135]
    v_pk_fma_f32 v[134:135], v[110:111], v[136:137], v[134:135]
    v_pk_fma_f32 v[134:135], v[112:113], v[136:137], v[134:135]
    v_pk_fma_f32 v[134:135], v[114:115], v[136:137], v[134:135]
    s_or_b64 vcc, vcc, s[68:69]
    v_cmp_u_f32 s[70:71], v134, v135
    s_or_b64 vcc, vcc, s[70:71]
    s_cselect_b32 s66, 1, 0
    v_mov_b32 v5, s66
    ds_write_b32 v6, v5
    s_waitcnt lgkmcnt(0)
    s_barrier
    ds_read_b32 v5, v7
    s_add_u32 s72, s3, 1
    s_waitcnt lgkmcnt(0)
    v_cmp_lt_u32 vcc, s86, v5
    s_cbranch_vccnz L_att_redo
    v_mov_b32 v4, s72
    v_mov_b32 v5, 0
    s_waitcnt vmcnt(0)
    s_mov_b64 exec, 1
    s_cmp_eq_u32 s47, 0
    s_cbranch_scc1 L56_slow
    buffer_store_dword v4, v5, s[4:7], s88 offen
L57_back:
    s_mov_b64 exec, -1
    s_cmp_ge_u32 s46, 4
    s_cbranch_scc1 L_ch_h
    s_setprio 1
    s_and_b32 s68, s62, -256
    s_add_u32 s68, s68, 128
    v_and_b32 v6, 31, v0
    v_lshlrev_b32 v6, 2, v6
    s_lshl_b32 s66, s46, 10
    s_add_u32 s66, s66, 102400
    v_add_u32 v4, s66, v1
    s_mul_i32 s81, s63, 50176
    s_add_u32 s81, s81, 0x300000
    s_add_u32 s82, s81, 4096
    s_add_u32 s73, s81, 8192
    s_add_u32 s74, s81, 12288
    s_add_u32 s75, s81, 16384
    v_add_u32 v40, 61440, v1
    v_lshlrev_b32 v5, 3, v3
    ds_write_b128 v4, v[188:191] offset:0
    ds_write_b128 v4, v[192:195] offset:4096
    ds_write_b128 v4, v[196:199] offset:8192
    buffer_load_dword v7, v6, s[4:7], s68 offen sc1
    ds_write_b128 v4, v[200:203] offset:12288
    ds_write_b128 v4, v[204:207] offset:16384
    ds_write_b128 v4, v[208:211] offset:20480
    ds_write_b128 v4, v[36:39] offset:24576
    ds_write_b128 v4, v[32:35] offset:28672
    s_waitcnt vmcnt(0)
    v_cmp_gt_u32 vcc, s72, v7
    s_cbranch_vccnz L58_poll
L59_seen:
    buffer_load_dwordx4 v[144:147], v1, s[4:7], s81 offen offset:0 sc1
    buffer_load_dwordx4 v[148:151], v1, s[4:7], s81 offen offset:1024 sc1
    buffer_load_dwordx4 v[152:155], v1, s[4:7], s81 offen offset:2048 sc1
    ds_read_b128 v[56:59], v1 offset:0
    ds_read_b128 v[60:63], v1 offset:1024
    ds_read_b128 v[64:67], v1 offset:2048
    ds_read_b128 v[68:71], v1 offset:3072
    ds_read_b128 v[72:75], v1 offset:4096
    ds_read_b128 v[76:79], v1 offset:5120
    ds_read_b128 v[80:83], v1 offset:6144
    ds_read_b128 v[84:87], v1 offset:7168
    s_waitcnt vmcnt(2) lgkmcnt(6)
    v_mfma_f32_16x16x32_bf16 v[8:11], v[56:59], v[144:147], v[8:11]
    ds_read_b128 v[56:59], v1 offset:8192
    buffer_load_dwordx4 v[156:159], v1, s[4:7], s81 offen offset:3072 sc1
    v_mfma_f32_16x16x32_bf16 v[12:15], v[60:63], v[144:147], v[12:15]
    ds_read_b128 v[60:63], v1 offset:9216
    s_waitcnt lgkmcnt(6)
    v_mfma_f32_16x16x32_bf16 v[16:19], v[64:67], v[144:147], v[16:19]
    ds_read_b128 v[64:67], v1 offset:10240
    buffer_load_dwordx4 v[160:163], v1, s[4:7], s82 offen offset:0 sc1
    v_mfma_f32_16x16x32_bf16 v[20:23], v[68:71], v[144:147], v[20:23]
    ds_read_b128 v[68:71], v1 offset:11264
    s_waitcnt lgkmcnt(7)
    v_mfma_f32_16x16x32_bf16 v[24:27], v[72:75], v[144:147], v[24:27]
    ds_read_b128 v[72:75], v1 offset:12288
    s_waitcnt vmcnt(3) lgkmcnt(6)
    v_mfma_f32_16x16x32_bf16 v[8:11], v[76:79], v[148:151], v[8:11]
    ds_read_b128 v[76:79], v1 offset:13312
    buffer_load_dwordx4 v[164:167], v1, s[4:7], s82 offen offset:1024 sc1
    v_mfma_f32_16x16x32_bf16 v[12:15], v[80:83], v[148:151], v[12:15]
    ds_read_b128 v[80:83], v1 offset:14336
    s_waitcnt lgkmcnt(6)
    v_mfma_f32_16x16x32_bf16 v[16:19], v[84:87], v[148:151], v[16:19]
    ds_read_b128 v[84:87], v1 offset:15360
    buffer_load_dwordx4 v[168:171], v1, s[4:7], s82 offen offset:2048 sc1
    v_mfma_f32_16x16x32_bf16 v[20:23], v[56:59], v[148:151], v[20:23]
    ds_read_b128 v[56:59], v1 offset:16384
    s_waitcnt lgkmcnt(7)
    v_mfma_f32_16x16x32_bf16 v[24:27], v[60:63], v[148:151], v[24:27]
    ds_read_b128 v[60:63], v1 offset:17408
    s_barrier
    s_waitcnt vmcnt(4) lgkmcnt(6)
    v_mfma_f32_16x16x32_bf16 v[8:11], v[64:67], v[152:155], v[8:11]
    ds_read_b128 v[64:67], v1 offset:18432
    buffer_load_dwordx4 v[172:175], v1, s[4:7], s82 offen offset:3072 sc1
    v_mfma_f32_16x16x32_bf16 v[12:15], v[68:71], v[152:155], v[12:15]
    ds_read_b128 v[68:71], v1 offset:19456
    s_waitcnt lgkmcnt(6)
    v_mfma_f32_16x16x32_bf16 v[16:19], v[72:75], v[152:155], v[16:19]
    ds_read_b128 v[72:75], v1 offset:20480
    buffer_load_dwordx4 v[176:179], v1, s[4:7], s73 offen offset:0 sc1
    v_mfma_f32_16x16x32_bf16 v[20:23], v[76:79], v[152:155], v[20:23]
    ds_read_b128 v[76:79], v1 offset:21504
    s_waitcnt lgkmcnt(7)
    v_mfma_f32_16x16x32_bf16 v[24:27], v[80:83], v[152:155], v[24:27]
    ds_read_b128 v[80:83], v1 offset:22528
    s_waitcnt vmcnt(5) lgkmcnt(6)
    v_mfma_f32_16x16x32_bf16 v[8:11], v[84:87], v[156:159], v[8:11]
    ds_read_b128 v[84:87], v1 offset:23552
    buffer_load_dwordx4 v[180:183], v1, s[4:7], s73 offen offset:1024 sc1
    v_mfma_f32_16x16x32_bf16 v[12:15], v[56:59], v[156:159], v[12:15]
    ds_read_b128 v[56:59], v1 offset:24576
    s_waitcnt lgkmcnt(6)
    v_mfma_f32_16x16x32_bf16 v[16:19], v[60:63], v[156:159], v[16:19]
    ds_read_b128 v[60:63], v1 offset:25600
    v_mfma_f32_16x16x32_bf16 v[20:23], v[64:67], v[156:159], v[20:23]
    ds_read_b128 v[64:67], v1 offset:26624
    s_waitcnt lgkmcnt(7)
    v_mfma_f32_16x16x32_bf16 v[24:27], v[68:71], v[156:159], v[24:27]
    ds_read_b128 v[68:71], v1 offset:27648
    s_waitcnt vmcnt(5) lgkmcnt(6)
    v_mfma_f32_16x16x32_bf16 v[8:11], v[72:75], v[160:163], v[8:11]
    ds_read_b128 v[72:75], v1 offset:28672
    buffer_load_dwordx4 v[144:147], v1, s[4:7], s73 offen offset:2048 sc1
    v_mfma_f32_16x16x32_bf16 v[12:15], v[76:79], v[160:163], v[12:15]
    ds_read_b128 v[76:79], v1 offset:29696
    s_waitcnt lgkmcnt(6)
    v_mfma_f32_16x16x32_bf16 v[16:19], v[80:83], v[160:163], v[16:19]
    ds_read_b128 v[80:83], v1 offset:30720
    v_mfma_f32_16x16x32_bf16 v[20:23], v[84:87], v[160:163], v[20:23]
    ds_read_b128 v[84:87], v1 offset:31744
    s_waitcnt lgkmcnt(7)
    v_mfma_f32_16x16x32_bf16 v[24:27], v[56:59], v[160:163], v[24:27]
    ds_read_b128 v[56:59], v1 offset:32768
    s_waitcnt vmcnt(5) lgkmcnt(6)
    v_mfma_f32_16x16x32_bf16 v[8:11], v[60:63], v[164:167], v[8:11]
    ds_read_b128 v[60:63], v1 offset:33792
    buffer_load_dwordx4 v[148:151], v1, s[4:7], s73 offen offset:3072 sc1
    v_mfma_f32_16x16x32_bf16 v[12:15], v[64:67], v[164:167], v[12:15]
    ds_read_b128 v[64:67], v1 offset:34816
    s_waitcnt lgkmcnt(6)
    v_mfma_f32_16x16x32_bf16 v[16:19], v[68:71], v[164:167], v[16:19]
    ds_read_b128 v[68:71], v1 offset:35840
    v_mfma_f32_16x16x32_bf16 v[20:23], v[72:75], v[164:167], v[20:23]
    ds_read_b128 v[72:75], v1 offset:36864
    s_waitcnt lgkmcnt(7)
    v_mfma_f32_16x16x32_bf16 v[24:27], v[76:79], v[164:167], v[24:27]
    ds_read_b128 v[76:79], v1 offset:37888
    s_waitcnt vmcnt(5) lgkmcnt(6)
    v_mfma_f32_16x16x32_bf16 v[8:11], v[80:83], v[168:171], v[8:11]
    ds_read_b128 v[80:83], v1 offset:38912
    buffer_load_dwordx4 v[152:155], v1, s[4:7], s74 offen offset:0 sc1
    v_mfma_f32_16x16x32_bf16 v[12:15], v[84:87], v[168:171], v[12:15]
    ds_read_b128 v[84:87], v1 offset:39936
    s_waitcnt lgkmcnt(6)
    v_mfma_f32_16x16x32_bf16 v[16:19], v[56:59], v[168:171], v[16:19]
    ds_read_b128 v[56:59], v1 offset:40960
    v_mfma_f32_16x16x32_bf16 v[20:23], v[60:63], v[168:171], v[20:23]
    ds_read_b128 v[60:63], v1 offset:41984
    s_waitcnt lgkmcnt(7)
    v_mfma_f32_16x16x32_bf16 v[24:27], v[64:67], v[168:171], v[24:27]
    ds_read_b128 v[64:67], v1 offset:43008
    s_waitcnt vmcnt(5) lgkmcnt(6)
    v_mfma_f32_16x16x32_bf16 v[8:11], v[68:71], v[172:175], v[8:11]
    ds_read_b128 v[68:71], v1 offset:44032
    buffer_load_dwordx4 v[156:159], v1, s[4:7], s74 offen offset:1024 sc1
    v_mfma_f32_16x16x32_bf16 v[12:15], v[72:75], v[172:175], v[12:15]
    ds_read_b128 v[72:75], v1 offset:45056
    s_waitcnt lgkmcnt(6)
    v_mfma_f32_16x16x32_bf16 v[16:19], v[76:79], v[172:175], v[16:19]
    ds_read_b128 v[76:79], v1 offset:46080
    v_mfma_f32_16x16x32_bf16 v[20:23], v[80:83], v[172:175], v[20:23]
    ds_read_b128 v[80:83], v1 offset:47104
    s_waitcnt lgkmcnt(7)
    v_mfma_f32_16x16x32_bf16 v[24:27], v[84:87], v[172:175], v[24:27]
    ds_read_b128 v[84:87], v1 offset:48128
    s_waitcnt vmcnt(5) lgkmcnt(6)
    v_mfma_f32_16x16x32_bf16 v[8:11], v[56:59], v[176:179], v[8:11]
    ds_read_b128 v[56:59], v1 offset:49152
    buffer_load_dwordx4 v[160:163], v1, s[4:7], s74 offen offset:2048 sc1
    v_mfma_f32_16x16x32_bf16 v[12:15], v[60:63], v[176:179], v[12:15]
    ds_read_b128 v[60:63], v1 offset:50176
    s_waitcnt lgkmcnt(6)
    v_mfma_f32_16x16x32_bf16 v[16:19], v[64:67], v[176:179], v[16:19]
    ds_read_b128 v[64:67], v1 offset:51200
    v_mfma_f32_16x16x32_bf16 v[20:23], v[68:71], v[176:179], v[20:23]
    ds_read_b128 v[68:71], v1 offset:52224
    s_waitcnt lgkmcnt(7)
    v_mfma_f32_16x16x32_bf16 v[24:27], v[72:75], v[176:179], v[24:27]
    ds_read_b128 v[72:75], v1 offset:53248
    s_waitcnt vmcnt(5) lgkmcnt(6)
    v_mfma_f32_16x16x32_bf16 v[8:11], v[76:79], v[180:183], v[8:11]
    ds_read_b128 v[76:79], v1 offset:54272
    buffer_load_dwordx4 v[164:167], v1, s[4:7], s74 offen offset:3072 sc1
    v_mfma_f32_16x16x32_bf16 v[12:15], v[80:83], v[180:183], v[12:15]
    ds_read_b128 v[80:83], v1 offset:55296
    s_waitcnt lgkmcnt(6)
    v_mfma_f32_16x16x32_bf16 v[16:19], v[84:87], v[180:183], v[16:19]
    ds_read_b128 v[84:87], v1 offset:56320
    v_mfma_f32_16x16x32_bf16 v[20:23], v[56:59], v[180:183], v[20:23]
    ds_read_b128 v[56:59], v1 offset:57344
    s_waitcnt lgkmcnt(7)
    v_mfma_f32_16x16x32_bf16 v[24:27], v[60:63], v[180:183], v[24:27]
    ds_read_b128 v[60:63], v1 offset:58368
    s_waitcnt vmcnt(5) lgkmcnt(6)
    v_mfma_f32_16x16x32_bf16 v[8:11], v[64:67], v[144:147], v[8:11]
    ds_read_b128 v[64:67], v1 offset:59392
    buffer_load_dwordx4 v[168:171], v1, s[4:7], s75 offen offset:0 sc1
    v_mfma_f32_16x16x32_bf16 v[12:15], v[68:71], v[144:147], v[12:15]
    ds_read_b128 v[68:71], v1 offset:60416
    s_waitcnt lgkmcnt(6)
    v_mfma_f32_16x16x32_bf16 v[16:19], v[72:75], v[144:147], v[16:19]
    ds_read_b128 v[72:75], v40 offset:0
    v_mfma_f32_16x16x32_bf16 v[20:23], v[76:79], v[144:147], v[20:23]
    ds_read_b128 v[76:79], v40 offset:1024
    s_waitcnt lgkmcnt(7)
    v_mfma_f32_16x16x32_bf16 v[24:27], v[80:83], v[144:147], v[24:27]
    ds_read_b128 v[80:83], v40 offset:2048
    s_waitcnt vmcnt(5) lgkmcnt(6)
    v_mfma_f32_16x16x32_bf16 v[8:11], v[84:87], v[148:151], v[8:11]
    ds_read_b128 v[84:87], v40 offset:3072
    buffer_load_dwordx4 v[172:175], v1, s[4:7], s75 offen offset:1024 sc1
    v_mfma_f32_16x16x32_bf16 v[12:15], v[56:59], v[148:151], v[12:15]
    ds_read_b128 v[56:59], v40 offset:4096
    s_waitcnt lgkmcnt(6)
    v_mfma_f32_16x16x32_bf16 v[16:19], v[60:63], v[148:151], v[16:19]
    ds_read_b128 v[60:63], v40 offset:5120
    v_mfma_f32_16x16x32_bf16 v[20:23], v[64:67], v[148:151], v[20:23]
    ds_read_b128 v[64:67], v40 offset:6144
    s_waitcnt lgkmcnt(7)
    v_mfma_f32_16x16x32_bf16 v[24:27], v[68:71], v[148:151], v[24:27]
    ds_read_b128 v[68:71], v40 offset:7168
    s_waitcnt vmcnt(5) lgkmcnt(6)
    v_mfma_f32_16x16x32_bf16 v[8:11], v[72:75], v[152:155], v[8:11]
    ds_read_b128 v[72:75], v40 offset:8192
    buffer_load_dwordx4 v[176:179], v1, s[4:7], s75 offen offset:2048 sc1
    v_mfma_f32_16x16x32_bf16 v[12:15], v[76:79], v[152:155], v[12:15]
    ds_read_b128 v[76:79], v40 offset:9216
    s_waitcnt lgkmcnt(6)
    v_mfma_f32_16x16x32_bf16 v[16:19], v[80:83], v[152:155], v[16:19]
    ds_read_b128 v[80:83], v40 offset:10240
    v_mfma_f32_16x16x32_bf16 v[20:23], v[84:87], v[152:155], v[20:23]
    ds_read_b128 v[84:87], v40 offset:11264
    s_waitcnt lgkmcnt(7)
    v_mfma_f32_16x16x32_bf16 v[24:27], v[56:59], v[152:155], v[24:27]
    ds_read_b128 v[56:59], v40 offset:12288
    s_waitcnt vmcnt(5) lgkmcnt(6)
    v_mfma_f32_16x16x32_bf16 v[8:11], v[60:63], v[156:159], v[8:11]
    ds_read_b128 v[60:63], v40 offset:13312
    buffer_load_dwordx4 v[180:183], v1, s[4:7], s75 offen offset:3072 sc1
    v_mfma_f32_16x16x32_bf16 v[12:15], v[64:67], v[156:159], v[12:15]
    ds_read_b128 v[64:67], v40 offset:14336
    s_waitcnt lgkmcnt(6)
    v_mfma_f32_16x16x32_bf16 v[16:19], v[68:71], v[156:159], v[16:19]
    ds_read_b128 v[68:71], v40 offset:15360
    v_mfma_f32_16x16x32_bf16 v[20:23], v[72:75], v[156:159], v[20:23]
    ds_read_b128 v[72:75], v40 offset:16384
    s_waitcnt lgkmcnt(7)
    v_mfma_f32_16x16x32_bf16 v[24:27], v[76:79], v[156:159], v[24:27]
    ds_read_b128 v[76:79], v40 offset:17408
    s_waitcnt vmcnt(5) lgkmcnt(6)
    v_mfma_f32_16x16x32_bf16 v[8:11], v[80:83], v[160:163], v[8:11]
    ds_read_b128 v[80:83], v40 offset:18432
    v_mfma_f32_16x16x32_bf16 v[12:15], v[84:87], v[160:163], v[12:15]
    ds_read_b128 v[84:87], v40 offset:19456
    s_waitcnt lgkmcnt(6)
    v_mfma_f32_16x16x32_bf16 v[16:19], v[56:59], v[160:163], v[16:19]
    ds_read_b128 v[56:59], v40 offset:20480
    v_mfma_f32_16x16x32_bf16 v[20:23], v[60:63], v[160:163], v[20:23]
    ds_read_b128 v[60:63], v40 offset:21504
    s_waitcnt lgkmcnt(7)
    v_mfma_f32_16x16x32_bf16 v[24:27], v[64:67], v[160:163], v[24:27]
    ds_read_b128 v[64:67], v40 offset:22528
    s_waitcnt vmcnt(4) lgkmcnt(6)
    v_mfma_f32_16x16x32_bf16 v[8:11], v[68:71], v[164:167], v[8:11]
    ds_read_b128 v[68:71], v40 offset:23552
    v_mfma_f32_16x16x32_bf16 v[12:15], v[72:75], v[164:167], v[12:15]
    ds_read_b128 v[72:75], v40 offset:24576
    s_waitcnt lgkmcnt(6)
    v_mfma_f32_16x16x32_bf16 v[16:19], v[76:79], v[164:167], v[16:19]
    ds_read_b128 v[76:79], v40 offset:25600
    v_mfma_f32_16x16x32_bf16 v[20:23], v[80:83], v[164:167], v[20:23]
    ds_read_b128 v[80:83], v40 offset:26624
    s_waitcnt lgkmcnt(7)
    v_mfma_f32_16x16x32_bf16 v[24:27], v[84:87], v[164:167], v[24:27]
    ds_read_b128 v[84:87], v40 offset:27648
    s_waitcnt vmcnt(3) lgkmcnt(6)
    v_mfma_f32_16x16x32_bf16 v[8:11], v[56:59], v[168:171], v[8:11]
    ds_read_b128 v[56:59], v40 offset:28672
    v_mfma_f32_16x16x32_bf16 v[12:15], v[60:63], v[168:171], v[12:15]
    ds_read_b128 v[60:63], v40 offset:29696
    s_waitcnt lgkmcnt(6)
    v_mfma_f32_16x16x32_bf16 v[16:19], v[64:67], v[168:171], v[16:19]
    ds_read_b128 v[64:67], v40 offset:30720
    v_mfma_f32_16x16x32_bf16 v[20:23], v[68:71], v[168:171], v[20:23]
    ds_read_b128 v[68:71], v40 offset:31744
    s_waitcnt lgkmcnt(7)
    v_mfma_f32_16x16x32_bf16 v[24:27], v[72:75], v[168:171], v[24:27]
    ds_read_b128 v[72:75], v40 offset:32768
    s_waitcnt vmcnt(2) lgkmcnt(6)
    v_mfma_f32_16x16x32_bf16 v[8:11], v[76:79], v[172:175], v[8:11]
    ds_read_b128 v[76:79], v40 offset:33792
    v_mfma_f32_16x16x32_bf16 v[12:15], v[80:83], v[172:175], v[12:15]
    ds_read_b128 v[80:83], v40 offset:34816
    s_waitcnt lgkmcnt(6)
    v_mfma_f32_16x16x32_bf16 v[16:19], v[84:87], v[172:175], v[16:19]
    ds_read_b128 v[84:87], v40 offset:35840
    v_mfma_f32_16x16x32_bf16 v[20:23], v[56:59], v[172:175], v[20:23]
    ds_read_b128 v[56:59], v40 offset:36864
    s_waitcnt lgkmcnt(7)
    v_mfma_f32_16x16x32_bf16 v[24:27], v[60:63], v[172:175], v[24:27]
    ds_read_b128 v[60:63], v40 offset:37888
    s_waitcnt vmcnt(1) lgkmcnt(6)
    v_mfma_f32_16x16x32_bf16 v[8:11], v[64:67], v[176:179], v[8:11]
    ds_read_b128 v[64:67], v40 offset:38912
    v_mfma_f32_16x16x32_bf16 v[12:15], v[68:71], v[176:179], v[12:15]
    ds_read_b128 v[68:71], v40 offset:39936
    s_waitcnt lgkmcnt(6)
    v_mfma_f32_16x16x32_bf16 v[16:19], v[72:75], v[176:179], v[16:19]
    v_mfma_f32_16x16x32_bf16 v[20:23], v[76:79], v[176:179], v[20:23]
    s_waitcnt lgkmcnt(5)
    v_mfma_f32_16x16x32_bf16 v[24:27], v[80:83], v[176:179], v[24:27]
    s_waitcnt vmcnt(0) lgkmcnt(3)
    v_mfma_f32_16x16x32_bf16 v[8:11], v[84:87], v[180:183], v[8:11]
    v_mfma_f32_16x16x32_bf16 v[12:15], v[56:59], v[180:183], v[12:15]
    s_waitcnt lgkmcnt(1)
    v_mfma_f32_16x16x32_bf16 v[16:19], v[60:63], v[180:183], v[16:19]
    v_mfma_f32_16x16x32_bf16 v[20:23], v[64:67], v[180:183], v[20:23]
    s_waitcnt lgkmcnt(0)
    v_mfma_f32_16x16x32_bf16 v[24:27], v[68:71], v[180:183], v[24:27]
    s_barrier
    s_lshl_b32 s69, s3, 2
    s_add_u32 s71, s69, 4
    s_add_u32 s69, s69, 3
    v_cvt_pk_bf16_f32 v128, v8, v9
    v_cvt_pk_bf16_f32 v129, v10, v11
    v_cvt_pk_bf16_f32 v130, v12, v13
    v_cvt_pk_bf16_f32 v131, v14, v15
    v_cvt_pk_bf16_f32 v132, v16, v17
    v_cvt_pk_bf16_f32 v133, v18, v19
    v_cvt_pk_bf16_f32 v134, v20, v21
    v_cvt_pk_bf16_f32 v135, v22, v23
    v_cvt_pk_bf16_f32 v136, v24, v25
    v_cvt_pk_bf16_f32 v137, v26, v27
    s_cmp_eq_u32 s47, 0
    s_cbranch_scc1 L60_slow
    buffer_store_dwordx4 v[128:131], v1, s[4:7], s59 offen nt
    buffer_store_dwordx4 v[132:135], v1, s[4:7], s59 offen offset:1024 nt
    buffer_store_dwordx2 v[136:137], v1, s[4:7], s60 offen nt
L61_back:
    v_mov_b32 v142, 0x3f803f80
    v_dot2_f32_bf16 v139, v128, v128, 0
    v_dot2_f32_bf16 v138, v128, v142, 0
    v_dot2_f32_bf16 v141, v129, v129, 0
    v_dot2_f32_bf16 v140, v129, v142, 0
    v_dot2_f32_bf16 v139, v130, v130, v139
    v_dot2_f32_bf16 v138, v130, v142, v138
    v_dot2_f32_bf16 v141, v131, v131, v141
    v_dot2_f32_bf16 v140, v131, v142, v140
    v_dot2_f32_bf16 v139, v132, v132, v139
    v_dot2_f32_bf16 v138, v132, v142, v138
    v_dot2_f32_bf16 v141, v133, v133, v141
    v_dot2_f32_bf16 v140, v133, v142, v140
    v_dot2_f32_bf16 v139, v134, v134, v139
    v_dot2_f32_bf16 v138, v134, v142, v138
    v_dot2_f32_bf16 v141, v135, v135, v141
    v_dot2_f32_bf16 v140, v135, v142, v140
    v_dot2_f32_bf16 v139, v136, v136, v139
    v_dot2_f32_bf16 v138, v136, v142, v138
    v_dot2_f32_bf16 v141, v137, v137, v141
    v_dot2_f32_bf16 v140, v137, v142, v140
    v_lshlrev_b32 v4, 2, v3
    v_lshl_add_u32 v4, v2, 4, v4
    s_nop 0
    v_pk_add_f32 v[138:139], v[138:139], v[140:141]
    s_nop 1
    v_permlane16_swap_b32 v138, v139
    s_nop 0
    v_add_f32 v138, v138, v139
    v_mov_b32 v139, v138
    s_nop 1
    v_permlane32_swap_b32 v138, v139
    s_nop 0
    v_add_f32 v138, v138, v139
    s_mov_b32 exec_hi, 0
    s_cmp_eq_u32 s47, 0
    s_cbranch_scc1 L62_slow
    buffer_store_dword v138, v4, s[4:7], s61 offen
L63_back:
    s_mov_b64 exec, -1
    s_and_b32 s68, s62, -256
    s_and_b32 s70, s45, 15
    s_lshl_b32 s88, s70, 2
    s_add_u32 s88, s88, s68
    s_add_u32 s88, s88, 64
    s_xor_b32 s66, s63, 1
    s_mul_i32 s81, s63, 21504
    s_mul_i32 s82, s66, 21504
    s_min_u32 s67, s81, s82
    s_add_u32 s67, s67, 20480
    s_mul_i32 s84, s66, 50176
    s_mul_i32 s87, s63, 50176
    s_mul_i32 s66, s70, 3072
    s_add_u32 s66, s66, 0x300000
    s_add_u32 s87, s87, s66
    s_add_u32 s84, s84, s66
    v_add_u32 v40, 102400, v1
    v_add_u32 v41, 40960, v1
    v_and_b32 v42, 511, v1
    v_lshlrev_b32 v5, 3, v3
    buffer_load_dwordx2 v[44:45], v5, s[28:31], s54 offen
    buffer_load_dwordx2 v[46:47], v5, s[28:31], s55 offen
    buffer_load_dwordx2 v[48:49], v5, s[28:31], s56 offen
    buffer_load_dwordx2 v[50:51], v5, s[28:31], s57 offen
    buffer_load_dwordx2 v[52:53], v5, s[28:31], s58 offen
    v_lshlrev_b32 v6, 2, v2
    v_mov_b32 v4, s71
    v_mov_b32 v5, 0
    s_waitcnt vmcnt(0)
    s_mov_b64 exec, 1
    s_cmp_eq_u32 s47, 0
    s_cbranch_scc1 L64_slow
    buffer_store_dword v4, v5, s[4:7], s62 offen
L65_back:
    s_mov_b64 exec, -1
    buffer_load_dword v7, v6, s[4:7], s68 offen sc1
    v_lshlrev_b32 v4, 16, v44
    v_and_b32 v5, 0xffff0000, v44
    v_pk_add_f32 v[8:9], v[8:9], v[4:5]
    v_lshlrev_b32 v4, 16, v45
    v_and_b32 v5, 0xffff0000, v45
    v_pk_add_f32 v[10:11], v[10:11], v[4:5]
    v_lshlrev_b32 v4, 16, v46
    v_and_b32 v5, 0xffff0000, v46
    v_pk_add_f32 v[12:13], v[12:13], v[4:5]
    v_lshlrev_b32 v4, 16, v47
    v_and_b32 v5, 0xffff0000, v47
    v_pk_add_f32 v[14:15], v[14:15], v[4:5]
    v_lshlrev_b32 v4, 16, v48
    v_and_b32 v5, 0xffff0000, v48
    v_pk_add_f32 v[16:17], v[16:17], v[4:5]
    v_lshlrev_b32 v4, 16, v49
    v_and_b32 v5, 0xffff0000, v49
    v_pk_add_f32 v[18:19], v[18:19], v[4:5]
    v_lshlrev_b32 v4, 16, v50
    v_and_b32 v5, 0xffff0000, v50
    v_pk_add_f32 v[20:21], v[20:21], v[4:5]
    v_lshlrev_b32 v4, 16, v51
    v_and_b32 v5, 0xffff0000, v51
    v_pk_add_f32 v[22:23], v[22:23], v[4:5]
    v_lshlrev_b32 v4, 16, v52
    v_and_b32 v5, 0xffff0000, v52
    v_pk_add_f32 v[24:25], v[24:25], v[4:5]
    v_lshlrev_b32 v4, 16, v53
    v_and_b32 v5, 0xffff0000, v53
    v_pk_add_f32 v[26:27], v[26:27], v[4:5]
    s_waitcnt vmcnt(0)
    v_cmp_gt_u32 vcc, s69, v7
    s_cbranch_vccnz L66_x1
L67_x1d:
    buffer_load_dwordx4 v[160:163], v1, s[4:7], s81 offen offset:0 sc1
    buffer_load_dwordx4 v[164:167], v1, s[4:7], s82 offen offset:0 sc1
    buffer_load_dwordx4 v[168:171], v1, s[4:7], s81 offen offset:1024 sc1
    buffer_load_dwordx4 v[172:175], v1, s[4:7], s82 offen offset:1024 sc1
    s_lshl_b32 s66, s93, 1
    v_xor_b32 v4, s66, v3
    v_lshrrev_b32 v5, 1, v4
    v_mul_u32_u24 v5, 20480, v5
    v_lshl_add_u32 v5, v4, 9, v5
    v_lshl_add_u32 v5, v2, 4, v5
    buffer_load_dwordx4 v[136:139], v5, s[4:7], s67 offen offset:0 sc1
    buffer_load_dwordx4 v[140:143], v5, s[4:7], s67 offen offset:256 sc1
    s_barrier
    ds_read_b128 v[56:59], v40 offset:0
    ds_read_b128 v[60:63], v40 offset:1024
    ds_read_b128 v[64:67], v40 offset:2048
    ds_read_b128 v[68:71], v40 offset:3072
    ds_read_b128 v[72:75], v40 offset:4096
    ds_read_b128 v[76:79], v40 offset:5120
    ds_read_b128 v[80:83], v40 offset:6144
    ds_read_b128 v[84:87], v40 offset:7168
    s_waitcnt vmcnt(4) lgkmcnt(6)
    v_mfma_f32_16x16x32_bf16 v[88:91], v[56:59], v[160:163], 0
    buffer_load_dwordx4 v[176:179], v1, s[4:7], s81 offen offset:2048 sc1
    v_mfma_f32_16x16x32_bf16 v[112:115], v[56:59], v[164:167], 0
    ds_read_b128 v[56:59], v40 offset:8192
    v_mfma_f32_16x16x32_bf16 v[92:95], v[60:63], v[160:163], 0
    v_mfma_f32_16x16x32_bf16 v[116:119], v[60:63], v[164:167], 0
    ds_read_b128 v[60:63], v40 offset:9216
    s_waitcnt lgkmcnt(6)
    v_mfma_f32_16x16x32_bf16 v[96:99], v[64:67], v[160:163], 0
    buffer_load_dwordx4 v[180:183], v1, s[4:7], s82 offen offset:2048 sc1
    v_mfma_f32_16x16x32_bf16 v[120:123], v[64:67], v[164:167], 0
    ds_read_b128 v[64:67], v40 offset:10240
    v_mfma_f32_16x16x32_bf16 v[100:103], v[68:71], v[160:163], 0
    v_mfma_f32_16x16x32_bf16 v[124:127], v[68:71], v[164:167], 0
    ds_read_b128 v[68:71], v40 offset:11264
    s_waitcnt lgkmcnt(6)
    v_mfma_f32_16x16x32_bf16 v[104:107], v[72:75], v[160:163], 0
    buffer_load_dwordx4 v[184:187], v1, s[4:7], s81 offen offset:3072 sc1
    s_add_u32 s81, s81, 4096
    v_mfma_f32_16x16x32_bf16 v[128:131], v[72:75], v[164:167], 0
    ds_read_b128 v[72:75], v40 offset:12288
    v_mfma_f32_16x16x32_bf16 v[108:111], v[76:79], v[160:163], 0
    v_mfma_f32_16x16x32_bf16 v[132:135], v[76:79], v[164:167], 0
    ds_read_b128 v[76:79], v40 offset:13312
    s_waitcnt vmcnt(5) lgkmcnt(6)
    v_mfma_f32_16x16x32_bf16 v[88:91], v[80:83], v[168:171], v[88:91]
    buffer_load_dwordx4 v[188:191], v1, s[4:7], s82 offen offset:3072 sc1
    s_add_u32 s82, s82, 4096
    v_mfma_f32_16x16x32_bf16 v[112:115], v[80:83], v[172:175], v[112:115]
    ds_read_b128 v[80:83], v40 offset:14336
    v_mfma_f32_16x16x32_bf16 v[92:95], v[84:87], v[168:171], v[92:95]
    v_mfma_f32_16x16x32_bf16 v[116:119], v[84:87], v[172:175], v[116:119]
    ds_read_b128 v[84:87], v40 offset:15360
    s_waitcnt lgkmcnt(6)
    v_mfma_f32_16x16x32_bf16 v[96:99], v[56:59], v[168:171], v[96:99]
    buffer_load_dwordx4 v[192:195], v1, s[4:7], s81 offen offset:0 sc1
    v_mfma_f32_16x16x32_bf16 v[120:123], v[56:59], v[172:175], v[120:123]
    ds_read_b128 v[56:59], v40 offset:16384
    v_mfma_f32_16x16x32_bf16 v[100:103], v[60:63], v[168:171], v[100:103]
    v_mfma_f32_16x16x32_bf16 v[124:127], v[60:63], v[172:175], v[124:127]
    ds_read_b128 v[60:63], v40 offset:17408
    s_waitcnt lgkmcnt(6)
    v_mfma_f32_16x16x32_bf16 v[104:107], v[64:67], v[168:171], v[104:107]
    buffer_load_dwordx4 v[196:199], v1, s[4:7], s82 offen offset:0 sc1
    v_mfma_f32_16x16x32_bf16 v[128:131], v[64:67], v[172:175], v[128:131]
    ds_read_b128 v[64:67], v40 offset:18432
    v_mfma_f32_16x16x32_bf16 v[108:111], v[68:71], v[168:171], v[108:111]
    v_mfma_f32_16x16x32_bf16 v[132:135], v[68:71], v[172:175], v[132:135]
    ds_read_b128 v[68:71], v40 offset:19456
    s_waitcnt vmcnt(4) lgkmcnt(6)
    v_mfma_f32_16x16x32_bf16 v[88:91], v[72:75], v[176:179], v[88:91]
    buffer_load_dwordx4 v[200:203], v1, s[4:7], s81 offen offset:1024 sc1
    v_mfma_f32_16x16x32_bf16 v[112:115], v[72:75], v[180:183], v[112:115]
    ds_read_b128 v[72:75], v40 offset:20480
    v_mfma_f32_16x16x32_bf16 v[92:95], v[76:79], v[176:179], v[92:95]
    v_mfma_f32_16x16x32_bf16 v[116:119], v[76:79], v[180:183], v[116:119]
    ds_read_b128 v[76:79], v40 offset:21504
    s_waitcnt lgkmcnt(6)
    v_mfma_f32_16x16x32_bf16 v[96:99], v[80:83], v[176:179], v[96:99]
    buffer_load_dwordx4 v[204:207], v1, s[4:7], s82 offen offset:1024 sc1
    v_mfma_f32_16x16x32_bf16 v[120:123], v[80:83], v[180:183], v[120:123]
    ds_read_b128 v[80:83], v40 offset:22528
    v_mfma_f32_16x16x32_bf16 v[100:103], v[84:87], v[176:179], v[100:103]
    v_mfma_f32_16x16x32_bf16 v[124:127], v[84:87], v[180:183], v[124:127]
    ds_read_b128 v[84:87], v40 offset:23552
    s_waitcnt lgkmcnt(6)
    v_mfma_f32_16x16x32_bf16 v[104:107], v[56:59], v[176:179], v[104:107]
    buffer_load_dwordx4 v[160:163], v1, s[4:7], s81 offen offset:2048 sc1
    v_mfma_f32_16x16x32_bf16 v[128:131], v[56:59], v[180:183], v[128:131]
    ds_read_b128 v[56:59], v40 offset:24576
    v_mfma_f32_16x16x32_bf16 v[108:111], v[60:63], v[176:179], v[108:111]
    v_mfma_f32_16x16x32_bf16 v[132:135], v[60:63], v[180:183], v[132:135]
    ds_read_b128 v[60:63], v40 offset:25600
    s_waitcnt vmcnt(5) lgkmcnt(6)
    v_mfma_f32_16x16x32_bf16 v[88:91], v[64:67], v[184:187], v[88:91]
    buffer_load_dwordx4 v[164:167], v1, s[4:7], s82 offen offset:2048 sc1
    v_mfma_f32_16x16x32_bf16 v[112:115], v[64:67], v[188:191], v[112:115]
    ds_read_b128 v[64:67], v40 offset:26624
    v_mfma_f32_16x16x32_bf16 v[92:95], v[68:71], v[184:187], v[92:95]
    v_add_f32 v136, v136, v138
    v_add_f32 v137, v137, v139
    v_mfma_f32_16x16x32_bf16 v[116:119], v[68:71], v[188:191], v[116:119]
    ds_read_b128 v[68:71], v40 offset:27648
    s_waitcnt lgkmcnt(6)
    v_mfma_f32_16x16x32_bf16 v[96:99], v[72:75], v[184:187], v[96:99]
    buffer_load_dwordx4 v[168:171], v1, s[4:7], s81 offen offset:3072 sc1
    s_add_u32 s81, s81, 4096
    v_mfma_f32_16x16x32_bf16 v[120:123], v[72:75], v[188:191], v[120:123]
    ds_read_b128 v[72:75], v40 offset:28672
    v_add_f32 v136, v136, v140
    v_mfma_f32_16x16x32_bf16 v[100:103], v[76:79], v[184:187], v[100:103]
    v_add_f32 v137, v137, v141
    v_add_f32 v136, v136, v142
    v_mfma_f32_16x16x32_bf16 v[124:127], v[76:79], v[188:191], v[124:127]
    ds_read_b128 v[76:79], v40 offset:29696
    s_waitcnt lgkmcnt(6)
    v_mfma_f32_16x16x32_bf16 v[104:107], v[80:83], v[184:187], v[104:107]
    buffer_load_dwordx4 v[172:175], v1, s[4:7], s82 offen offset:3072 sc1
    s_add_u32 s82, s82, 4096
    v_mfma_f32_16x16x32_bf16 v[128:131], v[80:83], v[188:191], v[128:131]
    ds_read_b128 v[80:83], v40 offset:30720
    v_add_f32 v137, v137, v143
    v_mfma_f32_16x16x32_bf16 v[108:111], v[84:87], v[184:187], v[108:111]
    v_mov_b32 v156, v136
    v_mov_b32 v157, v137
    v_mfma_f32_16x16x32_bf16 v[132:135], v[84:87], v[188:191], v[132:135]
    ds_read_b128 v[84:87], v40 offset:31744
    s_waitcnt vmcnt(6) lgkmcnt(6)
    v_mfma_f32_16x16x32_bf16 v[88:91], v[56:59], v[192:195], v[88:91]
    buffer_load_dwordx4 v[176:179], v1, s[4:7], s81 offen offset:0 sc1
    v_mfma_f32_16x16x32_bf16 v[112:115], v[56:59], v[196:199], v[112:115]
    ds_read_b128 v[56:59], v40 offset:32768
    v_mfma_f32_16x16x32_bf16 v[92:95], v[60:63], v[192:195], v[92:95]
    s_nop 1
    v_mfma_f32_16x16x32_bf16 v[116:119], v[60:63], v[196:199], v[116:119]
    ds_read_b128 v[60:63], v40 offset:33792
    s_waitcnt lgkmcnt(6)
    v_mfma_f32_16x16x32_bf16 v[96:99], v[64:67], v[192:195], v[96:99]
    buffer_load_dwordx4 v[180:183], v1, s[4:7], s82 offen offset:0 sc1
    v_mfma_f32_16x16x32_bf16 v[120:123], v[64:67], v[196:199], v[120:123]
    ds_read_b128 v[64:67], v40 offset:34816
    v_permlane16_swap_b32 v136, v156
    v_mfma_f32_16x16x32_bf16 v[100:103], v[68:71], v[192:195], v[100:103]
    v_permlane16_swap_b32 v137, v157
    v_add_f32 v136, v136, v156
    v_mfma_f32_16x16x32_bf16 v[124:127], v[68:71], v[196:199], v[124:127]
    ds_read_b128 v[68:71], v40 offset:35840
    s_waitcnt lgkmcnt(6)
    v_mfma_f32_16x16x32_bf16 v[104:107], v[72:75], v[192:195], v[104:107]
    buffer_load_dwordx4 v[184:187], v1, s[4:7], s81 offen offset:1024 sc1
    v_mfma_f32_16x16x32_bf16 v[128:131], v[72:75], v[196:199], v[128:131]
    ds_read_b128 v[72:75], v40 offset:36864
    v_add_f32 v137, v137, v157
    v_mfma_f32_16x16x32_bf16 v[108:111], v[76:79], v[192:195], v[108:111]
    v_mul_f32 v136, 0xbacccccd, v136
    v_mul_f32 v137, 0x3acccccd, v137
    v_mfma_f32_16x16x32_bf16 v[132:135], v[76:79], v[196:199], v[132:135]
    ds_read_b128 v[76:79], v40 offset:37888
    s_waitcnt vmcnt(7) lgkmcnt(6)
    v_mfma_f32_16x16x32_bf16 v[88:91], v[80:83], v[200:203], v[88:91]
    buffer_load_dwordx4 v[188:191], v1, s[4:7], s82 offen offset:1024 sc1
    v_mfma_f32_16x16x32_bf16 v[112:115], v[80:83], v[204:207], v[112:115]
    ds_read_b128 v[80:83], v40 offset:38912
    v_cmp_gt_u32 vcc, 2, v3
    v_mfma_f32_16x16x32_bf16 v[92:95], v[84:87], v[200:203], v[92:95]
    v_cmp_le_u32 s[68:69], 2, v3
    v_fma_f32 v137, -v136, v136, v137
    v_mfma_f32_16x16x32_bf16 v[116:119], v[84:87], v[204:207], v[116:119]
    ds_read_b128 v[84:87], v40 offset:39936
    s_waitcnt lgkmcnt(6)
    v_mfma_f32_16x16x32_bf16 v[96:99], v[56:59], v[200:203], v[96:99]
    buffer_load_dwordx4 v[192:195], v1, s[4:7], s81 offen offset:2048 sc1
    v_mfma_f32_16x16x32_bf16 v[120:123], v[56:59], v[204:207], v[120:123]
    ds_read_b128 v[56:59], v40 offset:40960
    v_max_f32 v137, 0, v137
    v_mfma_f32_16x16x32_bf16 v[100:103], v[60:63], v[200:203], v[100:103]
    v_add_f32 v137, 0x3727c5ac, v137
    v_mfma_f32_16x16x32_bf16 v[124:127], v[60:63], v[204:207], v[124:127]
    ds_read_b128 v[60:63], v40 offset:41984
    s_waitcnt lgkmcnt(6)
    v_mfma_f32_16x16x32_bf16 v[104:107], v[64:67], v[200:203], v[104:107]
    buffer_load_dwordx4 v[196:199], v1, s[4:7], s82 offen offset:2048 sc1
    v_mfma_f32_16x16x32_bf16 v[128:131], v[64:67], v[204:207], v[128:131]
    ds_read_b128 v[64:67], v40 offset:43008
    v_mfma_f32_16x16x32_bf16 v[108:111], v[68:71], v[200:203], v[108:111]
    v_rsq_f32 v138, v137
    v_mfma_f32_16x16x32_bf16 v[132:135], v[68:71], v[204:207], v[132:135]
    ds_read_b128 v[68:71], v40 offset:44032
    s_waitcnt vmcnt(8) lgkmcnt(6)
    v_mfma_f32_16x16x32_bf16 v[88:91], v[72:75], v[160:163], v[88:91]
    buffer_load_dwordx4 v[200:203], v1, s[4:7], s81 offen offset:3072 sc1
    s_add_u32 s81, s81, 4096
    v_mfma_f32_16x16x32_bf16 v[112:115], v[72:75], v[164:167], v[112:115]
    ds_read_b128 v[72:75], v40 offset:45056
    v_cvt_pk_bf16_f32 v140, v136, v136
    v_mfma_f32_16x16x32_bf16 v[92:95], v[76:79], v[160:163], v[92:95]
    v_and_b32 v139, 0xffff0000, v140
    v_sub_f32 v139, v136, v139
    v_mfma_f32_16x16x32_bf16 v[116:119], v[76:79], v[164:167], v[116:119]
    ds_read_b128 v[76:79], v40 offset:46080
    s_waitcnt lgkmcnt(6)
    v_mfma_f32_16x16x32_bf16 v[96:99], v[80:83], v[160:163], v[96:99]
    buffer_load_dwordx4 v[204:207], v1, s[4:7], s82 offen offset:3072 sc1
    s_add_u32 s82, s82, 4096
    v_mfma_f32_16x16x32_bf16 v[120:123], v[80:83], v[164:167], v[120:123]
    ds_read_b128 v[80:83], v40 offset:47104
    v_mov_b32 v144, v138
    v_mfma_f32_16x16x32_bf16 v[100:103], v[84:87], v[160:163], v[100:103]
    v_mov_b32 v145, v138
    v_mul_f32 v137, v137, v138
    v_mfma_f32_16x16x32_bf16 v[124:127], v[84:87], v[164:167], v[124:127]
    ds_read_b128 v[84:87], v40 offset:48128
    s_waitcnt lgkmcnt(6)
    v_mfma_f32_16x16x32_bf16 v[104:107], v[56:59], v[160:163], v[104:107]
    v_cvt_pk_bf16_f32 v141, v139, v137
    v_and_b32 v139, 0xffff0000, v141
    v_mfma_f32_16x16x32_bf16 v[128:131], v[56:59], v[164:167], v[128:131]
    ds_read_b128 v[56:59], v40 offset:49152
    v_sub_f32 v139, v137, v139
    v_mfma_f32_16x16x32_bf16 v[108:111], v[60:63], v[160:163], v[108:111]
    v_cvt_pk_bf16_f32 v142, v139, 0
    v_permlane32_swap_b32 v144, v145
    v_mfma_f32_16x16x32_bf16 v[132:135], v[60:63], v[164:167], v[132:135]
    ds_read_b128 v[60:63], v40 offset:50176
    s_waitcnt vmcnt(8) lgkmcnt(6)
    v_mfma_f32_16x16x32_bf16 v[88:91], v[64:67], v[168:171], v[88:91]
    buffer_load_dwordx4 v[160:163], v1, s[4:7], s81 offen offset:0 sc1
    v_mfma_f32_16x16x32_bf16 v[112:115], v[64:67], v[172:175], v[112:115]
    ds_read_b128 v[64:67], v40 offset:51200
    v_cndmask_b32 v148, 0, v140, vcc
    v_mfma_f32_16x16x32_bf16 v[92:95], v[68:71], v[168:171], v[92:95]
    v_cndmask_b32 v149, 0, v141, vcc
    v_cndmask_b32 v150, 0, v142, vcc
    v_mfma_f32_16x16x32_bf16 v[116:119], v[68:71], v[172:175], v[116:119]
    ds_read_b128 v[68:71], v40 offset:52224
    s_waitcnt lgkmcnt(6)
    v_mfma_f32_16x16x32_bf16 v[96:99], v[72:75], v[168:171], v[96:99]
    buffer_load_dwordx4 v[164:167], v1, s[4:7], s82 offen offset:0 sc1
    v_mfma_f32_16x16x32_bf16 v[120:123], v[72:75], v[172:175], v[120:123]
    ds_read_b128 v[72:75], v40 offset:53248
    v_mov_b32 v151, 0
    v_mfma_f32_16x16x32_bf16 v[100:103], v[76:79], v[168:171], v[100:103]
    v_cndmask_b32 v152, 0, v140, s[68:69]
    v_cndmask_b32 v153, 0, v141, s[68:69]
    v_mfma_f32_16x16x32_bf16 v[124:127], v[76:79], v[172:175], v[124:127]
    ds_read_b128 v[76:79], v40 offset:54272
    s_waitcnt lgkmcnt(6)
    v_mfma_f32_16x16x32_bf16 v[104:107], v[80:83], v[168:171], v[104:107]
    v_cndmask_b32 v154, 0, v142, s[68:69]
    v_mov_b32 v155, 0
    v_mfma_f32_16x16x32_bf16 v[128:131], v[80:83], v[172:175], v[128:131]
    ds_read_b128 v[80:83], v40 offset:55296
    v_mul_f32 v136, 0xc0135761, v144
    v_mfma_f32_16x16x32_bf16 v[108:111], v[84:87], v[168:171], v[108:111]
    v_mul_f32 v156, v144, v144
    v_mul_f32 v156, 0x3d372713, v156
    v_mfma_f32_16x16x32_bf16 v[132:135], v[84:87], v[172:175], v[132:135]
    ds_read_b128 v[84:87], v40 offset:56320
    s_waitcnt vmcnt(8) lgkmcnt(6)
    v_mfma_f32_16x16x32_bf16 v[88:91], v[56:59], v[176:179], v[88:91]
    buffer_load_dwordx4 v[168:171], v1, s[4:7], s81 offen offset:1024 sc1
    v_mfma_f32_16x16x32_bf16 v[112:115], v[56:59], v[180:183], v[112:115]
    ds_read_b128 v[56:59], v40 offset:57344
    v_mul_f32 v138, v156, v136
    v_mfma_f32_16x16x32_bf16 v[92:95], v[60:63], v[176:179], v[92:95]
    v_mov_b32 v137, v136
    v_mov_b32 v139, v138
    v_mfma_f32_16x16x32_bf16 v[116:119], v[60:63], v[180:183], v[116:119]
    ds_read_b128 v[60:63], v40 offset:58368
    s_waitcnt lgkmcnt(6)
    v_mfma_f32_16x16x32_bf16 v[96:99], v[64:67], v[176:179], v[96:99]
    buffer_load_dwordx4 v[172:175], v1, s[4:7], s82 offen offset:1024 sc1
    v_mfma_f32_16x16x32_bf16 v[120:123], v[64:67], v[180:183], v[120:123]
    ds_read_b128 v[64:67], v40 offset:59392
    v_mul_f32 v140, 0xc0135761, v145
    v_mfma_f32_16x16x32_bf16 v[100:103], v[68:71], v[176:179], v[100:103]
    v_mul_f32 v156, v145, v145
    v_mul_f32 v156, 0x3d372713, v156
    v_mfma_f32_16x16x32_bf16 v[124:127], v[68:71], v[180:183], v[124:127]
    ds_read_b128 v[68:71], v40 offset:60416
    s_waitcnt lgkmcnt(6)
    v_mfma_f32_16x16x32_bf16 v[104:107], v[72:75], v[176:179], v[104:107]
    v_mul_f32 v142, v156, v140
    v_mov_b32 v141, v140
    v_mfma_f32_16x16x32_bf16 v[128:131], v[72:75], v[180:183], v[128:131]
    ds_read_b128 v[72:75], v41 offset:0
    v_mov_b32 v143, v142
    v_mfma_f32_16x16x32_bf16 v[108:111], v[76:79], v[176:179], v[108:111]
    v_rcp_f32 v146, v145
    v_mfma_f32_16x16x32_bf16 v[132:135], v[76:79], v[180:183], v[132:135]
    ds_read_b128 v[76:79], v41 offset:1024
    s_waitcnt vmcnt(8) lgkmcnt(6)
    v_mfma_f32_16x16x32_bf16 v[88:91], v[80:83], v[184:187], v[88:91]
    buffer_load_dwordx4 v[176:179], v1, s[4:7], s81 offen offset:2048 sc1
    v_mfma_f32_16x16x32_bf16 v[112:115], v[80:83], v[188:191], v[112:115]
    ds_read_b128 v[80:83], v41 offset:2048
    v_mfma_f32_16x16x32_bf16 v[92:95], v[84:87], v[184:187], v[92:95]
    v_rcp_f32 v144, v144
    v_mfma_f32_16x16x32_bf16 v[116:119], v[84:87], v[188:191], v[116:119]
    ds_read_b128 v[84:87], v41 offset:3072
    s_waitcnt lgkmcnt(6)
    v_mfma_f32_16x16x32_bf16 v[96:99], v[56:59], v[184:187], v[96:99]
    buffer_load_dwordx4 v[180:183], v1, s[4:7], s82 offen offset:2048 sc1
    v_mfma_f32_16x16x32_bf16 v[120:123], v[56:59], v[188:191], v[120:123]
    ds_read_b128 v[56:59], v41 offset:4096
    s_nop 0
    v_mfma_f32_16x16x32_bf16 v[100:103], v[60:63], v[184:187], v[100:103]
    v_mov_b32 v147, v146
    v_mov_b32 v145, v144
    v_mfma_f32_16x16x32_bf16 v[124:127], v[60:63], v[188:191], v[124:127]
    ds_read_b128 v[60:63], v41 offset:5120
    s_waitcnt lgkmcnt(6)
    v_mfma_f32_16x16x32_bf16 v[104:107], v[64:67], v[184:187], v[104:107]
    s_add_u32 s66, s49, 1
    s_and_b32 s66, s66, 7
    v_mfma_f32_16x16x32_bf16 v[128:131], v[64:67], v[188:191], v[128:131]
    ds_read_b128 v[64:67], v41 offset:6144
    s_mul_i32 s89, s66, 3072
    v_mfma_f32_16x16x32_bf16 v[108:111], v[68:71], v[184:187], v[108:111]
    s_add_u32 s66, s49, 2
    s_and_b32 s66, s66, 7
    v_mfma_f32_16x16x32_bf16 v[132:135], v[68:71], v[188:191], v[132:135]
    ds_read_b128 v[68:71], v41 offset:7168
    s_waitcnt vmcnt(8) lgkmcnt(6)
    v_mfma_f32_16x16x32_bf16 v[88:91], v[72:75], v[192:195], v[88:91]
    buffer_load_dwordx4 v[184:187], v1, s[4:7], s81 offen offset:3072 sc1
    s_add_u32 s81, s81, 4096
    v_mfma_f32_16x16x32_bf16 v[112:115], v[72:75], v[196:199], v[112:115]
    ds_read_b128 v[72:75], v41 offset:8192
    s_mul_i32 s90, s66, 3072
    v_mfma_f32_16x16x32_bf16 v[92:95], v[76:79], v[192:195], v[92:95]
    s_add_u32 s66, s49, 3
    s_and_b32 s66, s66, 7
    v_mfma_f32_16x16x32_bf16 v[116:119], v[76:79], v[196:199], v[116:119]
    ds_read_b128 v[76:79], v41 offset:9216
    s_waitcnt lgkmcnt(6)
    v_mfma_f32_16x16x32_bf16 v[96:99], v[80:83], v[192:195], v[96:99]
    buffer_load_dwordx4 v[188:191], v1, s[4:7], s82 offen offset:3072 sc1
    s_add_u32 s82, s82, 4096
    v_mfma_f32_16x16x32_bf16 v[120:123], v[80:83], v[196:199], v[120:123]
    ds_read_b128 v[80:83], v41 offset:10240
    s_mul_i32 s91, s66, 3072
    v_mfma_f32_16x16x32_bf16 v[100:103], v[84:87], v[192:195], v[100:103]
    s_add_u32 s66, s49, 4
    s_and_b32 s66, s66, 7
    v_mfma_f32_16x16x32_bf16 v[124:127], v[84:87], v[196:199], v[124:127]
    ds_read_b128 v[84:87], v41 offset:11264
    s_waitcnt lgkmcnt(6)
    v_mfma_f32_16x16x32_bf16 v[104:107], v[56:59], v[192:195], v[104:107]
    s_mul_i32 s92, s66, 3072
    s_add_u32 s66, s49, 5
    v_mfma_f32_16x16x32_bf16 v[128:131], v[56:59], v[196:199], v[128:131]
    ds_read_b128 v[56:59], v41 offset:12288
    s_and_b32 s66, s66, 7
    v_mfma_f32_16x16x32_bf16 v[108:111], v[60:63], v[192:195], v[108:111]
    s_mul_i32 s94, s66, 3072
    s_add_u32 s66, s49, 6
    v_mfma_f32_16x16x32_bf16 v[132:135], v[60:63], v[196:199], v[132:135]
    ds_read_b128 v[60:63], v41 offset:13312
    s_waitcnt vmcnt(8) lgkmcnt(6)
    v_mfma_f32_16x16x32_bf16 v[88:91], v[64:67], v[200:203], v[88:91]
    buffer_load_dwordx4 v[192:195], v1, s[4:7], s81 offen offset:0 sc1
    v_mfma_f32_16x16x32_bf16 v[112:115], v[64:67], v[204:207], v[112:115]
    ds_read_b128 v[64:67], v41 offset:14336
    s_and_b32 s66, s66, 7
    v_mfma_f32_16x16x32_bf16 v[92:95], v[68:71], v[200:203], v[92:95]
    s_mul_i32 s95, s66, 3072
    s_add_u32 s66, s49, 7
    v_mfma_f32_16x16x32_bf16 v[116:119], v[68:71], v[204:207], v[116:119]
    ds_read_b128 v[68:71], v41 offset:15360
    s_waitcnt lgkmcnt(6)
    v_mfma_f32_16x16x32_bf16 v[96:99], v[72:75], v[200:203], v[96:99]
    buffer_load_dwordx4 v[196:199], v1, s[4:7], s82 offen offset:0 sc1
    v_mfma_f32_16x16x32_bf16 v[120:123], v[72:75], v[204:207], v[120:123]
    ds_read_b128 v[72:75], v41 offset:16384
    s_and_b32 s66, s66, 7
    v_mfma_f32_16x16x32_bf16 v[100:103], v[76:79], v[200:203], v[100:103]
    s_mul_i32 s101, s66, 3072
    s_mul_i32 s66, s49, 3072
    v_mfma_f32_16x16x32_bf16 v[124:127], v[76:79], v[204:207], v[124:127]
    ds_read_b128 v[76:79], v41 offset:17408
    s_waitcnt lgkmcnt(6)
    v_mfma_f32_16x16x32_bf16 v[104:107], v[80:83], v[200:203], v[104:107]
    s_sub_u32 s67, s87, s66
    v_add_u32 v44, s67, v1
    v_mfma_f32_16x16x32_bf16 v[128:131], v[80:83], v[204:207], v[128:131]
    ds_read_b128 v[80:83], v41 offset:18432
    s_sub_u32 s67, s84, s66
    v_mfma_f32_16x16x32_bf16 v[108:111], v[84:87], v[200:203], v[108:111]
    v_add_u32 v45, s67, v1
    v_add_u32 v43, 61440, v1
    v_mfma_f32_16x16x32_bf16 v[132:135], v[84:87], v[204:207], v[132:135]
    ds_read_b128 v[84:87], v41 offset:19456
    s_waitcnt vmcnt(8) lgkmcnt(6)
    v_mfma_f32_16x16x32_bf16 v[88:91], v[56:59], v[160:163], v[88:91]
    buffer_load_dwordx4 v[200:203], v1, s[4:7], s81 offen offset:1024 sc1
    v_mfma_f32_16x16x32_bf16 v[112:115], v[56:59], v[164:167], v[112:115]
    ds_read_b128 v[56:59], v41 offset:20480
    s_mul_i32 s66, s93, 43008
    v_mfma_f32_16x16x32_bf16 v[92:95], v[60:63], v[160:163], v[92:95]
    s_sub_u32 s66, 21504, s66
    s_add_u32 s70, s59, s66
    v_mfma_f32_16x16x32_bf16 v[116:119], v[60:63], v[164:167], v[116:119]
    ds_read_b128 v[60:63], v41 offset:21504
    s_waitcnt lgkmcnt(6)
    v_mfma_f32_16x16x32_bf16 v[96:99], v[64:67], v[160:163], v[96:99]
    buffer_load_dwordx4 v[204:207], v1, s[4:7], s82 offen offset:1024 sc1
    v_mfma_f32_16x16x32_bf16 v[120:123], v[64:67], v[164:167], v[120:123]
    ds_read_b128 v[64:67], v41 offset:22528
    s_add_u32 s71, s60, s66
    v_mfma_f32_16x16x32_bf16 v[100:103], v[68:71], v[160:163], v[100:103]
    s_bfe_u32 s66, s62, 0x30008
    s_lshl_b32 s66, s66, 6
    v_mfma_f32_16x16x32_bf16 v[124:127], v[68:71], v[164:167], v[124:127]
    ds_read_b128 v[68:71], v41 offset:23552
    s_waitcnt lgkmcnt(6)
    v_mfma_f32_16x16x32_bf16 v[104:107], v[72:75], v[160:163], v[104:107]
    s_and_b32 s67, s62, 63
    s_add_u32 s66, s66, s67
    v_mfma_f32_16x16x32_bf16 v[128:131], v[72:75], v[164:167], v[128:131]
    ds_read_b128 v[72:75], v41 offset:24576
    s_add_u32 s66, s66, s80
    v_mfma_f32_16x16x32_bf16 v[108:111], v[76:79], v[160:163], v[108:111]
    s_add_u32 s72, s66, 3328
    s_xor_b32 s73, s72, 4
    v_mfma_f32_16x16x32_bf16 v[132:135], v[76:79], v[164:167], v[132:135]
    ds_read_b128 v[76:79], v41 offset:25600
    s_waitcnt vmcnt(8) lgkmcnt(6)
    v_mfma_f32_16x16x32_bf16 v[88:91], v[80:83], v[168:171], v[88:91]
    buffer_load_dwordx4 v[160:163], v1, s[4:7], s81 offen offset:2048 sc1
    v_mfma_f32_16x16x32_bf16 v[112:115], v[80:83], v[172:175], v[112:115]
    ds_read_b128 v[80:83], v41 offset:26624
    s_and_b32 s74, s62, -256
    v_mfma_f32_16x16x32_bf16 v[92:95], v[84:87], v[168:171], v[92:95]
    s_add_u32 s74, s74, 64
    s_lshl_b32 s66, s93, 5
    v_mfma_f32_16x16x32_bf16 v[116:119], v[84:87], v[172:175], v[116:119]
    ds_read_b128 v[84:87], v41 offset:27648
    s_waitcnt lgkmcnt(6)
    v_mfma_f32_16x16x32_bf16 v[96:99], v[56:59], v[168:171], v[96:99]
    buffer_load_dwordx4 v[164:167], v1, s[4:7], s82 offen offset:2048 sc1
    v_mfma_f32_16x16x32_bf16 v[120:123], v[56:59], v[172:175], v[120:123]
    ds_read_b128 v[56:59], v41 offset:28672
    s_add_u32 s75, s74, s66
    v_mfma_f32_16x16x32_bf16 v[100:103], v[60:63], v[168:171], v[100:103]
    s_lshl_b32 s76, s3, 1
    s_add_u32 s76, s76, 1
    v_mfma_f32_16x16x32_bf16 v[124:127], v[60:63], v[172:175], v[124:127]
    ds_read_b128 v[60:63], v41 offset:29696
    s_waitcnt lgkmcnt(6)
    v_mfma_f32_16x16x32_bf16 v[104:107], v[64:67], v[168:171], v[104:107]
    s_add_u32 s77, s76, 1
    v_lshlrev_b32 v46, 2, v2
    v_mfma_f32_16x16x32_bf16 v[128:131], v[64:67], v[172:175], v[128:131]
    ds_read_b128 v[64:67], v41 offset:30720
    v_and_b32 v47, 28, v46
    v_mfma_f32_16x16x32_bf16 v[108:111], v[68:71], v[168:171], v[108:111]
    v_mov_b32 v48, s76
    v_mov_b32 v49, s77
    v_mfma_f32_16x16x32_bf16 v[132:135], v[68:71], v[172:175], v[132:135]
    ds_read_b128 v[68:71], v41 offset:31744
    s_waitcnt vmcnt(8) lgkmcnt(6)
    v_mfma_f32_16x16x32_bf16 v[88:91], v[72:75], v[176:179], v[88:91]
    buffer_load_dwordx4 v[168:171], v1, s[4:7], s81 offen offset:3072 sc1
    s_add_u32 s81, s81, 4096
    v_mfma_f32_16x16x32_bf16 v[112:115], v[72:75], v[180:183], v[112:115]
    ds_read_b128 v[72:75], v41 offset:32768
    v_mov_b32 v50, 0
    v_mfma_f32_16x16x32_bf16 v[92:95], v[76:79], v[176:179], v[92:95]
    v_mfma_f32_16x16x32_bf16 v[116:119], v[76:79], v[180:183], v[116:119]
    ds_read_b128 v[76:79], v41 offset:33792
    s_waitcnt lgkmcnt(6)
    v_mfma_f32_16x16x32_bf16 v[96:99], v[80:83], v[176:179], v[96:99]
    buffer_load_dwordx4 v[172:175], v1, s[4:7], s82 offen offset:3072 sc1
    s_add_u32 s82, s82, 4096
    v_mfma_f32_16x16x32_bf16 v[120:123], v[80:83], v[180:183], v[120:123]
    ds_read_b128 v[80:83], v41 offset:34816
    v_mfma_f32_16x16x32_bf16 v[100:103], v[84:87], v[176:179], v[100:103]
    v_mfma_f32_16x16x32_bf16 v[124:127], v[84:87], v[180:183], v[124:127]
    ds_read_b128 v[84:87], v41 offset:35840
    s_waitcnt lgkmcnt(6)
    v_mfma_f32_16x16x32_bf16 v[104:107], v[56:59], v[176:179], v[104:107]
    v_mfma_f32_16x16x32_bf16 v[128:131], v[56:59], v[180:183], v[128:131]
    ds_read_b128 v[56:59], v41 offset:36864
    v_mfma_f32_16x16x32_bf16 v[108:111], v[60:63], v[176:179], v[108:111]
    v_mfma_f32_16x16x32_bf16 v[132:135], v[60:63], v[180:183], v[132:135]
    ds_read_b128 v[60:63], v41 offset:37888
    s_waitcnt vmcnt(8) lgkmcnt(6)
    v_mfma_f32_16x16x32_bf16 v[88:91], v[64:67], v[184:187], v[88:91]
    v_mfma_f32_16x16x32_bf16 v[112:115], v[64:67], v[188:191], v[112:115]
    ds_read_b128 v[64:67], v41 offset:38912
    v_mfma_f32_16x16x32_bf16 v[92:95], v[68:71], v[184:187], v[92:95]
    v_mfma_f32_16x16x32_bf16 v[116:119], v[68:71], v[188:191], v[116:119]
    ds_read_b128 v[68:71], v41 offset:39936
    s_waitcnt lgkmcnt(6)
    v_mfma_f32_16x16x32_bf16 v[96:99], v[72:75], v[184:187], v[96:99]
    v_mfma_f32_16x16x32_bf16 v[120:123], v[72:75], v[188:191], v[120:123]
    ds_read_b128 v[72:75], v41 offset:40960
    v_mfma_f32_16x16x32_bf16 v[100:103], v[76:79], v[184:187], v[100:103]
    v_mfma_f32_16x16x32_bf16 v[124:127], v[76:79], v[188:191], v[124:127]
    ds_read_b128 v[76:79], v41 offset:41984
    s_waitcnt lgkmcnt(6)
    v_mfma_f32_16x16x32_bf16 v[104:107], v[80:83], v[184:187], v[104:107]
    v_mfma_f32_16x16x32_bf16 v[128:131], v[80:83], v[188:191], v[128:131]
    ds_read_b128 v[80:83], v41 offset:43008
    v_mfma_f32_16x16x32_bf16 v[108:111], v[84:87], v[184:187], v[108:111]
    v_mfma_f32_16x16x32_bf16 v[132:135], v[84:87], v[188:191], v[132:135]
    ds_read_b128 v[84:87], v41 offset:44032
    s_waitcnt vmcnt(6) lgkmcnt(6)
    v_mfma_f32_16x16x32_bf16 v[88:91], v[56:59], v[192:195], v[88:91]
    v_mfma_f32_16x16x32_bf16 v[112:115], v[56:59], v[196:199], v[112:115]
    ds_read_b128 v[56:59], v41 offset:45056
    v_mfma_f32_16x16x32_bf16 v[92:95], v[60:63], v[192:195], v[92:95]
    v_mfma_f32_16x16x32_bf16 v[116:119], v[60:63], v[196:199], v[116:119]
    ds_read_b128 v[60:63], v41 offset:46080
    s_waitcnt lgkmcnt(6)
    v_mfma_f32_16x16x32_bf16 v[96:99], v[64:67], v[192:195], v[96:99]
    v_mfma_f32_16x16x32_bf16 v[120:123], v[64:67], v[196:199], v[120:123]
    ds_read_b128 v[64:67], v41 offset:47104
    v_mfma_f32_16x16x32_bf16 v[100:103], v[68:71], v[192:195], v[100:103]
    v_mfma_f32_16x16x32_bf16 v[124:127], v[68:71], v[196:199], v[124:127]
    ds_read_b128 v[68:71], v41 offset:48128
    s_waitcnt lgkmcnt(6)
    v_mfma_f32_16x16x32_bf16 v[104:107], v[72:75], v[192:195], v[104:107]
    v_mfma_f32_16x16x32_bf16 v[128:131], v[72:75], v[196:199], v[128:131]
    ds_read_b128 v[72:75], v41 offset:49152
    v_mfma_f32_16x16x32_bf16 v[108:111], v[76:79], v[192:195], v[108:111]
    v_mfma_f32_16x16x32_bf16 v[132:135], v[76:79], v[196:199], v[132:135]
    ds_read_b128 v[76:79], v41 offset:50176
    s_waitcnt vmcnt(4) lgkmcnt(6)
    v_mfma_f32_16x16x32_bf16 v[88:91], v[80:83], v[200:203], v[88:91]
    v_mfma_f32_16x16x32_bf16 v[112:115], v[80:83], v[204:207], v[112:115]
    ds_read_b128 v[80:83], v41 offset:51200
    v_mfma_f32_16x16x32_bf16 v[92:95], v[84:87], v[200:203], v[92:95]
    v_mfma_f32_16x16x32_bf16 v[116:119], v[84:87], v[204:207], v[116:119]
    ds_read_b128 v[84:87], v41 offset:52224
    s_waitcnt lgkmcnt(6)
    v_mfma_f32_16x16x32_bf16 v[96:99], v[56:59], v[200:203], v[96:99]
    v_mfma_f32_16x16x32_bf16 v[120:123], v[56:59], v[204:207], v[120:123]
    ds_read_b128 v[56:59], v41 offset:53248
    v_mfma_f32_16x16x32_bf16 v[100:103], v[60:63], v[200:203], v[100:103]
    v_mfma_f32_16x16x32_bf16 v[124:127], v[60:63], v[204:207], v[124:127]
    ds_read_b128 v[60:63], v41 offset:54272
    s_waitcnt lgkmcnt(6)
    v_mfma_f32_16x16x32_bf16 v[104:107], v[64:67], v[200:203], v[104:107]
    v_mfma_f32_16x16x32_bf16 v[128:131], v[64:67], v[204:207], v[128:131]
    ds_read_b128 v[64:67], v41 offset:55296
    v_mfma_f32_16x16x32_bf16 v[108:111], v[68:71], v[200:203], v[108:111]
    v_mfma_f32_16x16x32_bf16 v[132:135], v[68:71], v[204:207], v[132:135]
    ds_read_b128 v[68:71], v41 offset:56320
    s_waitcnt vmcnt(2) lgkmcnt(6)
    v_mfma_f32_16x16x32_bf16 v[88:91], v[72:75], v[160:163], v[88:91]
    v_mfma_f32_16x16x32_bf16 v[112:115], v[72:75], v[164:167], v[112:115]
    ds_read_b128 v[72:75], v41 offset:57344
    v_mfma_f32_16x16x32_bf16 v[92:95], v[76:79], v[160:163], v[92:95]
    v_mfma_f32_16x16x32_bf16 v[116:119], v[76:79], v[164:167], v[116:119]
    ds_read_b128 v[76:79], v41 offset:58368
    s_waitcnt lgkmcnt(6)
    v_mfma_f32_16x16x32_bf16 v[96:99], v[80:83], v[160:163], v[96:99]
    v_mfma_f32_16x16x32_bf16 v[120:123], v[80:83], v[164:167], v[120:123]
    ds_read_b128 v[80:83], v41 offset:59392
    v_mfma_f32_16x16x32_bf16 v[100:103], v[84:87], v[160:163], v[100:103]
    v_mfma_f32_16x16x32_bf16 v[124:127], v[84:87], v[164:167], v[124:127]
    ds_read_b128 v[84:87], v41 offset:60416
    s_waitcnt lgkmcnt(6)
    v_mfma_f32_16x16x32_bf16 v[104:107], v[56:59], v[160:163], v[104:107]
    v_mfma_f32_16x16x32_bf16 v[128:131], v[56:59], v[164:167], v[128:131]
    ds_read_b128 v[56:59], v42 offset:36864
    v_mfma_f32_16x16x32_bf16 v[108:111], v[60:63], v[160:163], v[108:111]
    v_mfma_f32_16x16x32_bf16 v[132:135], v[60:63], v[164:167], v[132:135]
    ds_read_b128 v[60:63], v42 offset:37376
    s_waitcnt vmcnt(0) lgkmcnt(6)
    v_mfma_f32_16x16x32_bf16 v[88:91], v[64:67], v[168:171], v[88:91]
    v_mfma_f32_16x16x32_bf16 v[112:115], v[64:67], v[172:175], v[112:115]
    ds_read_b128 v[64:67], v42 offset:37888
    v_mfma_f32_16x16x32_bf16 v[92:95], v[68:71], v[168:171], v[92:95]
    v_mfma_f32_16x16x32_bf16 v[116:119], v[68:71], v[172:175], v[116:119]
    ds_read_b128 v[68:71], v42 offset:38400
    s_waitcnt lgkmcnt(6)
    v_mfma_f32_16x16x32_bf16 v[96:99], v[72:75], v[168:171], v[96:99]
    v_mfma_f32_16x16x32_bf16 v[120:123], v[72:75], v[172:175], v[120:123]
    ds_read_b128 v[72:75], v42 offset:38912
    v_mfma_f32_16x16x32_bf16 v[100:103], v[76:79], v[168:171], v[100:103]
    v_mfma_f32_16x16x32_bf16 v[124:127], v[76:79], v[172:175], v[124:127]
    ds_read_b128 v[76:79], v42 offset:39424
    s_waitcnt lgkmcnt(6)
    v_mfma_f32_16x16x32_bf16 v[104:107], v[80:83], v[168:171], v[104:107]
    v_mfma_f32_16x16x32_bf16 v[128:131], v[80:83], v[172:175], v[128:131]
    v_mfma_f32_16x16x32_bf16 v[108:111], v[84:87], v[168:171], v[108:111]
    v_mfma_f32_16x16x32_bf16 v[132:135], v[84:87], v[172:175], v[132:135]
    s_waitcnt lgkmcnt(4)
    v_mfma_f32_16x16x32_bf16 v[88:91], v[56:59], v[148:151], v[88:91]
    v_mfma_f32_16x16x32_bf16 v[112:115], v[56:59], v[152:155], v[112:115]
    v_mfma_f32_16x16x32_bf16 v[92:95], v[60:63], v[148:151], v[92:95]
    v_mfma_f32_16x16x32_bf16 v[116:119], v[60:63], v[152:155], v[116:119]
    s_waitcnt lgkmcnt(2)
    v_mfma_f32_16x16x32_bf16 v[96:99], v[64:67], v[148:151], v[96:99]
    v_mfma_f32_16x16x32_bf16 v[120:123], v[64:67], v[152:155], v[120:123]
    v_mfma_f32_16x16x32_bf16 v[100:103], v[68:71], v[148:151], v[100:103]
    v_mfma_f32_16x16x32_bf16 v[124:127], v[68:71], v[152:155], v[124:127]
    s_waitcnt lgkmcnt(0)
    v_mfma_f32_16x16x32_bf16 v[104:107], v[72:75], v[148:151], v[104:107]
    v_mfma_f32_16x16x32_bf16 v[128:131], v[72:75], v[152:155], v[128:131]
    v_mfma_f32_16x16x32_bf16 v[108:111], v[76:79], v[148:151], v[108:111]
    v_mfma_f32_16x16x32_bf16 v[132:135], v[76:79], v[152:155], v[132:135]
    s_barrier
    v_pk_mul_f32 v[56:57], v[88:89], v[88:89]
    v_pk_mul_f32 v[58:59], v[90:91], v[90:91]
    v_pk_mul_f32 v[60:61], v[92:93], v[92:93]
    v_pk_mul_f32 v[62:63], v[94:95], v[94:95]
    v_pk_fma_f32 v[56:57], v[56:57], v[138:139], v[136:137]
    v_pk_fma_f32 v[58:59], v[58:59], v[138:139], v[136:137]
    v_pk_fma_f32 v[60:61], v[60:61], v[138:139], v[136:137]
    v_pk_fma_f32 v[62:63], v[62:63], v[138:139], v[136:137]
    v_pk_mul_f32 v[56:57], v[56:57], v[88:89]
    v_pk_mul_f32 v[58:59], v[58:59], v[90:91]
    v_pk_mul_f32 v[60:61], v[60:61], v[92:93]
    v_pk_mul_f32 v[62:63], v[62:63], v[94:95]
    v_exp_f32 v56, v56
    v_exp_f32 v57, v57
    v_exp_f32 v58, v58
    v_exp_f32 v59, v59
    v_exp_f32 v60, v60
    v_exp_f32 v61, v61
    v_exp_f32 v62, v62
    v_exp_f32 v63, v63
    v_pk_fma_f32 v[56:57], v[56:57], v[144:145], v[144:145]
    v_pk_fma_f32 v[58:59], v[58:59], v[144:145], v[144:145]
    v_pk_fma_f32 v[60:61], v[60:61], v[144:145], v[144:145]
    v_pk_fma_f32 v[62:63], v[62:63], v[144:145], v[144:145]
    v_rcp_f32 v56, v56
    v_rcp_f32 v57, v57
    v_rcp_f32 v58, v58
    v_rcp_f32 v59, v59
    v_rcp_f32 v60, v60
    v_rcp_f32 v61, v61
    v_rcp_f32 v62, v62
    v_rcp_f32 v63, v63
    v_pk_mul_f32 v[88:89], v[88:89], v[56:57]
    v_pk_mul_f32 v[90:91], v[90:91], v[58:59]
    v_pk_mul_f32 v[92:93], v[92:93], v[60:61]
    v_pk_mul_f32 v[94:95], v[94:95], v[62:63]
    v_cvt_pk_bf16_f32 v168, v88, v89
    v_cvt_pk_bf16_f32 v169, v90, v91
    v_cvt_pk_bf16_f32 v170, v92, v93
    v_cvt_pk_bf16_f32 v171, v94, v95
    s_cmp_eq_u32 s47, 0
    s_cbranch_scc1 L70_slow
    buffer_store_dwordx4 v[168:171], v1, s[4:7], s87 offen offset:0 nt
L71_back:
    v_pk_mul_f32 v[64:65], v[112:113], v[112:113]
    v_pk_mul_f32 v[66:67], v[114:115], v[114:115]
    v_pk_mul_f32 v[68:69], v[116:117], v[116:117]
    v_pk_mul_f32 v[70:71], v[118:119], v[118:119]
    v_pk_fma_f32 v[64:65], v[64:65], v[142:143], v[140:141]
    v_pk_fma_f32 v[66:67], v[66:67], v[142:143], v[140:141]
    v_pk_fma_f32 v[68:69], v[68:69], v[142:143], v[140:141]
    v_pk_fma_f32 v[70:71], v[70:71], v[142:143], v[140:141]
    v_pk_mul_f32 v[64:65], v[64:65], v[112:113]
    v_pk_mul_f32 v[66:67], v[66:67], v[114:115]
    v_pk_mul_f32 v[68:69], v[68:69], v[116:117]
    v_pk_mul_f32 v[70:71], v[70:71], v[118:119]
    v_exp_f32 v64, v64
    v_exp_f32 v65, v65
    v_exp_f32 v66, v66
    v_exp_f32 v67, v67
    v_exp_f32 v68, v68
    v_exp_f32 v69, v69
    v_exp_f32 v70, v70
    v_exp_f32 v71, v71
    v_pk_fma_f32 v[64:65], v[64:65], v[146:147], v[146:147]
    v_pk_fma_f32 v[66:67], v[66:67], v[146:147], v[146:147]
    v_pk_fma_f32 v[68:69], v[68:69], v[146:147], v[146:147]
    v_pk_fma_f32 v[70:71], v[70:71], v[146:147], v[146:147]
    v_rcp_f32 v64, v64
    v_rcp_f32 v65, v65
    v_rcp_f32 v66, v66
    v_rcp_f32 v67, v67
    v_rcp_f32 v68, v68
    v_rcp_f32 v69, v69
    v_rcp_f32 v70, v70
    v_rcp_f32 v71, v71
    v_pk_mul_f32 v[112:113], v[112:113], v[64:65]
    v_pk_mul_f32 v[114:115], v[114:115], v[66:67]
    v_pk_mul_f32 v[116:117], v[116:117], v[68:69]
    v_pk_mul_f32 v[118:119], v[118:119], v[70:71]
    v_cvt_pk_bf16_f32 v172, v112, v113
    v_cvt_pk_bf16_f32 v173, v114, v115
    v_cvt_pk_bf16_f32 v174, v116, v117
    v_cvt_pk_bf16_f32 v175, v118, v119
    s_cmp_eq_u32 s47, 0
    s_cbranch_scc1 L72_slow
    buffer_store_dwordx4 v[172:175], v1, s[4:7], s84 offen offset:0 nt
L73_back:
    v_pk_mul_f32 v[56:57], v[96:97], v[96:97]
    v_pk_mul_f32 v[58:59], v[98:99], v[98:99]
    v_pk_mul_f32 v[60:61], v[100:101], v[100:101]
    v_pk_mul_f32 v[62:63], v[102:103], v[102:103]
    v_pk_fma_f32 v[56:57], v[56:57], v[138:139], v[136:137]
    v_pk_fma_f32 v[58:59], v[58:59], v[138:139], v[136:137]
    v_pk_fma_f32 v[60:61], v[60:61], v[138:139], v[136:137]
    v_pk_fma_f32 v[62:63], v[62:63], v[138:139], v[136:137]
    v_pk_mul_f32 v[56:57], v[56:57], v[96:97]
    v_pk_mul_f32 v[58:59], v[58:59], v[98:99]
    v_pk_mul_f32 v[60:61], v[60:61], v[100:101]
    v_pk_mul_f32 v[62:63], v[62:63], v[102:103]
    v_exp_f32 v56, v56
    v_exp_f32 v57, v57
    v_exp_f32 v58, v58
    v_exp_f32 v59, v59
    v_exp_f32 v60, v60
    v_exp_f32 v61, v61
    v_exp_f32 v62, v62
    v_exp_f32 v63, v63
    v_pk_fma_f32 v[56:57], v[56:57], v[144:145], v[144:145]
    v_pk_fma_f32 v[58:59], v[58:59], v[144:145], v[144:145]
    v_pk_fma_f32 v[60:61], v[60:61], v[144:145], v[144:145]
    v_pk_fma_f32 v[62:63], v[62:63], v[144:145], v[144:145]
    v_rcp_f32 v56, v56
    v_rcp_f32 v57, v57
    v_rcp_f32 v58, v58
    v_rcp_f32 v59, v59
    v_rcp_f32 v60, v60
    v_rcp_f32 v61, v61
    v_rcp_f32 v62, v62
    v_rcp_f32 v63, v63
    v_pk_mul_f32 v[96:97], v[96:97], v[56:57]
    v_pk_mul_f32 v[98:99], v[98:99], v[58:59]
    v_pk_mul_f32 v[100:101], v[100:101], v[60:61]
    v_pk_mul_f32 v[102:103], v[102:103], v[62:63]
    v_cvt_pk_bf16_f32 v176, v96, v97
    v_cvt_pk_bf16_f32 v177, v98, v99
    v_cvt_pk_bf16_f32 v178, v100, v101
    v_cvt_pk_bf16_f32 v179, v102, v103
    s_cmp_eq_u32 s47, 0
    s_cbranch_scc1 L74_slow
    buffer_store_dwordx4 v[176:179], v1, s[4:7], s87 offen offset:1024 nt
L75_back:
    v_pk_mul_f32 v[64:65], v[120:121], v[120:121]
    v_pk_mul_f32 v[66:67], v[122:123], v[122:123]
    v_pk_mul_f32 v[68:69], v[124:125], v[124:125]
    v_pk_mul_f32 v[70:71], v[126:127], v[126:127]
    v_pk_fma_f32 v[64:65], v[64:65], v[142:143], v[140:141]
    v_pk_fma_f32 v[66:67], v[66:67], v[142:143], v[140:141]
    v_pk_fma_f32 v[68:69], v[68:69], v[142:143], v[140:141]
    v_pk_fma_f32 v[70:71], v[70:71], v[142:143], v[140:141]
    v_pk_mul_f32 v[64:65], v[64:65], v[120:121]
    v_pk_mul_f32 v[66:67], v[66:67], v[122:123]
    v_pk_mul_f32 v[68:69], v[68:69], v[124:125]
    v_pk_mul_f32 v[70:71], v[70:71], v[126:127]
    v_exp_f32 v64, v64
    v_exp_f32 v65, v65
    v_exp_f32 v66, v66
    v_exp_f32 v67, v67
    v_exp_f32 v68, v68
    v_exp_f32 v69, v69
    v_exp_f32 v70, v70
    v_exp_f32 v71, v71
    v_pk_fma_f32 v[64:65], v[64:65], v[146:147], v[146:147]
    v_pk_fma_f32 v[66:67], v[66:67], v[146:147], v[146:147]
    v_pk_fma_f32 v[68:69], v[68:69], v[146:147], v[146:147]
    v_pk_fma_f32 v[70:71], v[70:71], v[146:147], v[146:147]
    v_rcp_f32 v64, v64
    v_rcp_f32 v65, v65
    v_rcp_f32 v66, v66
    v_rcp_f32 v67, v67
    v_rcp_f32 v68, v68
    v_rcp_f32 v69, v69
    v_rcp_f32 v70, v70
    v_rcp_f32 v71, v71
    v_pk_mul_f32 v[120:121], v[120:121], v[64:65]
    v_pk_mul_f32 v[122:123], v[122:123], v[66:67]
    v_pk_mul_f32 v[124:125], v[124:125], v[68:69]
    v_pk_mul_f32 v[126:127], v[126:127], v[70:71]
    v_cvt_pk_bf16_f32 v180, v120, v121
    v_cvt_pk_bf16_f32 v181, v122, v123
    v_cvt_pk_bf16_f32 v182, v124, v125
    v_cvt_pk_bf16_f32 v183, v126, v127
    s_cmp_eq_u32 s47, 0
    s_cbranch_scc1 L76_slow
    buffer_store_dwordx4 v[180:183], v1, s[4:7], s84 offen offset:1024 nt
L77_back:
    v_pk_mul_f32 v[56:57], v[104:105], v[104:105]
    v_pk_mul_f32 v[58:59], v[106:107], v[106:107]
    v_pk_mul_f32 v[60:61], v[108:109], v[108:109]
    v_pk_mul_f32 v[62:63], v[110:111], v[110:111]
    v_pk_fma_f32 v[56:57], v[56:57], v[138:139], v[136:137]
    v_pk_fma_f32 v[58:59], v[58:59], v[138:139], v[136:137]
    v_pk_fma_f32 v[60:61], v[60:61], v[138:139], v[136:137]
    v_pk_fma_f32 v[62:63], v[62:63], v[138:139], v[136:137]
    v_pk_mul_f32 v[56:57], v[56:57], v[104:105]
    v_pk_mul_f32 v[58:59], v[58:59], v[106:107]
    v_pk_mul_f32 v[60:61], v[60:61], v[108:109]
    v_pk_mul_f32 v[62:63], v[62:63], v[110:111]
    v_exp_f32 v56, v56
    v_exp_f32 v57, v57
    v_exp_f32 v58, v58
    v_exp_f32 v59, v59
    v_exp_f32 v60, v60
    v_exp_f32 v61, v61
    v_exp_f32 v62, v62
    v_exp_f32 v63, v63
    v_pk_fma_f32 v[56:57], v[56:57], v[144:145], v[144:145]
    v_pk_fma_f32 v[58:59], v[58:59], v[144:145], v[144:145]
    v_pk_fma_f32 v[60:61], v[60:61], v[144:145], v[144:145]
    v_pk_fma_f32 v[62:63], v[62:63], v[144:145], v[144:145]
    v_rcp_f32 v56, v56
    v_rcp_f32 v57, v57
    v_rcp_f32 v58, v58
    v_rcp_f32 v59, v59
    v_rcp_f32 v60, v60
    v_rcp_f32 v61, v61
    v_rcp_f32 v62, v62
    v_rcp_f32 v63, v63
    v_pk_mul_f32 v[104:105], v[104:105], v[56:57]
    v_pk_mul_f32 v[106:107], v[106:107], v[58:59]
    v_pk_mul_f32 v[108:109], v[108:109], v[60:61]
    v_pk_mul_f32 v[110:111], v[110:111], v[62:63]
    v_cvt_pk_bf16_f32 v184, v104, v105
    v_cvt_pk_bf16_f32 v185, v106, v107
    v_cvt_pk_bf16_f32 v186, v108, v109
    v_cvt_pk_bf16_f32 v187, v110, v111
    s_cmp_eq_u32 s47, 0
    s_cbranch_scc1 L78_slow
    buffer_store_dwordx4 v[184:187], v1, s[4:7], s87 offen offset:2048 nt
L79_back:
    v_pk_mul_f32 v[64:65], v[128:129], v[128:129]
    v_pk_mul_f32 v[66:67], v[130:131], v[130:131]
    v_pk_mul_f32 v[68:69], v[132:133], v[132:133]
    v_pk_mul_f32 v[70:71], v[134:135], v[134:135]
    v_pk_fma_f32 v[64:65], v[64:65], v[142:143], v[140:141]
    v_pk_fma_f32 v[66:67], v[66:67], v[142:143], v[140:141]
    v_pk_fma_f32 v[68:69], v[68:69], v[142:143], v[140:141]
    v_pk_fma_f32 v[70:71], v[70:71], v[142:143], v[140:141]
    v_pk_mul_f32 v[64:65], v[64:65], v[128:129]
    v_pk_mul_f32 v[66:67], v[66:67], v[130:131]
    v_pk_mul_f32 v[68:69], v[68:69], v[132:133]
    v_pk_mul_f32 v[70:71], v[70:71], v[134:135]
    v_exp_f32 v64, v64
    v_exp_f32 v65, v65
    v_exp_f32 v66, v66
    v_exp_f32 v67, v67
    v_exp_f32 v68, v68
    v_exp_f32 v69, v69
    v_exp_f32 v70, v70
    v_exp_f32 v71, v71
    v_pk_fma_f32 v[64:65], v[64:65], v[146:147], v[146:147]
    v_pk_fma_f32 v[66:67], v[66:67], v[146:147], v[146:147]
    v_pk_fma_f32 v[68:69], v[68:69], v[146:147], v[146:147]
    v_pk_fma_f32 v[70:71], v[70:71], v[146:147], v[146:147]
    s_waitcnt vmcnt(1)
    s_mov_b64 exec, 1
    s_cmp_eq_u32 s47, 0
    s_cbranch_scc1 L80_slow
    buffer_store_dword v48, v50, s[4:7], s88 offen
L81_back:
    s_mov_b64 exec, -1
    v_rcp_f32 v64, v64
    v_rcp_f32 v65, v65
    v_rcp_f32 v66, v66
    v_rcp_f32 v67, v67
    v_rcp_f32 v68, v68
    v_rcp_f32 v69, v69
    v_rcp_f32 v70, v70
    v_rcp_f32 v71, v71
    v_pk_mul_f32 v[128:129], v[128:129], v[64:65]
    v_pk_mul_f32 v[130:131], v[130:131], v[66:67]
    v_pk_mul_f32 v[132:133], v[132:133], v[68:69]
    v_pk_mul_f32 v[134:135], v[134:135], v[70:71]
    v_cvt_pk_bf16_f32 v188, v128, v129
    v_cvt_pk_bf16_f32 v189, v130, v131
    v_cvt_pk_bf16_f32 v190, v132, v133
    v_cvt_pk_bf16_f32 v191, v134, v135
    s_cmp_eq_u32 s47, 0
    s_cbranch_scc1 L82_slow
    buffer_store_dwordx4 v[188:191], v1, s[4:7], s84 offen offset:2048 nt
L83_back:
    ds_read_b128 v[56:59], v1 offset:0
    ds_read_b128 v[60:63], v1 offset:1024
    ds_read_b128 v[64:67], v1 offset:2048
    ds_read_b128 v[68:71], v1 offset:3072
    ds_read_b128 v[72:75], v1 offset:4096
    ds_read_b128 v[76:79], v1 offset:5120
    ds_read_b128 v[80:83], v1 offset:6144
    ds_read_b128 v[84:87], v1 offset:7168
    buffer_load_dword v7, v47, s[4:7], s75 offen sc1
    s_waitcnt lgkmcnt(6)
    v_mfma_f32_16x16x32_bf16 v[88:91], v[56:59], v[168:171], v[8:11]
    v_mfma_f32_16x16x32_bf16 v[108:111], v[56:59], v[172:175], 0
    ds_read_b128 v[56:59], v1 offset:8192
    v_mfma_f32_16x16x32_bf16 v[92:95], v[60:63], v[168:171], v[12:15]
    v_mfma_f32_16x16x32_bf16 v[112:115], v[60:63], v[172:175], 0
    ds_read_b128 v[60:63], v1 offset:9216
    s_waitcnt lgkmcnt(6)
    v_mfma_f32_16x16x32_bf16 v[96:99], v[64:67], v[168:171], v[16:19]
    v_mfma_f32_16x16x32_bf16 v[116:119], v[64:67], v[172:175], 0
    ds_read_b128 v[64:67], v1 offset:10240
    v_mfma_f32_16x16x32_bf16 v[100:103], v[68:71], v[168:171], v[20:23]
    v_mfma_f32_16x16x32_bf16 v[120:123], v[68:71], v[172:175], 0
    ds_read_b128 v[68:71], v1 offset:11264
    s_waitcnt lgkmcnt(7)
    v_mfma_f32_16x16x32_bf16 v[104:107], v[72:75], v[168:171], v[24:27]
    v_mfma_f32_16x16x32_bf16 v[124:127], v[72:75], v[172:175], 0
    ds_read_b128 v[72:75], v1 offset:12288
    s_waitcnt vmcnt(0)
    s_mov_b64 exec, 1
    s_cmp_eq_u32 s47, 0
    s_cbranch_scc1 L84_slow
    buffer_store_dword v49, v50, s[4:7], s88 offen
L85_back:
    s_mov_b64 exec, -1
    v_cmp_gt_u32 vcc, s76, v7
    s_cbranch_vccnz L86_ha
L87_had:
    buffer_load_dwordx4 v[192:195], v44, s[4:7], s89 offen offset:0 sc1
    buffer_load_dwordx4 v[196:199], v45, s[4:7], s89 offen offset:0 sc1
    buffer_load_dwordx4 v[200:203], v44, s[4:7], s89 offen offset:1024 sc1
    buffer_load_dwordx4 v[204:207], v45, s[4:7], s89 offen offset:1024 sc1
    s_waitcnt lgkmcnt(6)
    v_mfma_f32_16x16x32_bf16 v[88:91], v[76:79], v[176:179], v[88:91]
    buffer_load_dwordx4 v[144:147], v44, s[4:7], s90 offen offset:0 sc1
    v_mfma_f32_16x16x32_bf16 v[108:111], v[76:79], v[180:183], v[108:111]
    ds_read_b128 v[76:79], v1 offset:13312
    v_mfma_f32_16x16x32_bf16 v[92:95], v[80:83], v[176:179], v[92:95]
    v_mfma_f32_16x16x32_bf16 v[112:115], v[80:83], v[180:183], v[112:115]
    ds_read_b128 v[80:83], v1 offset:14336
    s_waitcnt lgkmcnt(6)
    v_mfma_f32_16x16x32_bf16 v[96:99], v[84:87], v[176:179], v[96:99]
    v_mfma_f32_16x16x32_bf16 v[116:119], v[84:87], v[180:183], v[116:119]
    ds_read_b128 v[84:87], v1 offset:15360
    v_mfma_f32_16x16x32_bf16 v[100:103], v[56:59], v[176:179], v[100:103]
    v_mfma_f32_16x16x32_bf16 v[120:123], v[56:59], v[180:183], v[120:123]
    ds_read_b128 v[56:59], v1 offset:16384
    s_waitcnt lgkmcnt(7)
    v_mfma_f32_16x16x32_bf16 v[104:107], v[60:63], v[176:179], v[104:107]
    v_mfma_f32_16x16x32_bf16 v[124:127], v[60:63], v[180:183], v[124:127]
    ds_read_b128 v[60:63], v1 offset:17408
    s_waitcnt lgkmcnt(6)
    v_mfma_f32_16x16x32_bf16 v[88:91], v[64:67], v[184:187], v[88:91]
    buffer_load_dwordx4 v[148:151], v45, s[4:7], s90 offen offset:0 sc1
    v_mfma_f32_16x16x32_bf16 v[108:111], v[64:67], v[188:191], v[108:111]
    ds_read_b128 v[64:67], v1 offset:18432
    v_mfma_f32_16x16x32_bf16 v[92:95], v[68:71], v[184:187], v[92:95]
    v_mfma_f32_16x16x32_bf16 v[112:115], v[68:71], v[188:191], v[112:115]
    ds_read_b128 v[68:71], v1 offset:19456
    s_waitcnt lgkmcnt(6)
    v_mfma_f32_16x16x32_bf16 v[96:99], v[72:75], v[184:187], v[96:99]
    buffer_load_dwordx4 v[152:155], v44, s[4:7], s90 offen offset:1024 sc1
    v_mfma_f32_16x16x32_bf16 v[116:119], v[72:75], v[188:191], v[116:119]
    ds_read_b128 v[72:75], v1 offset:20480
    v_mfma_f32_16x16x32_bf16 v[100:103], v[76:79], v[184:187], v[100:103]
    v_mfma_f32_16x16x32_bf16 v[120:123], v[76:79], v[188:191], v[120:123]
    ds_read_b128 v[76:79], v1 offset:21504
    s_waitcnt lgkmcnt(7)
    v_mfma_f32_16x16x32_bf16 v[104:107], v[80:83], v[184:187], v[104:107]
    v_mfma_f32_16x16x32_bf16 v[124:127], v[80:83], v[188:191], v[124:127]
    ds_read_b128 v[80:83], v1 offset:22528
    s_waitcnt vmcnt(5) lgkmcnt(6)
    v_mfma_f32_16x16x32_bf16 v[88:91], v[84:87], v[192:195], v[88:91]
    buffer_load_dwordx4 v[156:159], v45, s[4:7], s90 offen offset:1024 sc1
    v_mfma_f32_16x16x32_bf16 v[108:111], v[84:87], v[196:199], v[108:111]
    ds_read_b128 v[84:87], v1 offset:23552
    v_mfma_f32_16x16x32_bf16 v[92:95], v[56:59], v[192:195], v[92:95]
    v_mfma_f32_16x16x32_bf16 v[112:115], v[56:59], v[196:199], v[112:115]
    ds_read_b128 v[56:59], v1 offset:24576
    s_waitcnt lgkmcnt(6)
    v_mfma_f32_16x16x32_bf16 v[96:99], v[60:63], v[192:195], v[96:99]
    buffer_load_dwordx4 v[160:163], v44, s[4:7], s91 offen offset:0 sc1
    v_mfma_f32_16x16x32_bf16 v[116:119], v[60:63], v[196:199], v[116:119]
    ds_read_b128 v[60:63], v1 offset:25600
    v_mfma_f32_16x16x32_bf16 v[100:103], v[64:67], v[192:195], v[100:103]
    v_mfma_f32_16x16x32_bf16 v[120:123], v[64:67], v[196:199], v[120:123]
    ds_read_b128 v[64:67], v1 offset:26624
    s_waitcnt lgkmcnt(7)
    v_mfma_f32_16x16x32_bf16 v[104:107], v[68:71], v[192:195], v[104:107]
    v_mfma_f32_16x16x32_bf16 v[124:127], v[68:71], v[196:199], v[124:127]
    ds_read_b128 v[68:71], v1 offset:27648
    s_waitcnt vmcnt(5) lgkmcnt(6)
    v_mfma_f32_16x16x32_bf16 v[88:91], v[72:75], v[200:203], v[88:91]
    buffer_load_dwordx4 v[164:167], v45, s[4:7], s91 offen offset:0 sc1
    v_mfma_f32_16x16x32_bf16 v[108:111], v[72:75], v[204:207], v[108:111]
    ds_read_b128 v[72:75], v1 offset:28672
    v_mfma_f32_16x16x32_bf16 v[92:95], v[76:79], v[200:203], v[92:95]
    v_mfma_f32_16x16x32_bf16 v[112:115], v[76:79], v[204:207], v[112:115]
    ds_read_b128 v[76:79], v1 offset:29696
    s_waitcnt lgkmcnt(6)
    v_mfma_f32_16x16x32_bf16 v[96:99], v[80:83], v[200:203], v[96:99]
    buffer_load_dwordx4 v[168:171], v44, s[4:7], s91 offen offset:1024 sc1
    v_mfma_f32_16x16x32_bf16 v[116:119], v[80:83], v[204:207], v[116:119]
    ds_read_b128 v[80:83], v1 offset:30720
    v_mfma_f32_16x16x32_bf16 v[100:103], v[84:87], v[200:203], v[100:103]
    v_mfma_f32_16x16x32_bf16 v[120:123], v[84:87], v[204:207], v[120:123]
    ds_read_b128 v[84:87], v1 offset:31744
    s_waitcnt lgkmcnt(7)
    v_mfma_f32_16x16x32_bf16 v[104:107], v[56:59], v[200:203], v[104:107]
    v_mfma_f32_16x16x32_bf16 v[124:127], v[56:59], v[204:207], v[124:127]
    ds_read_b128 v[56:59], v1 offset:32768
    s_barrier
    s_waitcnt vmcnt(5) lgkmcnt(6)
    v_mfma_f32_16x16x32_bf16 v[88:91], v[60:63], v[144:147], v[88:91]
    buffer_load_dwordx4 v[172:175], v45, s[4:7], s91 offen offset:1024 sc1
    v_mfma_f32_16x16x32_bf16 v[108:111], v[60:63], v[148:151], v[108:111]
    ds_read_b128 v[60:63], v1 offset:33792
    v_mfma_f32_16x16x32_bf16 v[92:95], v[64:67], v[144:147], v[92:95]
    v_mfma_f32_16x16x32_bf16 v[112:115], v[64:67], v[148:151], v[112:115]
    ds_read_b128 v[64:67], v1 offset:34816
    s_waitcnt lgkmcnt(6)
    v_mfma_f32_16x16x32_bf16 v[96:99], v[68:71], v[144:147], v[96:99]
    buffer_load_dwordx4 v[176:179], v44, s[4:7], s92 offen offset:0 sc1
    v_mfma_f32_16x16x32_bf16 v[116:119], v[68:71], v[148:151], v[116:119]
    ds_read_b128 v[68:71], v1 offset:35840
    v_mfma_f32_16x16x32_bf16 v[100:103], v[72:75], v[144:147], v[100:103]
    v_mfma_f32_16x16x32_bf16 v[120:123], v[72:75], v[148:151], v[120:123]
    ds_read_b128 v[72:75], v1 offset:36864
    s_waitcnt lgkmcnt(7)
    v_mfma_f32_16x16x32_bf16 v[104:107], v[76:79], v[144:147], v[104:107]
    v_mfma_f32_16x16x32_bf16 v[124:127], v[76:79], v[148:151], v[124:127]
    ds_read_b128 v[76:79], v1 offset:37888
    buffer_load_dword v7, v46, s[4:7], s74 offen sc1
    s_waitcnt vmcnt(6) lgkmcnt(6)
    v_mfma_f32_16x16x32_bf16 v[88:91], v[80:83], v[152:155], v[88:91]
    buffer_load_dwordx4 v[180:183], v45, s[4:7], s92 offen offset:0 sc1
    v_mfma_f32_16x16x32_bf16 v[108:111], v[80:83], v[156:159], v[108:111]
    ds_read_b128 v[80:83], v1 offset:38912
    v_mfma_f32_16x16x32_bf16 v[92:95], v[84:87], v[152:155], v[92:95]
    v_mfma_f32_16x16x32_bf16 v[112:115], v[84:87], v[156:159], v[112:115]
    ds_read_b128 v[84:87], v1 offset:39936
    s_waitcnt lgkmcnt(6)
    v_mfma_f32_16x16x32_bf16 v[96:99], v[56:59], v[152:155], v[96:99]
    buffer_load_dwordx4 v[184:187], v45, s[4:7], s92 offen offset:1024 sc1
    v_mfma_f32_16x16x32_bf16 v[116:119], v[56:59], v[156:159], v[116:119]
    ds_read_b128 v[56:59], v1 offset:40960
    v_mfma_f32_16x16x32_bf16 v[100:103], v[60:63], v[152:155], v[100:103]
    v_mfma_f32_16x16x32_bf16 v[120:123], v[60:63], v[156:159], v[120:123]
    ds_read_b128 v[60:63], v1 offset:41984
    s_waitcnt lgkmcnt(7)
    v_mfma_f32_16x16x32_bf16 v[104:107], v[64:67], v[152:155], v[104:107]
    v_mfma_f32_16x16x32_bf16 v[124:127], v[64:67], v[156:159], v[124:127]
    ds_read_b128 v[64:67], v1 offset:43008
    s_waitcnt vmcnt(6) lgkmcnt(6)
    v_mfma_f32_16x16x32_bf16 v[88:91], v[68:71], v[160:163], v[88:91]
    buffer_load_dwordx4 v[188:191], v45, s[4:7], s94 offen offset:0 sc1
    v_mfma_f32_16x16x32_bf16 v[108:111], v[68:71], v[164:167], v[108:111]
    ds_read_b128 v[68:71], v1 offset:44032
    v_mfma_f32_16x16x32_bf16 v[92:95], v[72:75], v[160:163], v[92:95]
    v_mfma_f32_16x16x32_bf16 v[112:115], v[72:75], v[164:167], v[112:115]
    ds_read_b128 v[72:75], v1 offset:45056
    s_waitcnt lgkmcnt(6)
    v_mfma_f32_16x16x32_bf16 v[96:99], v[76:79], v[160:163], v[96:99]
    buffer_load_dwordx4 v[192:195], v45, s[4:7], s94 offen offset:1024 sc1
    v_mfma_f32_16x16x32_bf16 v[116:119], v[76:79], v[164:167], v[116:119]
    ds_read_b128 v[76:79], v1 offset:46080
    v_mfma_f32_16x16x32_bf16 v[100:103], v[80:83], v[160:163], v[100:103]
    v_mfma_f32_16x16x32_bf16 v[120:123], v[80:83], v[164:167], v[120:123]
    ds_read_b128 v[80:83], v1 offset:47104
    s_waitcnt lgkmcnt(7)
    v_mfma_f32_16x16x32_bf16 v[104:107], v[84:87], v[160:163], v[104:107]
    v_mfma_f32_16x16x32_bf16 v[124:127], v[84:87], v[164:167], v[124:127]
    ds_read_b128 v[84:87], v1 offset:48128
    s_waitcnt vmcnt(6) lgkmcnt(6)
    v_mfma_f32_16x16x32_bf16 v[88:91], v[56:59], v[168:171], v[88:91]
    buffer_load_dwordx4 v[196:199], v45, s[4:7], s95 offen offset:0 sc1
    v_mfma_f32_16x16x32_bf16 v[108:111], v[56:59], v[172:175], v[108:111]
    ds_read_b128 v[56:59], v1 offset:49152
    v_mfma_f32_16x16x32_bf16 v[92:95], v[60:63], v[168:171], v[92:95]
    v_mfma_f32_16x16x32_bf16 v[112:115], v[60:63], v[172:175], v[112:115]
    ds_read_b128 v[60:63], v1 offset:50176
    s_waitcnt lgkmcnt(6)
    v_mfma_f32_16x16x32_bf16 v[96:99], v[64:67], v[168:171], v[96:99]
    buffer_load_dwordx4 v[200:203], v45, s[4:7], s95 offen offset:1024 sc1
    v_mfma_f32_16x16x32_bf16 v[116:119], v[64:67], v[172:175], v[116:119]
    ds_read_b128 v[64:67], v1 offset:51200
    v_mfma_f32_16x16x32_bf16 v[100:103], v[68:71], v[168:171], v[100:103]
    v_mfma_f32_16x16x32_bf16 v[120:123], v[68:71], v[172:175], v[120:123]
    ds_read_b128 v[68:71], v1 offset:52224
    s_waitcnt lgkmcnt(7)
    v_mfma_f32_16x16x32_bf16 v[104:107], v[72:75], v[168:171], v[104:107]
    v_mfma_f32_16x16x32_bf16 v[124:127], v[72:75], v[172:175], v[124:127]
    ds_read_b128 v[72:75], v1 offset:53248
    s_waitcnt vmcnt(5) lgkmcnt(6)
    v_mfma_f32_16x16x32_bf16 v[88:91], v[76:79], v[176:179], v[88:91]
    buffer_load_dwordx4 v[204:207], v45, s[4:7], s101 offen offset:0 sc1
    v_mfma_f32_16x16x32_bf16 v[108:111], v[76:79], v[180:183], v[108:111]
    ds_read_b128 v[76:79], v1 offset:54272
    v_mfma_f32_16x16x32_bf16 v[92:95], v[80:83], v[176:179], v[92:95]
    v_mfma_f32_16x16x32_bf16 v[112:115], v[80:83], v[180:183], v[112:115]
    ds_read_b128 v[80:83], v1 offset:55296
    s_waitcnt lgkmcnt(6)
    v_mfma_f32_16x16x32_bf16 v[96:99], v[84:87], v[176:179], v[96:99]
    buffer_load_dwordx4 v[144:147], v45, s[4:7], s101 offen offset:1024 sc1
    v_mfma_f32_16x16x32_bf16 v[116:119], v[84:87], v[180:183], v[116:119]
    ds_read_b128 v[84:87], v1 offset:56320
    v_mfma_f32_16x16x32_bf16 v[100:103], v[56:59], v[176:179], v[100:103]
    v_mfma_f32_16x16x32_bf16 v[120:123], v[56:59], v[180:183], v[120:123]
    ds_read_b128 v[56:59], v1 offset:57344
    s_waitcnt lgkmcnt(7)
    v_mfma_f32_16x16x32_bf16 v[104:107], v[60:63], v[176:179], v[104:107]
    v_mfma_f32_16x16x32_bf16 v[124:127], v[60:63], v[180:183], v[124:127]
    ds_read_b128 v[60:63], v1 offset:58368
    s_waitcnt vmcnt(6) lgkmcnt(6)
    v_mfma_f32_16x16x32_bf16 v[108:111], v[64:67], v[184:187], v[108:111]
    ds_read_b128 v[64:67], v1 offset:59392
    v_mfma_f32_16x16x32_bf16 v[112:115], v[68:71], v[184:187], v[112:115]
    ds_read_b128 v[68:71], v1 offset:60416
    s_waitcnt lgkmcnt(6)
    v_mfma_f32_16x16x32_bf16 v[116:119], v[72:75], v[184:187], v[116:119]
    ds_read_b128 v[72:75], v43 offset:0
    v_mfma_f32_16x16x32_bf16 v[120:123], v[76:79], v[184:187], v[120:123]
    ds_read_b128 v[76:79], v43 offset:1024
    s_waitcnt lgkmcnt(7)
    v_mfma_f32_16x16x32_bf16 v[124:127], v[80:83], v[184:187], v[124:127]
    ds_read_b128 v[80:83], v43 offset:2048
    v_cmp_gt_u32 vcc, s77, v7
    s_cbranch_vccnz L90_hb
L91_hbd:
    s_waitcnt vmcnt(5) lgkmcnt(6)
    v_mfma_f32_16x16x32_bf16 v[108:111], v[84:87], v[188:191], v[108:111]
    ds_read_b128 v[84:87], v43 offset:3072
    buffer_load_dwordx4 v[148:151], v45, s[4:7], s89 offen offset:2048 sc1
    v_mfma_f32_16x16x32_bf16 v[112:115], v[56:59], v[188:191], v[112:115]
    ds_read_b128 v[56:59], v43 offset:4096
    s_waitcnt lgkmcnt(6)
    v_mfma_f32_16x16x32_bf16 v[116:119], v[60:63], v[188:191], v[116:119]
    ds_read_b128 v[60:63], v43 offset:5120
    buffer_load_dwordx4 v[152:155], v45, s[4:7], s90 offen offset:2048 sc1
    v_mfma_f32_16x16x32_bf16 v[120:123], v[64:67], v[188:191], v[120:123]
    ds_read_b128 v[64:67], v43 offset:6144
    s_waitcnt lgkmcnt(7)
    v_mfma_f32_16x16x32_bf16 v[124:127], v[68:71], v[188:191], v[124:127]
    ds_read_b128 v[68:71], v43 offset:7168
    s_waitcnt vmcnt(6) lgkmcnt(6)
    v_mfma_f32_16x16x32_bf16 v[108:111], v[72:75], v[192:195], v[108:111]
    ds_read_b128 v[72:75], v43 offset:8192
    buffer_load_dwordx4 v[156:159], v45, s[4:7], s91 offen offset:2048 sc1
    v_mfma_f32_16x16x32_bf16 v[112:115], v[76:79], v[192:195], v[112:115]
    ds_read_b128 v[76:79], v43 offset:9216
    s_waitcnt lgkmcnt(6)
    v_mfma_f32_16x16x32_bf16 v[116:119], v[80:83], v[192:195], v[116:119]
    ds_read_b128 v[80:83], v43 offset:10240
    buffer_load_dwordx4 v[160:163], v45, s[4:7], s92 offen offset:2048 sc1
    v_mfma_f32_16x16x32_bf16 v[120:123], v[84:87], v[192:195], v[120:123]
    ds_read_b128 v[84:87], v43 offset:11264
    s_waitcnt lgkmcnt(7)
    v_mfma_f32_16x16x32_bf16 v[124:127], v[56:59], v[192:195], v[124:127]
    ds_read_b128 v[56:59], v43 offset:12288
    s_waitcnt vmcnt(7) lgkmcnt(6)
    v_mfma_f32_16x16x32_bf16 v[108:111], v[60:63], v[196:199], v[108:111]
    ds_read_b128 v[60:63], v43 offset:13312
    buffer_load_dwordx4 v[164:167], v45, s[4:7], s94 offen offset:2048 sc1
    v_mfma_f32_16x16x32_bf16 v[112:115], v[64:67], v[196:199], v[112:115]
    ds_read_b128 v[64:67], v43 offset:14336
    s_waitcnt lgkmcnt(6)
    v_mfma_f32_16x16x32_bf16 v[116:119], v[68:71], v[196:199], v[116:119]
    ds_read_b128 v[68:71], v43 offset:15360
    v_mfma_f32_16x16x32_bf16 v[120:123], v[72:75], v[196:199], v[120:123]
    ds_read_b128 v[72:75], v43 offset:16384
    s_waitcnt lgkmcnt(7)
    v_mfma_f32_16x16x32_bf16 v[124:127], v[76:79], v[196:199], v[124:127]
    ds_read_b128 v[76:79], v43 offset:17408
    s_barrier
    s_waitcnt vmcnt(7) lgkmcnt(6)
    v_mfma_f32_16x16x32_bf16 v[108:111], v[80:83], v[200:203], v[108:111]
    ds_read_b128 v[80:83], v43 offset:18432
    buffer_load_dwordx4 v[168:171], v45, s[4:7], s95 offen offset:2048 sc1
    v_mfma_f32_16x16x32_bf16 v[112:115], v[84:87], v[200:203], v[112:115]
    ds_read_b128 v[84:87], v43 offset:19456
    s_waitcnt lgkmcnt(6)
    v_mfma_f32_16x16x32_bf16 v[116:119], v[56:59], v[200:203], v[116:119]
    ds_read_b128 v[56:59], v43 offset:20480
    v_mfma_f32_16x16x32_bf16 v[120:123], v[60:63], v[200:203], v[120:123]
    ds_read_b128 v[60:63], v43 offset:21504
    s_waitcnt lgkmcnt(7)
    v_mfma_f32_16x16x32_bf16 v[124:127], v[64:67], v[200:203], v[124:127]
    ds_read_b128 v[64:67], v43 offset:22528
    s_waitcnt vmcnt(7) lgkmcnt(6)
    v_mfma_f32_16x16x32_bf16 v[108:111], v[68:71], v[204:207], v[108:111]
    ds_read_b128 v[68:71], v43 offset:23552
    buffer_load_dwordx4 v[172:175], v45, s[4:7], s101 offen offset:2048 sc1
    v_mfma_f32_16x16x32_bf16 v[112:115], v[72:75], v[204:207], v[112:115]
    ds_read_b128 v[72:75], v43 offset:24576
    s_waitcnt lgkmcnt(6)
    v_mfma_f32_16x16x32_bf16 v[116:119], v[76:79], v[204:207], v[116:119]
    ds_read_b128 v[76:79], v43 offset:25600
    v_mfma_f32_16x16x32_bf16 v[120:123], v[80:83], v[204:207], v[120:123]
    ds_read_b128 v[80:83], v43 offset:26624
    s_waitcnt lgkmcnt(7)
    v_mfma_f32_16x16x32_bf16 v[124:127], v[84:87], v[204:207], v[124:127]
    ds_read_b128 v[84:87], v43 offset:27648
    s_waitcnt vmcnt(7) lgkmcnt(6)
    v_mfma_f32_16x16x32_bf16 v[108:111], v[56:59], v[144:147], v[108:111]
    ds_read_b128 v[56:59], v43 offset:28672
    buffer_load_dwordx4 v[176:179], v44, s[4:7], s92 offen offset:1024 sc1
    v_mfma_f32_16x16x32_bf16 v[112:115], v[60:63], v[144:147], v[112:115]
    ds_read_b128 v[60:63], v43 offset:29696
    s_waitcnt lgkmcnt(6)
    v_mfma_f32_16x16x32_bf16 v[116:119], v[64:67], v[144:147], v[116:119]
    ds_read_b128 v[64:67], v43 offset:30720
    v_mfma_f32_16x16x32_bf16 v[120:123], v[68:71], v[144:147], v[120:123]
    ds_read_b128 v[68:71], v43 offset:31744
    s_waitcnt lgkmcnt(7)
    v_mfma_f32_16x16x32_bf16 v[124:127], v[72:75], v[144:147], v[124:127]
    ds_read_b128 v[72:75], v43 offset:32768
    s_waitcnt vmcnt(7) lgkmcnt(6)
    v_mfma_f32_16x16x32_bf16 v[108:111], v[76:79], v[148:151], v[108:111]
    ds_read_b128 v[76:79], v43 offset:33792
    buffer_load_dwordx4 v[180:183], v44, s[4:7], s94 offen offset:0 sc1
    v_mfma_f32_16x16x32_bf16 v[112:115], v[80:83], v[148:151], v[112:115]
    ds_read_b128 v[80:83], v43 offset:34816
    s_waitcnt lgkmcnt(6)
    v_mfma_f32_16x16x32_bf16 v[116:119], v[84:87], v[148:151], v[116:119]
    ds_read_b128 v[84:87], v43 offset:35840
    v_mfma_f32_16x16x32_bf16 v[120:123], v[56:59], v[148:151], v[120:123]
    ds_read_b128 v[56:59], v43 offset:36864
    s_waitcnt lgkmcnt(7)
    v_mfma_f32_16x16x32_bf16 v[124:127], v[60:63], v[148:151], v[124:127]
    ds_read_b128 v[60:63], v43 offset:37888
    s_waitcnt vmcnt(7) lgkmcnt(6)
    v_mfma_f32_16x16x32_bf16 v[108:111], v[64:67], v[152:155], v[108:111]
    ds_read_b128 v[64:67], v43 offset:38912
    buffer_load_dwordx4 v[184:187], v44, s[4:7], s94 offen offset:1024 sc1
    v_mfma_f32_16x16x32_bf16 v[112:115], v[68:71], v[152:155], v[112:115]
    ds_read_b128 v[68:71], v43 offset:39936
    s_waitcnt lgkmcnt(6)
    v_mfma_f32_16x16x32_bf16 v[116:119], v[72:75], v[152:155], v[116:119]
    ds_read_b128 v[72:75], v43 offset:40960
    v_mfma_f32_16x16x32_bf16 v[120:123], v[76:79], v[152:155], v[120:123]
    ds_read_b128 v[76:79], v43 offset:41984
    s_waitcnt lgkmcnt(7)
    v_mfma_f32_16x16x32_bf16 v[124:127], v[80:83], v[152:155], v[124:127]
    ds_read_b128 v[80:83], v43 offset:43008
    s_waitcnt vmcnt(7) lgkmcnt(6)
    v_mfma_f32_16x16x32_bf16 v[108:111], v[84:87], v[156:159], v[108:111]
    ds_read_b128 v[84:87], v43 offset:44032
    buffer_load_dwordx4 v[188:191], v44, s[4:7], s95 offen offset:0 sc1
    v_mfma_f32_16x16x32_bf16 v[112:115], v[56:59], v[156:159], v[112:115]
    ds_read_b128 v[56:59], v43 offset:45056
    s_waitcnt lgkmcnt(6)
    v_mfma_f32_16x16x32_bf16 v[116:119], v[60:63], v[156:159], v[116:119]
    ds_read_b128 v[60:63], v43 offset:46080
    v_mfma_f32_16x16x32_bf16 v[120:123], v[64:67], v[156:159], v[120:123]
    ds_read_b128 v[64:67], v43 offset:47104
    s_waitcnt lgkmcnt(7)
    v_mfma_f32_16x16x32_bf16 v[124:127], v[68:71], v[156:159], v[124:127]
    ds_read_b128 v[68:71], v43 offset:48128
    s_waitcnt vmcnt(7) lgkmcnt(6)
    v_mfma_f32_16x16x32_bf16 v[108:111], v[72:75], v[160:163], v[108:111]
    ds_read_b128 v[72:75], v43 offset:49152
    buffer_load_dwordx4 v[192:195], v44, s[4:7], s95 offen offset:1024 sc1
    v_mfma_f32_16x16x32_bf16 v[112:115], v[76:79], v[160:163], v[112:115]
    ds_read_b128 v[76:79], v43 offset:50176
    s_waitcnt lgkmcnt(6)
    v_mfma_f32_16x16x32_bf16 v[116:119], v[80:83], v[160:163], v[116:119]
    ds_read_b128 v[80:83], v43 offset:51200
    v_mfma_f32_16x16x32_bf16 v[120:123], v[84:87], v[160:163], v[120:123]
    ds_read_b128 v[84:87], v43 offset:52224
    s_waitcnt lgkmcnt(7)
    v_mfma_f32_16x16x32_bf16 v[124:127], v[56:59], v[160:163], v[124:127]
    ds_read_b128 v[56:59], v43 offset:53248
    s_waitcnt vmcnt(7) lgkmcnt(6)
    v_mfma_f32_16x16x32_bf16 v[108:111], v[60:63], v[164:167], v[108:111]
    ds_read_b128 v[60:63], v43 offset:54272
    buffer_load_dwordx4 v[196:199], v44, s[4:7], s101 offen offset:0 sc1
    v_mfma_f32_16x16x32_bf16 v[112:115], v[64:67], v[164:167], v[112:115]
    ds_read_b128 v[64:67], v43 offset:55296
    s_waitcnt lgkmcnt(6)
    v_mfma_f32_16x16x32_bf16 v[116:119], v[68:71], v[164:167], v[116:119]
    ds_read_b128 v[68:71], v43 offset:56320
    v_mfma_f32_16x16x32_bf16 v[120:123], v[72:75], v[164:167], v[120:123]
    ds_read_b128 v[72:75], v43 offset:57344
    s_waitcnt lgkmcnt(7)
    v_mfma_f32_16x16x32_bf16 v[124:127], v[76:79], v[164:167], v[124:127]
    ds_read_b128 v[76:79], v43 offset:58368
    s_waitcnt vmcnt(7) lgkmcnt(6)
    v_mfma_f32_16x16x32_bf16 v[108:111], v[80:83], v[168:171], v[108:111]
    ds_read_b128 v[80:83], v43 offset:59392
    buffer_load_dwordx4 v[200:203], v44, s[4:7], s101 offen offset:1024 sc1
    v_mfma_f32_16x16x32_bf16 v[112:115], v[84:87], v[168:171], v[112:115]
    ds_read_b128 v[84:87], v43 offset:60416
    s_waitcnt lgkmcnt(6)
    v_mfma_f32_16x16x32_bf16 v[116:119], v[56:59], v[168:171], v[116:119]
    ds_read_b128 v[56:59], v1 offset:51200
    v_mfma_f32_16x16x32_bf16 v[120:123], v[60:63], v[168:171], v[120:123]
    ds_read_b128 v[60:63], v1 offset:52224
    s_waitcnt lgkmcnt(7)
    v_mfma_f32_16x16x32_bf16 v[124:127], v[64:67], v[168:171], v[124:127]
    ds_read_b128 v[64:67], v1 offset:53248
    s_waitcnt vmcnt(7) lgkmcnt(6)
    v_mfma_f32_16x16x32_bf16 v[108:111], v[68:71], v[172:175], v[108:111]
    ds_read_b128 v[68:71], v1 offset:54272
    buffer_load_dwordx4 v[204:207], v44, s[4:7], s89 offen offset:2048 sc1
    v_mfma_f32_16x16x32_bf16 v[112:115], v[72:75], v[172:175], v[112:115]
    ds_read_b128 v[72:75], v1 offset:55296
    s_waitcnt lgkmcnt(6)
    v_mfma_f32_16x16x32_bf16 v[116:119], v[76:79], v[172:175], v[116:119]
    ds_read_b128 v[76:79], v1 offset:56320
    v_mfma_f32_16x16x32_bf16 v[120:123], v[80:83], v[172:175], v[120:123]
    ds_read_b128 v[80:83], v1 offset:57344
    s_waitcnt lgkmcnt(7)
    v_mfma_f32_16x16x32_bf16 v[124:127], v[84:87], v[172:175], v[124:127]
    ds_read_b128 v[84:87], v1 offset:58368
    s_waitcnt vmcnt(7) lgkmcnt(6)
    v_mfma_f32_16x16x32_bf16 v[88:91], v[56:59], v[176:179], v[88:91]
    ds_read_b128 v[56:59], v1 offset:59392
    buffer_load_dwordx4 v[144:147], v44, s[4:7], s90 offen offset:2048 sc1
    v_mfma_f32_16x16x32_bf16 v[92:95], v[60:63], v[176:179], v[92:95]
    ds_read_b128 v[60:63], v1 offset:60416
    s_waitcnt lgkmcnt(6)
    v_mfma_f32_16x16x32_bf16 v[96:99], v[64:67], v[176:179], v[96:99]
    ds_read_b128 v[64:67], v43 offset:0
    v_mfma_f32_16x16x32_bf16 v[100:103], v[68:71], v[176:179], v[100:103]
    ds_read_b128 v[68:71], v43 offset:1024
    s_waitcnt lgkmcnt(7)
    v_mfma_f32_16x16x32_bf16 v[104:107], v[72:75], v[176:179], v[104:107]
    ds_read_b128 v[72:75], v43 offset:2048
    v_cvt_pk_bf16_f32 v128, v108, v109
    v_cvt_pk_bf16_f32 v129, v110, v111
    v_cvt_pk_bf16_f32 v130, v112, v113
    v_cvt_pk_bf16_f32 v131, v114, v115
    v_cvt_pk_bf16_f32 v132, v116, v117
    v_cvt_pk_bf16_f32 v133, v118, v119
    v_cvt_pk_bf16_f32 v134, v120, v121
    v_cvt_pk_bf16_f32 v135, v122, v123
    v_cvt_pk_bf16_f32 v136, v124, v125
    v_cvt_pk_bf16_f32 v137, v126, v127
    s_cmp_eq_u32 s47, 0
    s_cbranch_scc1 L94_slow
    buffer_store_dwordx4 v[128:131], v1, s[4:7], s70 offen nt
    buffer_store_dwordx4 v[132:135], v1, s[4:7], s70 offen offset:1024 nt
    buffer_store_dwordx2 v[136:137], v1, s[4:7], s71 offen nt
L95_back:
    s_waitcnt vmcnt(10) lgkmcnt(6)
    v_mfma_f32_16x16x32_bf16 v[88:91], v[76:79], v[180:183], v[88:91]
    ds_read_b128 v[76:79], v43 offset:3072
    buffer_load_dwordx4 v[148:151], v44, s[4:7], s91 offen offset:2048 sc1
    v_mfma_f32_16x16x32_bf16 v[92:95], v[80:83], v[180:183], v[92:95]
    ds_read_b128 v[80:83], v43 offset:4096
    s_waitcnt lgkmcnt(6)
    v_mfma_f32_16x16x32_bf16 v[96:99], v[84:87], v[180:183], v[96:99]
    ds_read_b128 v[84:87], v43 offset:5120
    v_mfma_f32_16x16x32_bf16 v[100:103], v[56:59], v[180:183], v[100:103]
    ds_read_b128 v[56:59], v43 offset:6144
    s_waitcnt lgkmcnt(7)
    v_mfma_f32_16x16x32_bf16 v[104:107], v[60:63], v[180:183], v[104:107]
    ds_read_b128 v[60:63], v43 offset:7168
    s_waitcnt vmcnt(10) lgkmcnt(6)
    v_mfma_f32_16x16x32_bf16 v[88:91], v[64:67], v[184:187], v[88:91]
    ds_read_b128 v[64:67], v43 offset:8192
    buffer_load_dwordx4 v[152:155], v44, s[4:7], s92 offen offset:2048 sc1
    v_mfma_f32_16x16x32_bf16 v[92:95], v[68:71], v[184:187], v[92:95]
    ds_read_b128 v[68:71], v43 offset:9216
    s_waitcnt lgkmcnt(6)
    v_mfma_f32_16x16x32_bf16 v[96:99], v[72:75], v[184:187], v[96:99]
    ds_read_b128 v[72:75], v43 offset:10240
    v_mfma_f32_16x16x32_bf16 v[100:103], v[76:79], v[184:187], v[100:103]
    ds_read_b128 v[76:79], v43 offset:11264
    s_waitcnt lgkmcnt(7)
    v_mfma_f32_16x16x32_bf16 v[104:107], v[80:83], v[184:187], v[104:107]
    ds_read_b128 v[80:83], v43 offset:12288
    s_waitcnt vmcnt(10) lgkmcnt(6)
    v_mfma_f32_16x16x32_bf16 v[88:91], v[84:87], v[188:191], v[88:91]
    ds_read_b128 v[84:87], v43 offset:13312
    buffer_load_dwordx4 v[156:159], v44, s[4:7], s94 offen offset:2048 sc1
    v_mfma_f32_16x16x32_bf16 v[92:95], v[56:59], v[188:191], v[92:95]
    ds_read_b128 v[56:59], v43 offset:14336
    s_waitcnt lgkmcnt(6)
    v_mfma_f32_16x16x32_bf16 v[96:99], v[60:63], v[188:191], v[96:99]
    ds_read_b128 v[60:63], v43 offset:15360
    v_mfma_f32_16x16x32_bf16 v[100:103], v[64:67], v[188:191], v[100:103]
    ds_read_b128 v[64:67], v43 offset:16384
    s_waitcnt lgkmcnt(7)
    v_mfma_f32_16x16x32_bf16 v[104:107], v[68:71], v[188:191], v[104:107]
    ds_read_b128 v[68:71], v43 offset:17408
    s_waitcnt vmcnt(10) lgkmcnt(6)
    v_mfma_f32_16x16x32_bf16 v[88:91], v[72:75], v[192:195], v[88:91]
    ds_read_b128 v[72:75], v43 offset:18432
    buffer_load_dwordx4 v[160:163], v44, s[4:7], s95 offen offset:2048 sc1
    v_mfma_f32_16x16x32_bf16 v[92:95], v[76:79], v[192:195], v[92:95]
    ds_read_b128 v[76:79], v43 offset:19456
    s_waitcnt lgkmcnt(6)
    v_mfma_f32_16x16x32_bf16 v[96:99], v[80:83], v[192:195], v[96:99]
    ds_read_b128 v[80:83], v43 offset:20480
    v_mfma_f32_16x16x32_bf16 v[100:103], v[84:87], v[192:195], v[100:103]
    ds_read_b128 v[84:87], v43 offset:21504
    s_waitcnt lgkmcnt(7)
    v_mfma_f32_16x16x32_bf16 v[104:107], v[56:59], v[192:195], v[104:107]
    ds_read_b128 v[56:59], v43 offset:22528
    s_waitcnt vmcnt(4)
    s_mov_b64 exec, 1
    s_cmp_eq_u32 s47, 0
    s_cbranch_scc1 L96_slow
    buffer_store_dword v49, v50, s[4:7], s72 offen
L97_back:
    s_mov_b64 exec, -1
    s_waitcnt lgkmcnt(6)
    v_mfma_f32_16x16x32_bf16 v[88:91], v[60:63], v[196:199], v[88:91]
    ds_read_b128 v[60:63], v43 offset:23552
    buffer_load_dwordx4 v[164:167], v44, s[4:7], s101 offen offset:2048 sc1
    v_mfma_f32_16x16x32_bf16 v[92:95], v[64:67], v[196:199], v[92:95]
    ds_read_b128 v[64:67], v43 offset:24576
    s_waitcnt lgkmcnt(6)
    v_mfma_f32_16x16x32_bf16 v[96:99], v[68:71], v[196:199], v[96:99]
    ds_read_b128 v[68:71], v43 offset:25600
    v_mfma_f32_16x16x32_bf16 v[100:103], v[72:75], v[196:199], v[100:103]
    ds_read_b128 v[72:75], v43 offset:26624
    s_waitcnt lgkmcnt(7)
    v_mfma_f32_16x16x32_bf16 v[104:107], v[76:79], v[196:199], v[104:107]
    ds_read_b128 v[76:79], v43 offset:27648
    s_waitcnt lgkmcnt(6)
    v_mfma_f32_16x16x32_bf16 v[88:91], v[80:83], v[200:203], v[88:91]
    ds_read_b128 v[80:83], v43 offset:28672
    v_mfma_f32_16x16x32_bf16 v[92:95], v[84:87], v[200:203], v[92:95]
    ds_read_b128 v[84:87], v43 offset:29696
    s_waitcnt lgkmcnt(6)
    v_mfma_f32_16x16x32_bf16 v[96:99], v[56:59], v[200:203], v[96:99]
    ds_read_b128 v[56:59], v43 offset:30720
    v_mfma_f32_16x16x32_bf16 v[100:103], v[60:63], v[200:203], v[100:103]
    ds_read_b128 v[60:63], v43 offset:31744
    s_waitcnt lgkmcnt(7)
    v_mfma_f32_16x16x32_bf16 v[104:107], v[64:67], v[200:203], v[104:107]
    ds_read_b128 v[64:67], v43 offset:32768
    buffer_load_dword v7, v50, s[4:7], s73 offen sc1
    s_waitcnt lgkmcnt(6)
    v_mfma_f32_16x16x32_bf16 v[88:91], v[68:71], v[204:207], v[88:91]
    ds_read_b128 v[68:71], v43 offset:33792
    v_mfma_f32_16x16x32_bf16 v[92:95], v[72:75], v[204:207], v[92:95]
    ds_read_b128 v[72:75], v43 offset:34816
    s_waitcnt lgkmcnt(6)
    v_mfma_f32_16x16x32_bf16 v[96:99], v[76:79], v[204:207], v[96:99]
    ds_read_b128 v[76:79], v43 offset:35840
    v_mfma_f32_16x16x32_bf16 v[100:103], v[80:83], v[204:207], v[100:103]
    ds_read_b128 v[80:83], v43 offset:36864
    s_waitcnt lgkmcnt(7)
    v_mfma_f32_16x16x32_bf16 v[104:107], v[84:87], v[204:207], v[104:107]
    ds_read_b128 v[84:87], v43 offset:37888
    s_waitcnt lgkmcnt(6)
    v_mfma_f32_16x16x32_bf16 v[88:91], v[56:59], v[144:147], v[88:91]
    ds_read_b128 v[56:59], v43 offset:38912
    v_mfma_f32_16x16x32_bf16 v[92:95], v[60:63], v[144:147], v[92:95]
    ds_read_b128 v[60:63], v43 offset:39936
    s_waitcnt lgkmcnt(6)
    v_mfma_f32_16x16x32_bf16 v[96:99], v[64:67], v[144:147], v[96:99]
    ds_read_b128 v[64:67], v43 offset:40960
    v_mfma_f32_16x16x32_bf16 v[100:103], v[68:71], v[144:147], v[100:103]
    ds_read_b128 v[68:71], v43 offset:41984
    s_waitcnt lgkmcnt(7)
    v_mfma_f32_16x16x32_bf16 v[104:107], v[72:75], v[144:147], v[104:107]
    ds_read_b128 v[72:75], v43 offset:43008
    s_waitcnt vmcnt(6) lgkmcnt(6)
    v_mfma_f32_16x16x32_bf16 v[88:91], v[76:79], v[148:151], v[88:91]
    ds_read_b128 v[76:79], v43 offset:44032
    v_mfma_f32_16x16x32_bf16 v[92:95], v[80:83], v[148:151], v[92:95]
    ds_read_b128 v[80:83], v43 offset:45056
    s_waitcnt lgkmcnt(6)
    v_mfma_f32_16x16x32_bf16 v[96:99], v[84:87], v[148:151], v[96:99]
    ds_read_b128 v[84:87], v43 offset:46080
    v_mfma_f32_16x16x32_bf16 v[100:103], v[56:59], v[148:151], v[100:103]
    ds_read_b128 v[56:59], v43 offset:47104
    s_waitcnt lgkmcnt(7)
    v_mfma_f32_16x16x32_bf16 v[104:107], v[60:63], v[148:151], v[104:107]
    ds_read_b128 v[60:63], v43 offset:48128
    s_waitcnt vmcnt(5) lgkmcnt(6)
    v_mfma_f32_16x16x32_bf16 v[88:91], v[64:67], v[152:155], v[88:91]
    ds_read_b128 v[64:67], v43 offset:49152
    v_mfma_f32_16x16x32_bf16 v[92:95], v[68:71], v[152:155], v[92:95]
    ds_read_b128 v[68:71], v43 offset:50176
    s_waitcnt lgkmcnt(6)
    v_mfma_f32_16x16x32_bf16 v[96:99], v[72:75], v[152:155], v[96:99]
    ds_read_b128 v[72:75], v43 offset:51200
    v_mfma_f32_16x16x32_bf16 v[100:103], v[76:79], v[152:155], v[100:103]
    ds_read_b128 v[76:79], v43 offset:52224
    s_waitcnt lgkmcnt(7)
    v_mfma_f32_16x16x32_bf16 v[104:107], v[80:83], v[152:155], v[104:107]
    ds_read_b128 v[80:83], v43 offset:53248
    s_waitcnt vmcnt(0)
    v_cmp_gt_u32 vcc, s77, v7
    s_cbranch_vccnz L98_pp
L99_ppd:
    buffer_load_dwordx4 v[108:111], v1, s[4:7], s59 offen sc1
    buffer_load_dwordx4 v[112:115], v1, s[4:7], s59 offen offset:1024 sc1
    buffer_load_dwordx2 v[116:117], v1, s[4:7], s60 offen sc1
    s_waitcnt lgkmcnt(6)
    v_mfma_f32_16x16x32_bf16 v[88:91], v[84:87], v[156:159], v[88:91]
    ds_read_b128 v[84:87], v43 offset:54272
    v_mfma_f32_16x16x32_bf16 v[92:95], v[56:59], v[156:159], v[92:95]
    ds_read_b128 v[56:59], v43 offset:55296
    s_waitcnt lgkmcnt(6)
    v_mfma_f32_16x16x32_bf16 v[96:99], v[60:63], v[156:159], v[96:99]
    ds_read_b128 v[60:63], v43 offset:56320
    v_mfma_f32_16x16x32_bf16 v[100:103], v[64:67], v[156:159], v[100:103]
    ds_read_b128 v[64:67], v43 offset:57344
    s_waitcnt lgkmcnt(7)
    v_mfma_f32_16x16x32_bf16 v[104:107], v[68:71], v[156:159], v[104:107]
    ds_read_b128 v[68:71], v43 offset:58368
    s_waitcnt lgkmcnt(6)
    v_mfma_f32_16x16x32_bf16 v[88:91], v[72:75], v[160:163], v[88:91]
    ds_read_b128 v[72:75], v43 offset:59392
    v_mfma_f32_16x16x32_bf16 v[92:95], v[76:79], v[160:163], v[92:95]
    ds_read_b128 v[76:79], v43 offset:60416
    s_waitcnt lgkmcnt(6)
    v_mfma_f32_16x16x32_bf16 v[96:99], v[80:83], v[160:163], v[96:99]
    v_mfma_f32_16x16x32_bf16 v[100:103], v[84:87], v[160:163], v[100:103]
    s_waitcnt lgkmcnt(5)
    v_mfma_f32_16x16x32_bf16 v[104:107], v[56:59], v[160:163], v[104:107]
    s_waitcnt lgkmcnt(3)
    v_mfma_f32_16x16x32_bf16 v[88:91], v[60:63], v[164:167], v[88:91]
    v_mfma_f32_16x16x32_bf16 v[92:95], v[64:67], v[164:167], v[92:95]
    s_waitcnt lgkmcnt(1)
    v_mfma_f32_16x16x32_bf16 v[96:99], v[68:71], v[164:167], v[96:99]
    v_mfma_f32_16x16x32_bf16 v[100:103], v[72:75], v[164:167], v[100:103]
    s_waitcnt lgkmcnt(0)
    v_mfma_f32_16x16x32_bf16 v[104:107], v[76:79], v[164:167], v[104:107]
    s_barrier
    s_waitcnt vmcnt(0)
    s_nop 2
    v_lshlrev_b32 v4, 16, v108
    v_and_b32 v5, 0xffff0000, v108
    v_pk_add_f32 v[8:9], v[88:89], v[4:5]
    v_cvt_pk_bf16_f32 v128, v8, v9
    v_lshlrev_b32 v6, 16, v109
    v_and_b32 v7, 0xffff0000, v109
    v_pk_add_f32 v[10:11], v[90:91], v[6:7]
    v_cvt_pk_bf16_f32 v129, v10, v11
    v_lshlrev_b32 v4, 16, v110
    v_and_b32 v5, 0xffff0000, v110
    v_pk_add_f32 v[12:13], v[92:93], v[4:5]
    v_cvt_pk_bf16_f32 v130, v12, v13
    v_lshlrev_b32 v6, 16, v111
    v_and_b32 v7, 0xffff0000, v111
    v_pk_add_f32 v[14:15], v[94:95], v[6:7]
    v_cvt_pk_bf16_f32 v131, v14, v15
    v_lshlrev_b32 v4, 16, v112
    v_and_b32 v5, 0xffff0000, v112
    v_pk_add_f32 v[16:17], v[96:97], v[4:5]
    v_cvt_pk_bf16_f32 v132, v16, v17
    v_lshlrev_b32 v6, 16, v113
    v_and_b32 v7, 0xffff0000, v113
    v_pk_add_f32 v[18:19], v[98:99], v[6:7]
    v_cvt_pk_bf16_f32 v133, v18, v19
    v_lshlrev_b32 v4, 16, v114
    v_and_b32 v5, 0xffff0000, v114
    v_pk_add_f32 v[20:21], v[100:101], v[4:5]
    v_cvt_pk_bf16_f32 v134, v20, v21
    v_lshlrev_b32 v6, 16, v115
    v_and_b32 v7, 0xffff0000, v115
    v_pk_add_f32 v[22:23], v[102:103], v[6:7]
    v_cvt_pk_bf16_f32 v135, v22, v23
    v_lshlrev_b32 v4, 16, v116
    v_and_b32 v5, 0xffff0000, v116
    v_pk_add_f32 v[24:25], v[104:105], v[4:5]
    v_cvt_pk_bf16_f32 v136, v24, v25
    v_lshlrev_b32 v6, 16, v117
    v_and_b32 v7, 0xffff0000, v117
    v_pk_add_f32 v[26:27], v[106:107], v[6:7]
    v_cvt_pk_bf16_f32 v137, v26, v27
    s_cmp_lg_u32 s3, 0
    s_cbranch_scc1 L_out
    s_cmp_eq_u32 s47, 0
    s_cbranch_scc1 L102_slow
    buffer_store_dwordx4 v[128:131], v1, s[4:7], s59 offen nt
    buffer_store_dwordx4 v[132:135], v1, s[4:7], s59 offen offset:1024 nt
    buffer_store_dwordx2 v[136:137], v1, s[4:7], s60 offen nt
L103_back:
    v_mov_b32 v142, 0x3f803f80
    v_dot2_f32_bf16 v139, v128, v128, 0
    v_dot2_f32_bf16 v138, v128, v142, 0
    v_dot2_f32_bf16 v141, v129, v129, 0
    v_dot2_f32_bf16 v140, v129, v142, 0
    v_dot2_f32_bf16 v139, v130, v130, v139
    v_dot2_f32_bf16 v138, v130, v142, v138
    v_dot2_f32_bf16 v141, v131, v131, v141
    v_dot2_f32_bf16 v140, v131, v142, v140
    v_dot2_f32_bf16 v139, v132, v132, v139
    v_dot2_f32_bf16 v138, v132, v142, v138
    v_dot2_f32_bf16 v141, v133, v133, v141
    v_dot2_f32_bf16 v140, v133, v142, v140
    v_dot2_f32_bf16 v139, v134, v134, v139
    v_dot2_f32_bf16 v138, v134, v142, v138
    v_dot2_f32_bf16 v141, v135, v135, v141
    v_dot2_f32_bf16 v140, v135, v142, v140
    v_dot2_f32_bf16 v139, v136, v136, v139
    v_dot2_f32_bf16 v138, v136, v142, v138
    v_dot2_f32_bf16 v141, v137, v137, v141
    v_dot2_f32_bf16 v140, v137, v142, v140
    v_lshlrev_b32 v4, 2, v3
    v_lshl_add_u32 v4, v2, 4, v4
    s_nop 0
    v_pk_add_f32 v[138:139], v[138:139], v[140:141]
    s_nop 1
    v_permlane16_swap_b32 v138, v139
    s_nop 0
    v_add_f32 v138, v138, v139
    v_mov_b32 v139, v138
    s_nop 1
    v_permlane32_swap_b32 v138, v139
    s_nop 0
    v_add_f32 v138, v138, v139
    s_mov_b32 exec_hi, 0
    s_cmp_eq_u32 s47, 0
    s_cbranch_scc1 L104_slow
    buffer_store_dword v138, v4, s[4:7], s61 offen
L105_back:
    s_mov_b64 exec, -1
    s_lshl_b32 s66, s46, 10
    v_add_u32 v4, s66, v1
    v_add_u32 v5, 40960, v4
    ds_write_b128 v4, v[212:215] offset:0
    ds_write_b128 v4, v[216:219] offset:8192
    ds_write_b128 v4, v[220:223] offset:16384
    ds_write_b128 v4, v[224:227] offset:24576
    ds_write_b128 v4, v[228:231] offset:32768
    ds_write_b128 v5, v[232:235] offset:0
    v_mov_b32 v4, 6
    v_mov_b32 v5, 0
    s_waitcnt vmcnt(0)
    s_mov_b64 exec, 1
    s_cmp_eq_u32 s47, 0
    s_cbranch_scc1 L106_slow
    buffer_store_dword v4, v5, s[4:7], s62 offen
L107_back:
    s_mov_b64 exec, -1
    s_mov_b32 s3, 1
    s_setprio 2
    s_lshl_b32 s66, s46, 10
    v_add_u32 v4, s66, v1
    v_add_u32 v5, 40960, v4
    ds_write_b128 v5, v[236:239] offset:8192
    ds_write_b128 v5, v[240:243] offset:16384
    ds_write_b128 v5, v[244:247] offset:24576
    ds_write_b128 v5, v[248:251] offset:32768
    v_add_u32 v52, 65536, v1
    s_lshl_b32 s66, s44, 3
    s_add_u32 s66, s66, s46
    s_mul_i32 s81, s66, 43008
    s_add_u32 s84, s81, 20480
    s_add_u32 s82, s81, 21504
    s_lshl_b32 s68, s46, 8
    s_add_u32 s68, s68, s80
    v_lshlrev_b32 v6, 2, v2
    s_lshl_b32 s75, s3, 2
    s_add_u32 s75, s75, 2
    s_mov_b32 s74, s68
    s_lshr_b32 s69, s46, 2
    s_add_u32 s69, s69, s75
    s_sub_u32 s69, s69, 1
    s_branch L_q1_w
L_out:
    s_mul_i32 s66, s46, 3072
    v_mul_u32_u24 v43, 160, v2
    v_lshl_add_u32 v43, v3, 3, v43
    v_add_u32 v43, s66, v43
    v_add_u32 v44, s66, v1
    ds_write_b64 v43, v[128:129] offset:0
    ds_write_b64 v43, v[130:131] offset:32
    ds_write_b64 v43, v[132:133] offset:64
    ds_write_b64 v43, v[134:135] offset:96
    ds_write_b64 v43, v[136:137] offset:128
    s_mul_i32 s66, s63, 20480
    s_mul_i32 s67, s49, 160
    s_add_u32 s66, s66, s67
    s_waitcnt lgkmcnt(0)
    ds_read_b128 v[108:111], v44 offset:0
    ds_read_b128 v[112:115], v44 offset:1024
    ds_read_b128 v[116:119], v44 offset:2048
    v_add_u32 v4, 0, v0
    v_mul_u32_u24 v5, 205, v4
    v_lshrrev_b32 v5, 11, v5
    v_mul_u32_u24 v6, 10, v5
    v_sub_u32 v4, v4, v6
    v_mul_u32_u24 v5, 1280, v5
    v_lshl_add_u32 v4, s50, 1, v4
    v_subrev_u32 v6, 10, v4
    v_min_u32 v4, v4, v6
    v_lshl_add_u32 v40, v4, 4, v5
    v_add_u32 v4, 64, v0
    v_mul_u32_u24 v5, 205, v4
    v_lshrrev_b32 v5, 11, v5
    v_mul_u32_u24 v6, 10, v5
    v_sub_u32 v4, v4, v6
    v_mul_u32_u24 v5, 1280, v5
    v_lshl_add_u32 v4, s50, 1, v4
    v_subrev_u32 v6, 10, v4
    v_min_u32 v4, v4, v6
    v_lshl_add_u32 v41, v4, 4, v5
    v_add_u32 v4, 128, v0
    v_mul_u32_u24 v5, 205, v4
    v_lshrrev_b32 v5, 11, v5
    v_mul_u32_u24 v6, 10, v5
    v_sub_u32 v4, v4, v6
    v_mul_u32_u24 v5, 1280, v5
    v_lshl_add_u32 v4, s50, 1, v4
    v_subrev_u32 v6, 10, v4
    v_min_u32 v4, v4, v6
    v_lshl_add_u32 v42, v4, 4, v5
    s_waitcnt lgkmcnt(2)
    buffer_store_dwordx4 v[108:111], v40, s[36:39], s66 offen nt
    s_waitcnt lgkmcnt(1)
    buffer_store_dwordx4 v[112:115], v41, s[36:39], s66 offen nt
    s_waitcnt lgkmcnt(0)
    s_mov_b32 exec_hi, 0
    buffer_store_dwordx4 v[116:119], v42, s[36:39], s66 offen nt
    s_mov_b64 exec, -1
    s_endpgm
L_ch_h:
    s_lshl_b32 s74, s53, 10
    s_and_b32 s83, s45, 15
    s_mul_i32 s83, s83, 122880
    s_add_u32 s83, s83, s74
    s_add_u32 s83, s83, 0x1600000
    s_and_b32 s66, s45, 15
    s_mul_i32 s66, s66, 192
    s_lshl_b32 s67, s51, 5
    s_add_u32 s66, s66, s67
    v_lshlrev_b32 v5, 1, v2
    buffer_load_ushort v40, v5, s[24:27], s66 offen offset:0
    buffer_load_ushort v41, v5, s[24:27], s66 offen offset:128
    buffer_load_ushort v42, v5, s[24:27], s66 offen offset:64
    s_add_u32 m0, s74, 135168
    s_add_u32 s66, s83, 32768
    buffer_load_dwordx4 v1, s[4:7], s66 offen sc1 lds
    s_waitcnt vmcnt(6)
    s_add_u32 m0, s74, 143360
    s_add_u32 s66, s83, 40960
    buffer_load_dwordx4 v1, s[4:7], s66 offen sc1 lds
    s_waitcnt vmcnt(6)
    s_cmp_lg_u32 s3, 0
    s_cbranch_scc1 L108_hl0
    v_mov_b32 v100, 0x3f803f80
    v_mov_b32 v101, 0x3f803f80
    v_mov_b32 v102, 0x3f803f80
    v_mov_b32 v103, 0x3f803f80
    s_nop 1
    v_mfma_f32_16x16x32_bf16 v[88:91], v[100:103], v[188:191], 0
    v_mfma_f32_16x16x32_bf16 v[92:95], v[100:103], v[192:195], 0
    v_mfma_f32_16x16x32_bf16 v[96:99], v[100:103], v[196:199], 0
    v_mfma_f32_16x16x32_bf16 v[88:91], v[100:103], v[200:203], v[88:91]
    v_mfma_f32_16x16x32_bf16 v[92:95], v[100:103], v[204:207], v[92:95]
    v_mfma_f32_16x16x32_bf16 v[96:99], v[100:103], v[208:211], v[96:99]
    v_mfma_f32_16x16x32_bf16 v[88:91], v[100:103], v[36:39], v[88:91]
    v_mfma_f32_16x16x32_bf16 v[92:95], v[100:103], v[8:11], v[92:95]
    v_mfma_f32_16x16x32_bf16 v[96:99], v[100:103], v[12:15], v[96:99]
    v_mfma_f32_16x16x32_bf16 v[88:91], v[100:103], v[16:19], v[88:91]
    v_mfma_f32_16x16x32_bf16 v[92:95], v[100:103], v[20:23], v[92:95]
    v_mfma_f32_16x16x32_bf16 v[96:99], v[100:103], v[24:27], v[96:99]
L108_hl0:
    s_barrier
    s_add_u32 m0, s74, 139264
    s_add_u32 s66, s83, 36864
    buffer_load_dwordx4 v1, s[4:7], s66 offen sc1 lds
    s_waitcnt vmcnt(6)
    s_add_u32 s66, s74, 40960
    v_add_u32 v4, s66, v1
    v_add_u32 v6, 61440, v4
    s_waitcnt vmcnt(0)
    s_barrier
    s_add_u32 m0, s74, 90112
    s_add_u32 s66, s83, 110592
    buffer_load_dwordx4 v1, s[4:7], s66 offen sc1 lds
    s_waitcnt vmcnt(6)
    s_add_u32 m0, s74, 94208
    s_add_u32 s66, s83, 114688
    buffer_load_dwordx4 v1, s[4:7], s66 offen sc1 lds
    s_waitcnt vmcnt(6)
    s_add_u32 m0, s74, 98304
    s_add_u32 s66, s83, 118784
    buffer_load_dwordx4 v1, s[4:7], s66 offen sc1 lds
    s_waitcnt vmcnt(6)
    ds_write_b128 v4, v[188:191] offset:0
    ds_write_b128 v4, v[192:195] offset:4096
    ds_write_b128 v4, v[196:199] offset:8192
    ds_write_b128 v4, v[200:203] offset:12288
    ds_write_b128 v4, v[204:207] offset:16384
    ds_write_b128 v4, v[208:211] offset:20480
    ds_write_b128 v4, v[36:39] offset:24576
    ds_write_b128 v4, v[8:11] offset:28672
    ds_write_b128 v4, v[12:15] offset:32768
    ds_write_b128 v4, v[16:19] offset:36864
    ds_write_b128 v4, v[20:23] offset:40960
    ds_write_b128 v4, v[24:27] offset:45056
    s_and_b32 s83, s45, 15
    s_mul_i32 s83, s83, 122880
    s_add_u32 s83, s83, s74
    s_add_u32 s83, s83, 0x1800000
    s_waitcnt vmcnt(0)
    s_waitcnt lgkmcnt(0)
    s_cmp_lg_u32 s3, 0
    s_cbranch_scc1 L109_hl0
    ds_read_b128 v[48:51], v6 offset:0
    ds_read_b128 v[52:55], v6 offset:4096
    ds_read_b128 v[56:59], v6 offset:8192
    ds_read_b128 v[60:63], v6 offset:12288
    ds_read_b128 v[64:67], v6 offset:16384
    ds_read_b128 v[68:71], v6 offset:20480
    ds_read_b128 v[72:75], v6 offset:24576
    ds_read_b128 v[76:79], v6 offset:28672
    ds_read_b128 v[80:83], v6 offset:32768
    s_waitcnt lgkmcnt(8)
    v_mfma_f32_16x16x32_bf16 v[88:91], v[100:103], v[48:51], v[88:91]
    s_waitcnt lgkmcnt(7)
    v_mfma_f32_16x16x32_bf16 v[92:95], v[100:103], v[52:55], v[92:95]
    s_waitcnt lgkmcnt(6)
    v_mfma_f32_16x16x32_bf16 v[96:99], v[100:103], v[56:59], v[96:99]
    s_waitcnt lgkmcnt(5)
    v_mfma_f32_16x16x32_bf16 v[88:91], v[100:103], v[60:63], v[88:91]
    s_waitcnt lgkmcnt(4)
    v_mfma_f32_16x16x32_bf16 v[92:95], v[100:103], v[64:67], v[92:95]
    s_waitcnt lgkmcnt(3)
    v_mfma_f32_16x16x32_bf16 v[96:99], v[100:103], v[68:71], v[96:99]
    s_waitcnt lgkmcnt(2)
    v_mfma_f32_16x16x32_bf16 v[88:91], v[100:103], v[72:75], v[88:91]
    s_waitcnt lgkmcnt(1)
    v_mfma_f32_16x16x32_bf16 v[92:95], v[100:103], v[76:79], v[92:95]
    s_waitcnt lgkmcnt(0)
    v_mfma_f32_16x16x32_bf16 v[96:99], v[100:103], v[80:83], v[96:99]
    ds_read_b128 v[48:51], v6 offset:36864
    ds_read_b128 v[52:55], v6 offset:40960
    ds_read_b128 v[56:59], v6 offset:45056
    ds_read_b128 v[60:63], v6 offset:49152
    ds_read_b128 v[64:67], v6 offset:53248
    ds_read_b128 v[68:71], v6 offset:57344
    ds_read_b128 v[72:75], v4 offset:49152
    ds_read_b128 v[76:79], v4 offset:53248
    ds_read_b128 v[80:83], v4 offset:57344
    s_waitcnt lgkmcnt(8)
    v_mfma_f32_16x16x32_bf16 v[88:91], v[100:103], v[48:51], v[88:91]
    s_waitcnt lgkmcnt(7)
    v_mfma_f32_16x16x32_bf16 v[92:95], v[100:103], v[52:55], v[92:95]
    s_waitcnt lgkmcnt(6)
    v_mfma_f32_16x16x32_bf16 v[96:99], v[100:103], v[56:59], v[96:99]
    s_waitcnt lgkmcnt(5)
    v_mfma_f32_16x16x32_bf16 v[88:91], v[100:103], v[60:63], v[88:91]
    s_waitcnt lgkmcnt(4)
    v_mfma_f32_16x16x32_bf16 v[92:95], v[100:103], v[64:67], v[92:95]
    s_waitcnt lgkmcnt(3)
    v_mfma_f32_16x16x32_bf16 v[96:99], v[100:103], v[68:71], v[96:99]
    s_waitcnt lgkmcnt(2)
    v_mfma_f32_16x16x32_bf16 v[88:91], v[100:103], v[72:75], v[88:91]
    s_waitcnt lgkmcnt(1)
    v_mfma_f32_16x16x32_bf16 v[92:95], v[100:103], v[76:79], v[92:95]
    s_waitcnt lgkmcnt(0)
    v_mfma_f32_16x16x32_bf16 v[96:99], v[100:103], v[80:83], v[96:99]
    s_nop 7
    v_mov_b32 v32, v88
    v_mov_b32 v33, v92
    v_mov_b32 v34, v96
L109_hl0:
    s_cmp_eq_u32 s52, 0
    s_cselect_b64 vcc, -1, 0
    s_lshl_b32 s66, s51, 9
    s_lshl_b32 s67, s52, 8
    s_add_u32 s66, s66, s67
    s_add_u32 s66, s66, 36864
    s_mul_i32 s67, s52, 1024
    s_add_u32 s67, s67, s66
    v_lshl_add_u32 v48, v2, 4, s67
    v_cndmask_b32 v90, 0, v40, vcc
    v_cvt_pk_bf16_f32 v88, v32, v32
    v_and_b32 v5, 0xffff0000, v88
    v_sub_f32 v5, v32, v5
    v_and_b32 v89, 0xffff, v88
    v_cvt_pk_bf16_f32 v88, v32, v5
    v_lshl_or_b32 v89, v90, 16, v89
    v_mov_b32 v91, 0
    s_mul_i32 s67, s52, -2048
    s_add_u32 s67, s67, s66
    v_lshl_add_u32 v49, v2, 4, s67
    v_cndmask_b32 v94, 0, v41, vcc
    v_cvt_pk_bf16_f32 v92, v33, v33
    v_and_b32 v5, 0xffff0000, v92
    v_sub_f32 v5, v33, v5
    v_and_b32 v93, 0xffff, v92
    v_cvt_pk_bf16_f32 v92, v33, v5
    v_lshl_or_b32 v93, v94, 16, v93
    v_mov_b32 v95, 0
    s_mul_i32 s67, s52, 1024
    s_add_u32 s67, s67, s66
    v_lshl_add_u32 v50, v2, 4, s67
    v_cndmask_b32 v98, 0, v42, vcc
    v_cvt_pk_bf16_f32 v96, v34, v34
    v_and_b32 v5, 0xffff0000, v96
    v_sub_f32 v5, v34, v5
    v_and_b32 v97, 0xffff, v96
    v_cvt_pk_bf16_f32 v96, v34, v5
    v_lshl_or_b32 v97, v98, 16, v97
    v_mov_b32 v99, 0
    s_mov_b64 exec, 0xffff
    ds_write_b128 v48, v[88:91] offset:0
    ds_write_b128 v49, v[92:95] offset:2048
    ds_write_b128 v50, v[96:99] offset:1024
    s_mov_b64 exec, -1
    s_waitcnt lgkmcnt(0)
    s_barrier
    s_add_u32 m0, s74, 0
    s_add_u32 s66, s83, 0
    buffer_load_dwordx4 v1, s[4:7], s66 offen sc1 lds
    s_waitcnt vmcnt(0)
    s_add_u32 m0, s74, 4096
    s_add_u32 s66, s83, 4096
    buffer_load_dwordx4 v1, s[4:7], s66 offen sc1 lds
    s_waitcnt vmcnt(0)
    s_add_u32 m0, s74, 8192
    s_add_u32 s66, s83, 8192
    buffer_load_dwordx4 v1, s[4:7], s66 offen sc1 lds
    s_waitcnt vmcnt(0)
    s_add_u32 m0, s74, 12288
    s_add_u32 s66, s83, 12288
    buffer_load_dwordx4 v1, s[4:7], s66 offen sc1 lds
    s_waitcnt vmcnt(0)
    s_add_u32 m0, s74, 16384
    s_add_u32 s66, s83, 16384
    buffer_load_dwordx4 v1, s[4:7], s66 offen sc1 lds
    s_waitcnt vmcnt(0)
    s_add_u32 m0, s74, 20480
    s_add_u32 s66, s83, 20480
    buffer_load_dwordx4 v1, s[4:7], s66 offen sc1 lds
    s_waitcnt vmcnt(0)
    s_add_u32 m0, s74, 24576
    s_add_u32 s66, s83, 24576
    buffer_load_dwordx4 v1, s[4:7], s66 offen sc1 lds
    s_waitcnt vmcnt(0)
    s_add_u32 m0, s74, 28672
    s_add_u32 s66, s83, 28672
    buffer_load_dwordx4 v1, s[4:7], s66 offen sc1 lds
    s_waitcnt vmcnt(0)
    s_add_u32 m0, s74, 32768
    s_add_u32 s66, s83, 32768
    buffer_load_dwordx4 v1, s[4:7], s66 offen sc1 lds
    s_waitcnt vmcnt(0)
    s_waitcnt vmcnt(0)
    s_barrier
    s_add_u32 m0, s74, 36864
    s_add_u32 s66, s83, 36864
    buffer_load_dwordx4 v1, s[4:7], s66 offen sc1 lds
    s_waitcnt vmcnt(3)
    s_add_u32 m0, s74, 40960
    s_add_u32 s66, s83, 40960
    buffer_load_dwordx4 v1, s[4:7], s66 offen sc1 lds
    s_waitcnt vmcnt(3)
    s_add_u32 m0, s74, 45056
    s_add_u32 s66, s83, 45056
    buffer_load_dwordx4 v1, s[4:7], s66 offen sc1 lds
    s_waitcnt vmcnt(3)
    s_add_u32 m0, s74, 49152
    s_add_u32 s66, s83, 49152
    buffer_load_dwordx4 v1, s[4:7], s66 offen sc1 lds
    s_waitcnt vmcnt(3)
    s_add_u32 m0, s74, 53248
    s_add_u32 s66, s83, 53248
    buffer_load_dwordx4 v1, s[4:7], s66 offen sc1 lds
    s_waitcnt vmcnt(3)
    s_add_u32 m0, s74, 57344
    s_add_u32 s66, s83, 57344
    buffer_load_dwordx4 v1, s[4:7], s66 offen sc1 lds
    s_waitcnt vmcnt(3)
    s_add_u32 m0, s74, 61440
    s_add_u32 s66, s83, 61440
    buffer_load_dwordx4 v1, s[4:7], s66 offen sc1 lds
    s_waitcnt vmcnt(3)
    s_add_u32 m0, s74, 65536
    s_add_u32 s66, s83, 65536
    buffer_load_dwordx4 v1, s[4:7], s66 offen sc1 lds
    s_waitcnt vmcnt(3)
    s_add_u32 m0, s74, 69632
    s_add_u32 s66, s83, 69632
    buffer_load_dwordx4 v1, s[4:7], s66 offen sc1 lds
    s_waitcnt vmcnt(3)
    s_add_u32 m0, s74, 73728
    s_add_u32 s66, s83, 73728
    buffer_load_dwordx4 v1, s[4:7], s66 offen sc1 lds
    s_waitcnt vmcnt(3)
    s_add_u32 m0, s74, 77824
    s_add_u32 s66, s83, 77824
    buffer_load_dwordx4 v1, s[4:7], s66 offen sc1 lds
    s_waitcnt vmcnt(3)
    s_add_u32 m0, s74, 81920
    s_add_u32 s66, s83, 81920
    buffer_load_dwordx4 v1, s[4:7], s66 offen sc1 lds
    s_waitcnt vmcnt(3)
    s_add_u32 m0, s74, 86016
    s_add_u32 s66, s83, 86016
    buffer_load_dwordx4 v1, s[4:7], s66 offen sc1 lds
    s_waitcnt vmcnt(3)
    s_add_u32 m0, s74, 90112
    s_add_u32 s66, s83, 90112
    buffer_load_dwordx4 v1, s[4:7], s66 offen sc1 lds
    s_waitcnt vmcnt(3)
    s_add_u32 m0, s74, 94208
    s_add_u32 s66, s83, 94208
    buffer_load_dwordx4 v1, s[4:7], s66 offen sc1 lds
    s_waitcnt vmcnt(3)
    s_add_u32 m0, s74, 98304
    s_add_u32 s66, s83, 98304
    buffer_load_dwordx4 v1, s[4:7], s66 offen sc1 lds
    s_waitcnt vmcnt(3)
    s_add_u32 m0, s74, 102400
    s_add_u32 s66, s83, 102400
    buffer_load_dwordx4 v1, s[4:7], s66 offen sc1 lds
    s_waitcnt vmcnt(3)
    s_add_u32 m0, s74, 106496
    s_add_u32 s66, s83, 106496
    buffer_load_dwordx4 v1, s[4:7], s66 offen sc1 lds
    s_waitcnt vmcnt(3)
    s_add_u32 m0, s74, 110592
    s_add_u32 s66, s83, 110592
    buffer_load_dwordx4 v1, s[4:7], s66 offen sc1 lds
    s_waitcnt vmcnt(3)
    s_add_u32 m0, s74, 114688
    s_add_u32 s66, s83, 114688
    buffer_load_dwordx4 v1, s[4:7], s66 offen sc1 lds
    s_waitcnt vmcnt(3)
    s_add_u32 m0, s74, 118784
    s_add_u32 s66, s83, 118784
    buffer_load_dwordx4 v1, s[4:7], s66 offen sc1 lds
    s_waitcnt vmcnt(3)
    s_waitcnt vmcnt(10)
    s_barrier
    s_waitcnt vmcnt(0)
    s_barrier
    s_barrier
    s_cmp_lg_u32 s3, 0
    s_cbranch_scc1 L_h_last
    s_lshl_b32 s66, s46, 10
    v_add_u32 v4, s66, v1
    v_add_u32 v5, 40960, v4
    ds_write_b128 v4, v[212:215] offset:0
    ds_write_b128 v4, v[216:219] offset:8192
    ds_write_b128 v4, v[220:223] offset:16384
    ds_write_b128 v4, v[224:227] offset:24576
    ds_write_b128 v4, v[228:231] offset:32768
    ds_write_b128 v5, v[232:235] offset:0
    ds_write_b128 v5, v[236:239] offset:8192
    ds_write_b128 v5, v[240:243] offset:16384
    ds_write_b128 v5, v[244:247] offset:24576
    ds_write_b128 v5, v[248:251] offset:32768
    s_mov_b32 s3, 1
    s_branch L_qkv1
L_h_last:
L_end:
    s_endpgm
L1_poll:
    buffer_load_dword v7, v6, s[40:43], 0 offen sc1
    s_waitcnt vmcnt(0)
    v_cmp_gt_u32 vcc, 1, v7
    s_cbranch_vccz L2_seen
    s_sub_u32 s48, s48, 1
    s_cbranch_scc0 L1_poll
    s_mov_b32 s48, 0
    s_branch L2_seen
L3_poll:
    buffer_load_dword v7, v6, s[4:7], s68 offen sc1
    s_waitcnt vmcnt(0)
    v_cmp_gt_u32 vcc, s69, v7
    s_cbranch_vccz L4_seen
    s_sub_u32 s48, s48, 1
    s_cbranch_scc0 L3_poll
    s_mov_b32 s48, 0
    s_branch L4_seen
L5_st:
    v_lshrrev_b32 v5, 1, v3
    v_mul_u32_u24 v5, 20480, v5
    v_lshl_add_u32 v5, v3, 9, v5
    v_lshl_add_u32 v5, v2, 4, v5
    buffer_load_dwordx4 v[100:103], v5, s[4:7], s84 offen offset:0 sc1
    buffer_load_dwordx4 v[104:107], v5, s[4:7], s84 offen offset:256 sc1
    s_branch L6_stb
L8_as:
    buffer_store_dwordx4 v[188:191], v1, s[4:7], s87 offen offset:0 sc1
    buffer_store_dwordx4 v[192:195], v1, s[4:7], s87 offen offset:1024 sc1
    s_mov_b32 exec_hi, 0
    buffer_store_dwordx4 v[196:199], v1, s[4:7], s87 offen offset:2048 sc1
    s_mov_b64 exec, -1
    s_branch L9_asb
L10_as:
    s_waitcnt vmcnt(0)
    v_cmp_gt_u32 vcc, s72, v7
    s_cbranch_vccz L13_seen
L12_poll:
    buffer_load_dword v7, v49, s[4:7], s71 offen sc1
    s_waitcnt vmcnt(0)
    v_cmp_gt_u32 vcc, s72, v7
    s_cbranch_vccz L13_seen
    s_sub_u32 s48, s48, 1
    s_cbranch_scc0 L12_poll
    s_mov_b32 s48, 0
L13_seen:
    s_add_u32 s73, s44, 1
    s_and_b32 s73, s73, 7
    s_mul_i32 s73, s73, 20480
    s_add_u32 s73, s73, s85
    s_add_u32 m0, s76, 0
    s_nop 0
    buffer_load_dwordx4 v1, s[4:7], s73 offen offset:0 sc1 lds
    s_add_u32 m0, s76, 0
    s_nop 0
    buffer_load_dwordx4 v1, s[4:7], s73 offen offset:1024 sc1 lds
    s_add_u32 m0, s76, 0
    s_mov_b32 exec_hi, 0
    buffer_load_dwordx4 v1, s[4:7], s73 offen offset:2048 sc1 lds
    s_mov_b64 exec, -1
    s_add_u32 s73, s44, 2
    s_and_b32 s73, s73, 7
    s_mul_i32 s73, s73, 20480
    s_add_u32 s73, s73, s85
    s_add_u32 m0, s76, 10240
    s_nop 0
    buffer_load_dwordx4 v1, s[4:7], s73 offen offset:0 sc1 lds
    s_add_u32 m0, s76, 10240
    s_nop 0
    buffer_load_dwordx4 v1, s[4:7], s73 offen offset:1024 sc1 lds
    s_add_u32 m0, s76, 10240
    s_mov_b32 exec_hi, 0
    buffer_load_dwordx4 v1, s[4:7], s73 offen offset:2048 sc1 lds
    s_mov_b64 exec, -1
    s_branch L11_asb
L14_as:
    v_mov_b32 v4, s72
    v_mov_b32 v5, 0
    s_waitcnt vmcnt(0)
    s_mov_b64 exec, 1
    buffer_store_dword v4, v5, s[4:7], s88 offen sc1
    s_mov_b64 exec, -1
    s_branch L15_asb
L28_lpoll:
    buffer_load_dword v7, v49, s[4:7], s71 offen sc1
    s_waitcnt vmcnt(0)
    v_cmp_gt_u32 vcc, s72, v7
    s_cbranch_vccz L31_seen
L30_poll:
    buffer_load_dword v7, v49, s[4:7], s71 offen sc1
    s_waitcnt vmcnt(0)
    v_cmp_gt_u32 vcc, s72, v7
    s_cbranch_vccz L31_seen
    s_sub_u32 s48, s48, 1
    s_cbranch_scc0 L30_poll
    s_mov_b32 s48, 0
L31_seen:
    s_branch L29_lseen
L34_ppoll:
    buffer_load_dword v7, v50, s[4:7], s77 offen sc1
    s_waitcnt vmcnt(0)
    v_cmp_gt_u32 vcc, 1, v7
    s_cbranch_vccz L37_seen
L36_poll:
    buffer_load_dword v7, v50, s[4:7], s77 offen sc1
    s_waitcnt vmcnt(0)
    v_cmp_gt_u32 vcc, 1, v7
    s_cbranch_vccz L37_seen
    s_sub_u32 s48, s48, 1
    s_cbranch_scc0 L36_poll
    s_mov_b32 s48, 0
L37_seen:
    s_add_u32 s66, s80, 3200
    buffer_load_dword v7, v50, s[4:7], s66 offen sc1
    s_waitcnt vmcnt(0)
    v_cmp_gt_u32 vcc, 16, v7
    s_cbranch_vccz L39_seen
L38_poll:
    buffer_load_dword v7, v50, s[4:7], s66 offen sc1
    s_waitcnt vmcnt(0)
    v_cmp_gt_u32 vcc, 16, v7
    s_cbranch_vccz L39_seen
    s_sub_u32 s48, s48, 1
    s_cbranch_scc0 L38_poll
    s_mov_b32 s48, 0
L39_seen:
    s_branch L35_pseen
L40_plh:
    s_add_u32 s66, s78, 28672
    buffer_load_dwordx4 v[8:11], v1, s[4:7], s66 offen sc1
    s_branch L41_pld
L42_plh:
    s_add_u32 s66, s78, 32768
    buffer_load_dwordx4 v[12:15], v1, s[4:7], s66 offen sc1
    s_branch L43_pld
L44_plh:
    s_add_u32 s66, s78, 36864
    buffer_load_dwordx4 v[16:19], v1, s[4:7], s66 offen sc1
    s_branch L45_pld
L46_plh:
    s_add_u32 s66, s78, 40960
    buffer_load_dwordx4 v[20:23], v1, s[4:7], s66 offen sc1
    s_branch L47_pld
L48_plh:
    s_add_u32 s66, s78, 45056
    buffer_load_dwordx4 v[24:27], v1, s[4:7], s66 offen sc1
    s_branch L49_pld
L54_slow:
    buffer_store_dwordx2 v[120:121], v46, s[4:7], s87 offen sc1
    buffer_store_dwordx2 v[122:123], v47, s[4:7], s87 offen sc1
    s_mov_b32 exec_hi, 0
    buffer_store_dwordx2 v[124:125], v48, s[4:7], s87 offen sc1
    s_mov_b64 exec, -1
    s_branch L55_back
L56_slow:
    buffer_store_dword v4, v5, s[4:7], s88 offen sc1
    s_branch L57_back
L_att_redo:
    v_mov_b32 v152, 0
    v_mov_b32 v153, 0
    v_mov_b32 v154, 0
    v_mov_b32 v155, 0
    v_mov_b32 v156, 0
    v_mov_b32 v157, 0
    v_mov_b32 v158, 0
    v_mov_b32 v159, 0
    v_mov_b32 v160, 0
    v_mov_b32 v161, 0
    v_mov_b32 v162, 0
    v_mov_b32 v163, 0
    v_mov_b32 v164, 0
    v_mov_b32 v165, 0
    v_mov_b32 v166, 0
    v_mov_b32 v167, 0
    v_mov_b32 v168, 0
    v_mov_b32 v169, 0
    v_mov_b32 v170, 0
    v_mov_b32 v171, 0
    v_mov_b32 v172, 0
    v_mov_b32 v173, 0
    v_mov_b32 v174, 0
    v_mov_b32 v175, 0
    v_mov_b32 v176, 0
    v_mov_b32 v177, 0
    v_mov_b32 v178, 0
    v_mov_b32 v179, 0
    v_mov_b32 v180, 0
    v_mov_b32 v181, 0
    v_mov_b32 v182, 0
    v_mov_b32 v183, 0
    v_mov_b32 v184, 0xff800000
    v_mov_b32 v185, 0xff800000
    v_mov_b32 v88, 0
    v_mov_b32 v89, 0
    v_mov_b32 v90, 0
    v_mov_b32 v91, 0
    v_mov_b32 v92, 0
    v_mov_b32 v93, 0
    v_mov_b32 v94, 0
    v_mov_b32 v95, 0
    v_mov_b32 v96, 0
    v_mov_b32 v97, 0
    v_mov_b32 v98, 0
    v_mov_b32 v99, 0
    v_mov_b32 v100, 0
    v_mov_b32 v101, 0
    v_mov_b32 v102, 0
    v_mov_b32 v103, 0
    v_mov_b32 v104, 0
    v_mov_b32 v105, 0
    v_mov_b32 v106, 0
    v_mov_b32 v107, 0
    v_mov_b32 v108, 0
    v_mov_b32 v109, 0
    v_mov_b32 v110, 0
    v_mov_b32 v111, 0
    v_mov_b32 v112, 0
    v_mov_b32 v113, 0
    v_mov_b32 v114, 0
    v_mov_b32 v115, 0
    v_mov_b32 v116, 0
    v_mov_b32 v117, 0
    v_mov_b32 v118, 0
    v_mov_b32 v119, 0
L_fb_pass:
    s_mov_b32 s84, 0
L_fb_blk:
    s_waitcnt vmcnt(0) lgkmcnt(0)
    s_barrier
    s_lshl_b32 s73, s84, 1
    s_lshr_b32 s66, s46, 2
    s_add_u32 s73, s73, s66
    s_mul_i32 s73, s73, 10240
    s_add_u32 s73, s73, s85
    s_add_u32 m0, s76, 122880
    s_nop 0
    buffer_load_dwordx4 v1, s[4:7], s73 offen offset:0 sc1 lds
    s_add_u32 m0, s76, 122880
    s_nop 0
    buffer_load_dwordx4 v1, s[4:7], s73 offen offset:1024 sc1 lds
    s_add_u32 m0, s76, 122880
    s_mov_b32 exec_hi, 0
    buffer_load_dwordx4 v1, s[4:7], s73 offen offset:2048 sc1 lds
    s_mov_b64 exec, -1
    s_lshr_b32 s66, s46, 2
    s_mul_i32 s66, s66, 10240
    s_add_u32 s66, s66, 122880
    v_lshl_add_u32 v44, v40, 3, s66
    v_lshl_add_u32 v43, v41, 8, v44
    v_add_u32 v44, 1024, v44
    v_mul_u32_u24 v4, 20, v41
    v_add_u32 v4, v4, v40
    v_lshl_add_u32 v45, v4, 4, s66
    s_mov_b32 s75, 0
    s_waitcnt vmcnt(0)
    s_barrier
L_fb_step:
    ds_read_b64 v[62:63], v44 offset:0
    ds_read2st64_b64 v[64:67], v43 offset0:0 offset1:1
    s_mov_b64 exec, s[64:65]
    ds_read_b128 v[72:75], v45 offset:1280
    ds_read_b128 v[76:79], v45 offset:1920
    s_mov_b64 exec, -1
    s_waitcnt lgkmcnt(0)
    v_mfma_f32_32x32x4_2b_bf16 v[120:151], v[62:63], v[60:61], v[152:183]
    s_nop 15
    s_nop 1
    v_mfma_f32_32x32x16_bf16 v[120:135], v[64:67], v[52:55], v[120:135]
    v_mfma_f32_32x32x16_bf16 v[136:151], v[64:67], v[56:59], v[136:151]
    s_nop 11
    s_cmp_eq_u32 s86, 0
    s_cbranch_scc0 L_fb_sum
    v_max3_f32 v184, v184, v120, v121
    v_max3_f32 v184, v184, v122, v123
    v_max3_f32 v184, v184, v124, v125
    v_max3_f32 v184, v184, v126, v127
    v_max3_f32 v184, v184, v128, v129
    v_max3_f32 v184, v184, v130, v131
    v_max3_f32 v184, v184, v132, v133
    v_max3_f32 v184, v184, v134, v135
    v_max3_f32 v185, v185, v136, v137
    v_max3_f32 v185, v185, v138, v139
    v_max3_f32 v185, v185, v140, v141
    v_max3_f32 v185, v185, v142, v143
    v_max3_f32 v185, v185, v144, v145
    v_max3_f32 v185, v185, v146, v147
    v_max3_f32 v185, v185, v148, v149
    v_max3_f32 v185, v185, v150, v151
    s_branch L_fb_next
L_fb_sum:
    v_exp_f32 v120, v120
    v_exp_f32 v121, v121
    v_exp_f32 v122, v122
    v_exp_f32 v123, v123
    v_exp_f32 v124, v124
    v_exp_f32 v125, v125
    v_exp_f32 v126, v126
    v_exp_f32 v127, v127
    v_exp_f32 v128, v128
    v_exp_f32 v129, v129
    v_exp_f32 v130, v130
    v_exp_f32 v131, v131
    v_exp_f32 v132, v132
    v_exp_f32 v133, v133
    v_exp_f32 v134, v134
    v_exp_f32 v135, v135
    v_exp_f32 v136, v136
    v_exp_f32 v137, v137
    v_exp_f32 v138, v138
    v_exp_f32 v139, v139
    v_exp_f32 v140, v140
    v_exp_f32 v141, v141
    v_exp_f32 v142, v142
    v_exp_f32 v143, v143
    v_exp_f32 v144, v144
    v_exp_f32 v145, v145
    v_exp_f32 v146, v146
    v_exp_f32 v147, v147
    v_exp_f32 v148, v148
    v_exp_f32 v149, v149
    v_exp_f32 v150, v150
    v_exp_f32 v151, v151
    s_nop 1
    v_smfmac_f32_32x32x32_bf16 v[88:103], v[72:75], v[120:127], v42
    v_smfmac_f32_32x32x32_bf16 v[88:103], v[76:79], v[128:135], v42
    v_smfmac_f32_32x32x32_bf16 v[104:119], v[72:75], v[136:143], v42
    v_smfmac_f32_32x32x32_bf16 v[104:119], v[76:79], v[144:151], v42
L_fb_next:
    v_add_u32 v43, 2560, v43
    v_add_u32 v44, 2560, v44
    v_add_u32 v45, 2560, v45
    s_add_u32 s75, s75, 1
    s_cmp_lt_u32 s75, 4
    s_cbranch_scc1 L_fb_step
    s_add_u32 s84, s84, 1
    s_cmp_lt_u32 s84, 8
    s_cbranch_scc1 L_fb_blk
    s_nop 15
    s_cmp_eq_u32 s86, 0
    s_cbranch_scc1 L_fb_max
    s_lshl_b32 s68, s46, 11
    s_add_u32 s68, s68, 102400
    v_add_u32 v64, s68, v1
    s_lshr_b32 s68, s46, 2
    s_mul_i32 s68, s68, 24576
    s_lshl_b32 s69, s53, 10
    s_add_u32 s68, s68, s69
    s_add_u32 s68, s68, 118784
    v_add_u32 v65, s68, v1
    s_xor_b32 s66, s46, 4
    s_lshl_b32 s68, s66, 11
    s_add_u32 s68, s68, 102400
    v_add_u32 v66, s68, v1
    s_lshr_b32 s68, s66, 2
    s_mul_i32 s68, s68, 24576
    s_lshl_b32 s69, s53, 10
    s_add_u32 s68, s68, s69
    s_add_u32 s68, s68, 118784
    v_add_u32 v67, s68, v1
    ds_write_b128 v64, v[88:91] offset:0
    ds_write_b128 v64, v[92:95] offset:1024
    ds_write_b128 v65, v[96:99] offset:0
    s_branch L_att_fin
L_fb_max:
    v_mov_b32 v4, v184
    v_mov_b32 v5, v185
    s_nop 1
    v_permlane32_swap_b32 v184, v4
    v_permlane32_swap_b32 v185, v5
    v_max_f32 v184, v184, v4
    v_max_f32 v185, v185, v5
    s_lshl_b32 s66, s46, 9
    s_add_u32 s66, s66, 102400
    v_lshl_add_u32 v4, v0, 3, s66
    s_xor_b32 s66, s46, 4
    s_lshl_b32 s66, s66, 9
    s_add_u32 s66, s66, 102400
    v_lshl_add_u32 v5, v0, 3, s66
    ds_write_b64 v4, v[184:185]
    s_waitcnt lgkmcnt(0)
    s_barrier
    ds_read_b64 v[6:7], v5
    s_waitcnt lgkmcnt(0)
    v_max_f32 v184, v184, v7
    v_max_f32 v185, v185, v6
    v_sub_f32 v152, 0, v184
    v_sub_f32 v153, 0, v184
    v_sub_f32 v154, 0, v184
    v_sub_f32 v155, 0, v184
    v_sub_f32 v156, 0, v184
    v_sub_f32 v157, 0, v184
    v_sub_f32 v158, 0, v184
    v_sub_f32 v159, 0, v184
    v_sub_f32 v160, 0, v184
    v_sub_f32 v161, 0, v184
    v_sub_f32 v162, 0, v184
    v_sub_f32 v163, 0, v184
    v_sub_f32 v164, 0, v184
    v_sub_f32 v165, 0, v184
    v_sub_f32 v166, 0, v184
    v_sub_f32 v167, 0, v184
    v_sub_f32 v168, 0, v185
    v_sub_f32 v169, 0, v185
    v_sub_f32 v170, 0, v185
    v_sub_f32 v171, 0, v185
    v_sub_f32 v172, 0, v185
    v_sub_f32 v173, 0, v185
    v_sub_f32 v174, 0, v185
    v_sub_f32 v175, 0, v185
    v_sub_f32 v176, 0, v185
    v_sub_f32 v177, 0, v185
    v_sub_f32 v178, 0, v185
    v_sub_f32 v179, 0, v185
    v_sub_f32 v180, 0, v185
    v_sub_f32 v181, 0, v185
    v_sub_f32 v182, 0, v185
    v_sub_f32 v183, 0, v185
    s_mov_b32 s86, 1
    s_branch L_fb_pass
L58_poll:
    buffer_load_dword v7, v6, s[4:7], s68 offen sc1
    s_waitcnt vmcnt(0)
    v_cmp_gt_u32 vcc, s72, v7
    s_cbranch_vccz L59_seen
    s_sub_u32 s48, s48, 1
    s_cbranch_scc0 L58_poll
    s_mov_b32 s48, 0
    s_branch L59_seen
L60_slow:
    buffer_store_dwordx4 v[128:131], v1, s[4:7], s59 offen sc1
    buffer_store_dwordx4 v[132:135], v1, s[4:7], s59 offen offset:1024 sc1
    buffer_store_dwordx2 v[136:137], v1, s[4:7], s60 offen sc1
    s_branch L61_back
L62_slow:
    buffer_store_dword v138, v4, s[4:7], s61 offen sc1
    s_branch L63_back
L64_slow:
    buffer_store_dword v4, v5, s[4:7], s62 offen sc1
    s_branch L65_back
L66_x1:
    buffer_load_dword v7, v6, s[4:7], s68 offen sc1
    s_waitcnt vmcnt(0)
    v_cmp_gt_u32 vcc, s69, v7
    s_cbranch_vccz L69_seen
L68_poll:
    buffer_load_dword v7, v6, s[4:7], s68 offen sc1
    s_waitcnt vmcnt(0)
    v_cmp_gt_u32 vcc, s69, v7
    s_cbranch_vccz L69_seen
    s_sub_u32 s48, s48, 1
    s_cbranch_scc0 L68_poll
    s_mov_b32 s48, 0
L69_seen:
    s_branch L67_x1d
L70_slow:
    buffer_store_dwordx4 v[168:171], v1, s[4:7], s87 offen offset:0 sc1
    s_branch L71_back
L72_slow:
    buffer_store_dwordx4 v[172:175], v1, s[4:7], s84 offen offset:0 sc1
    s_branch L73_back
L74_slow:
    buffer_store_dwordx4 v[176:179], v1, s[4:7], s87 offen offset:1024 sc1
    s_branch L75_back
L76_slow:
    buffer_store_dwordx4 v[180:183], v1, s[4:7], s84 offen offset:1024 sc1
    s_branch L77_back
L78_slow:
    buffer_store_dwordx4 v[184:187], v1, s[4:7], s87 offen offset:2048 sc1
    s_branch L79_back
L80_slow:
    buffer_store_dword v48, v50, s[4:7], s88 offen sc1
    s_branch L81_back
L82_slow:
    buffer_store_dwordx4 v[188:191], v1, s[4:7], s84 offen offset:2048 sc1
    s_branch L83_back
L84_slow:
    buffer_store_dword v49, v50, s[4:7], s88 offen sc1
    s_branch L85_back
L86_ha:
    buffer_load_dword v7, v47, s[4:7], s75 offen sc1
    s_waitcnt vmcnt(0)
    v_cmp_gt_u32 vcc, s76, v7
    s_cbranch_vccz L89_seen
L88_poll:
    buffer_load_dword v7, v47, s[4:7], s75 offen sc1
    s_waitcnt vmcnt(0)
    v_cmp_gt_u32 vcc, s76, v7
    s_cbranch_vccz L89_seen
    s_sub_u32 s48, s48, 1
    s_cbranch_scc0 L88_poll
    s_mov_b32 s48, 0
L89_seen:
    s_branch L87_had
L90_hb:
    buffer_load_dword v7, v46, s[4:7], s74 offen sc1
    s_waitcnt vmcnt(0)
    v_cmp_gt_u32 vcc, s77, v7
    s_cbranch_vccz L93_seen
L92_poll:
    buffer_load_dword v7, v46, s[4:7], s74 offen sc1
    s_waitcnt vmcnt(0)
    v_cmp_gt_u32 vcc, s77, v7
    s_cbranch_vccz L93_seen
    s_sub_u32 s48, s48, 1
    s_cbranch_scc0 L92_poll
    s_mov_b32 s48, 0
L93_seen:
    s_branch L91_hbd
L94_slow:
    buffer_store_dwordx4 v[128:131], v1, s[4:7], s70 offen sc1
    buffer_store_dwordx4 v[132:135], v1, s[4:7], s70 offen offset:1024 sc1
    buffer_store_dwordx2 v[136:137], v1, s[4:7], s71 offen sc1
    s_branch L95_back
L96_slow:
    buffer_store_dword v49, v50, s[4:7], s72 offen sc1
    s_branch L97_back
L98_pp:
    buffer_load_dword v7, v50, s[4:7], s73 offen sc1
    s_waitcnt vmcnt(0)
    v_cmp_gt_u32 vcc, s77, v7
    s_cbranch_vccz L101_seen
L100_poll:
    buffer_load_dword v7, v50, s[4:7], s73 offen sc1
    s_waitcnt vmcnt(0)
    v_cmp_gt_u32 vcc, s77, v7
    s_cbranch_vccz L101_seen
    s_sub_u32 s48, s48, 1
    s_cbranch_scc0 L100_poll
    s_mov_b32 s48, 0
L101_seen:
    s_branch L99_ppd
L102_slow:
    buffer_store_dwordx4 v[128:131], v1, s[4:7], s59 offen sc1
    buffer_store_dwordx4 v[132:135], v1, s[4:7], s59 offen offset:1024 sc1
    buffer_store_dwordx2 v[136:137], v1, s[4:7], s60 offen sc1
    s_branch L103_back
L104_slow:
    buffer_store_dword v138, v4, s[4:7], s61 offen sc1
    s_branch L105_back
L106_slow:
    buffer_store_dword v4, v5, s[4:7], s62 offen sc1
    s_branch L107_back
L_last:
    s_endpgm
.section .rodata,"a"
.p2align 6
.amdhsa_kernel interleave_layers__softmax_full_mha__dense_activation_gelu__prompt_kernel
  .amdhsa_next_free_vgpr 256
  .amdhsa_next_free_sgpr 102
  .amdhsa_accum_offset 256
  .amdhsa_group_segment_fixed_size 0
  .amdhsa_kernarg_size 88
  .amdhsa_user_sgpr_count 2
  .amdhsa_user_sgpr_kernarg_segment_ptr 1
  .amdhsa_system_sgpr_workgroup_id_x 1
.end_amdhsa_kernel
```
